```python
import torch

def _softmax(x, axis=-1):
    return torch.softmax(x, dim=axis)
def _gelu(x):
    return torch.nn.functional.gelu(x, approximate="tanh")
def _silu(x):
    return torch.nn.functional.silu(x)
def _sigmoid(x):
    return torch.sigmoid(x)
def _layernorm(x, axis=-1, eps=1e-5):
    m = x.mean(dim=axis, keepdim=True)
    v = x.var(dim=axis, keepdim=True, unbiased=False)
    return (x - m) / torch.sqrt(v + eps)
def _scatter_add(tgt, idx, src, axis=0):
    return tgt.clone().index_add_(axis, idx, src)
def _segment_sum(src, seg, n):
    out = torch.zeros((n,) + src.shape[1:], dtype=src.dtype)
    return out.index_add_(0, seg, src)
def _pad(x, pw):
    flat = tuple(v for pair in reversed(pw) for v in pair)
    return torch.nn.functional.pad(x, flat)

kernel_name = 'interleave_layers__sliding_block__dense_activation_gelu__prompt'

def setup_inputs():

    _w = (lambda a: (lambda t: t.to(torch.bfloat16) if t.is_floating_point() else t)(torch.as_tensor(a)))
    def _A_setup():
        B, S, D = 1, 2048, 512
        return {
            "x": _w((lambda *s: torch.randn(*s, dtype=torch.bfloat16) * 0.05)(B, S, D)),
            "wqkv": _w((lambda *s: torch.randn(*s, dtype=torch.bfloat16) * 0.05)(D, 3 * D)),
            "wo": _w((lambda *s: torch.randn(*s, dtype=torch.bfloat16) * 0.05)(D, D)),
        }
    _A_in = _A_setup()

    def _B_setup():
        B, S, D, F = 1, 2048, 512, 1792
        return {
            "x": _w((lambda *s: torch.randn(*s, dtype=torch.bfloat16) * 0.05)(B, S, D)),
            "w1": _w((lambda *s: torch.randn(*s, dtype=torch.bfloat16) * 0.8)(D, F) * (D ** -0.5)),
            "b1": _w((lambda *s: torch.randn(*s, dtype=torch.bfloat16) * 0.8)(F) * 0.01),
            "w2": _w((lambda *s: torch.randn(*s, dtype=torch.bfloat16) * 0.8)(F, D) * (F ** -0.5)),
            "b2": _w((lambda *s: torch.randn(*s, dtype=torch.bfloat16) * 0.8)(D) * 0.01),
        }
    _B_in = _B_setup()

    return {
        "A_x": _A_in["x"],
        "A_wqkv": _A_in["wqkv"],
        "A_wo": _A_in["wo"],
        "B_x": _B_in["x"],
        "B_w1": _B_in["w1"],
        "B_b1": _B_in["b1"],
        "B_w2": _B_in["w2"],
        "B_b2": _B_in["b2"],
    }

def reference(A_x, A_wqkv, A_wo, B_x, B_w1, B_b1, B_w2, B_b2):
    def _A_ref(x, wqkv, wo):
        B, S, D = x.shape
        H = 32; Dh = D // H; W = 256
        qkv = (lambda x, *d: x.permute(*d))((x @ wqkv).reshape(B, S, 3, H, Dh), 2, 0, 3, 1, 4)
        q, k, v = qkv[0], qkv[1], qkv[2]
        scores = torch.einsum("bhqd,bhkd->bhqk", q, k) * (Dh ** -0.5)
        idx = torch.arange(S)
        mask = (idx[:, None] - idx[None, :] >= 0) & (idx[:, None] - idx[None, :] < W)
        scores = torch.where(mask[None, None], scores, -1e9)
        p = _softmax(scores, axis=-1)
        o = torch.einsum("bhqk,bhkd->bhqd", p, v)
        return (lambda x, *d: x.permute(*d))(o, 0, 2, 1, 3).reshape(B, S, D) @ wo

    def _B_ref(x, w1, b1, w2, b2):
        h = torch.einsum("bsd,df->bsf", x, w1) + b1
        h = _gelu(h)
        return torch.einsum("bsf,fd->bsd", h, w2) + b2

    x = A_x
    x = x + _A_ref(_layernorm(x, axis=-1), A_wqkv, A_wo)
    x = x + _B_ref(_layernorm(x, axis=-1), B_w1, B_b1, B_w2, B_b2)
    x = x + _A_ref(_layernorm(x, axis=-1), A_wqkv, A_wo)
    x = x + _B_ref(_layernorm(x, axis=-1), B_w1, B_b1, B_w2, B_b2)
    return x
```

```asm
; @launch grid=(256,1,1) block=(256,1,1) lds=163840
.amdgcn_target "amdgcn-amd-amdhsa--gfx950"
.text
.globl interleave_layers__sliding_block__dense_activation_gelu__prompt_kernel
.p2align 8
.type interleave_layers__sliding_block__dense_activation_gelu__prompt_kernel,@function
interleave_layers__sliding_block__dense_activation_gelu__prompt_kernel:
    s_cmp_ge_u32 s2, 256
    s_cbranch_scc1 L_end
    s_load_dwordx16 s[64:79], s[0:1], 0
    s_load_dwordx4 s[80:83], s[0:1], 64
    s_load_dwordx2 s[84:85], s[0:1], 80
    s_getpc_b64 s[4:5]
L_pc0:
    v_lshrrev_b32 v1, 6, v0
    v_and_b32 v207, 63, v0
    s_lshr_b32 s3, s2, 3
    s_lshl_b32 s3, s3, 11
    v_lshlrev_b32 v2, 9, v1
    v_lshl_add_u32 v2, v207, 7, v2
    v_add_u32 v2, s3, v2
    v_min_u32 v2, L_code_end-L_pc0-4, v2
    v_mov_b32 v5, s5
    v_add_co_u32 v4, vcc, s4, v2
    s_nop 1
    v_addc_co_u32 v5, vcc, 0, v5, vcc
    s_mov_b64 exec, 15
    global_load_dword v211, v[4:5], off
    s_mov_b64 exec, -1
    v_readfirstlane_b32 s48, v1
    s_and_b32 s3, s2, 7
    s_lshr_b32 s4, s2, 3
    s_xor_b32 s4, s4, 0
    s_lshr_b32 s5, s4, 4
    s_lshl_b32 s6, s3, 1
    s_add_u32 s5, s6, s5
    s_and_b32 s6, s4, 15
    s_xor_b32 s6, s6, 8
    s_lshr_b32 s7, s3, 0
    s_lshl_b32 s7, s7, 1
    s_lshr_b32 s49, s4, 4
    s_add_u32 s49, s49, s7
    s_and_b32 s7, s3, 0
    s_lshl_b32 s7, s7, 4
    s_and_b32 s50, s4, 15
    s_add_u32 s50, s50, s7
    v_lshlrev_b32 v206, 4, v207
    v_lshlrev_b32 v213, 2, v207
    s_mov_b32 s53, 0
    s_mov_b32 s58, 0
    s_lshl_b32 s3, s49, 2
    s_add_u32 s54, s3, s48
    s_lshl_b32 s3, s5, 2
    s_and_b32 s4, s6, 1
    s_lshl_b32 s4, s4, 1
    s_add_u32 s3, s3, s4
    s_and_b32 s57, s48, 1
    s_add_u32 s55, s3, s57
    s_lshr_b32 s3, s6, 1
    s_lshl_b32 s63, s3, 7
    s_lshl_b32 s3, s3, 2
    s_lshr_b32 s4, s48, 1
    s_lshl_b32 s4, s4, 1
    s_add_u32 s56, s3, s4
    s_lshl_b32 s3, s49, 4
    s_add_u32 s3, s3, s50
    s_lshl_b32 s59, s3, 11
    s_add_u32 s59, s59, 32768
    s_lshl_b32 s60, s3, 4
    s_lshl_b32 s61, s49, 8
    s_add_u32 s61, s61, 4096
    s_lshl_b32 s45, s5, 8
    s_lshl_b32 s6, s6, 4
    s_add_u32 s44, s45, s6
    s_add_u32 s44, s44, 4096
    v_lshrrev_b32 v2, 3, v207
    v_and_b32 v3, 7, v207
    v_lshrrev_b32 v4, 1, v2
    v_xor_b32 v3, v3, v4
    v_lshlrev_b32 v2, 10, v2
    v_lshl_add_u32 v216, v3, 4, v2
    v_xor_b32 v217, 64, v216
    v_add_u32 v217, 7168, v217
    v_add_u32 v218, 14336, v216
    v_add_u32 v219, 14336, v217
    s_mul_i32 s96, s48, 49152
    s_lshl_b32 s3, s50, 6
    s_add_u32 s96, s96, s3
    s_mul_i32 s97, s48, 3072
    s_lshl_b32 s98, s54, 15
    s_lshl_b32 s99, s48, 14
    s_add_u32 s99, s99, 98304
    s_and_b32 s100, s2, 7
    s_waitcnt lgkmcnt(0)
    s_mov_b32 s28, s64
    s_mov_b32 s29, s65
    s_mov_b32 s30, 0x200000
    s_mov_b32 s31, 0x00020000
    s_add_u32 s4, s100, 0
    s_and_b32 s4, s4, 7
    s_lshl_b32 s4, s4, 7
    s_add_u32 s3, s98, s4
    s_add_u32 m0, s99, 0
    s_nop 0
    buffer_load_dwordx4 v216, s[28:31], s3 offen offset:0 lds
    buffer_load_dwordx4 v217, s[28:31], s3 offen offset:1024 lds
    buffer_load_dwordx4 v218, s[28:31], s3 offen offset:2048 lds
    buffer_load_dwordx4 v219, s[28:31], s3 offen offset:3072 lds
    s_mov_b32 s12, s66
    s_mov_b32 s13, s67
    s_mov_b32 s14, 0x180000
    s_mov_b32 s15, 0x00020000
    v_add_u32 v2, 0, v207
    v_mul_u32_u24 v193, 5462, v2
    v_lshrrev_b32 v193, 16, v193
    v_mul_u32_u24 v3, 12, v193
    v_sub_u32 v2, v2, v3
    v_mul_u32_u24 v193, 3072, v193
    v_lshrrev_b32 v3, 2, v2
    v_add_u32 v3, 1, v3
    v_cmp_eq_u32 vcc, 3, v3
    s_nop 1
    v_cndmask_b32 v3, v3, 0, vcc
    v_lshl_add_u32 v193, v3, 10, v193
    v_and_b32 v2, 3, v2
    v_lshl_add_u32 v193, v2, 4, v193
    v_add_u32 v193, 0, v193
    v_add_u32 v2, 64, v207
    v_mul_u32_u24 v194, 5462, v2
    v_lshrrev_b32 v194, 16, v194
    v_mul_u32_u24 v3, 12, v194
    v_sub_u32 v2, v2, v3
    v_mul_u32_u24 v194, 3072, v194
    v_lshrrev_b32 v3, 2, v2
    v_add_u32 v3, 1, v3
    v_cmp_eq_u32 vcc, 3, v3
    s_nop 1
    v_cndmask_b32 v3, v3, 0, vcc
    v_lshl_add_u32 v194, v3, 10, v194
    v_and_b32 v2, 3, v2
    v_lshl_add_u32 v194, v2, 4, v194
    v_add_u32 v194, 4294966272, v194
    v_add_u32 v2, 128, v207
    v_mul_u32_u24 v195, 5462, v2
    v_lshrrev_b32 v195, 16, v195
    v_mul_u32_u24 v3, 12, v195
    v_sub_u32 v2, v2, v3
    v_mul_u32_u24 v195, 3072, v195
    v_lshrrev_b32 v3, 2, v2
    v_add_u32 v3, 1, v3
    v_cmp_eq_u32 vcc, 3, v3
    s_nop 1
    v_cndmask_b32 v3, v3, 0, vcc
    v_lshl_add_u32 v195, v3, 10, v195
    v_and_b32 v2, 3, v2
    v_lshl_add_u32 v195, v2, 4, v195
    v_add_u32 v195, 4294965248, v195
    s_add_u32 s4, s100, 0
    s_and_b32 s4, s4, 7
    s_mul_i32 s4, s4, 196608
    s_add_u32 s3, s96, s4
    s_add_u32 m0, s97, 0
    s_nop 0
    buffer_load_dwordx4 v193, s[12:15], s3 offen offset:0 lds
    buffer_load_dwordx4 v194, s[12:15], s3 offen offset:1024 lds
    buffer_load_dwordx4 v195, s[12:15], s3 offen offset:2048 lds
    v_lshlrev_b32 v2, 7, v207
    s_lshl_b32 s3, s49, 17
    s_lshl_b32 s4, s50, 13
    s_add_u32 s3, s3, s4
    s_lshl_b32 s4, s48, 11
    s_add_u32 s3, s3, s4
    s_mov_b64 exec, 0xffff
    buffer_load_dword v211, v2, s[28:31], s3 offen
    s_mov_b64 exec, -1
    s_mov_b32 s8, s84
    s_mov_b32 s9, s85
    s_mov_b32 s10, 0x10000000
    s_mov_b32 s11, 0x00020000
    s_mov_b32 s16, s68
    s_mov_b32 s17, s69
    s_mov_b32 s18, 0x80000
    s_mov_b32 s19, 0x00020000
    s_mov_b32 s20, s72
    s_mov_b32 s21, s73
    s_mov_b32 s22, 0x1c0000
    s_mov_b32 s23, 0x00020000
    s_mov_b32 s24, s76
    s_mov_b32 s25, s77
    s_mov_b32 s26, 0x1c0000
    s_mov_b32 s27, 0x00020000
    s_lshr_b32 s4, s48, 1
    s_add_u32 s4, s4, s49
    s_sub_i32 s4, s4, 2
    s_max_i32 s4, s4, 0
    s_lshl_b32 s4, s4, 7
    s_lshl_b32 s5, s49, 7
    v_mov_b32 v3, s5
    v_writelane_b32 v3, s4, 1
    s_mov_b32 s4, 8192
    buffer_load_dword v204, v3, s[8:11], s4 offen sc1
    s_add_u32 s4, s100, 1
    s_and_b32 s4, s4, 7
    s_lshl_b32 s4, s4, 7
    s_add_u32 s3, s98, s4
    s_add_u32 m0, s99, 4096
    s_nop 0
    buffer_load_dwordx4 v216, s[28:31], s3 offen offset:0 lds
    buffer_load_dwordx4 v217, s[28:31], s3 offen offset:1024 lds
    buffer_load_dwordx4 v218, s[28:31], s3 offen offset:2048 lds
    buffer_load_dwordx4 v219, s[28:31], s3 offen offset:3072 lds
    s_add_u32 s4, s100, 1
    s_and_b32 s4, s4, 7
    s_mul_i32 s4, s4, 196608
    s_add_u32 s3, s96, s4
    s_add_u32 m0, s97, 12288
    s_nop 0
    buffer_load_dwordx4 v193, s[12:15], s3 offen offset:0 lds
    buffer_load_dwordx4 v194, s[12:15], s3 offen offset:1024 lds
    buffer_load_dwordx4 v195, s[12:15], s3 offen offset:2048 lds
    s_mov_b32 s34, s80
    s_mov_b32 s35, s81
    s_mov_b32 s32, 0
    s_mov_b32 s33, 0
    s_mov_b32 s36, s74
    s_mov_b32 s37, s75
    s_mov_b32 s38, 0xe00
    s_mov_b32 s39, 0x00020000
    s_mov_b32 s40, s78
    s_mov_b32 s41, s79
    s_mov_b32 s42, 0x400
    s_mov_b32 s43, 0x00020000
    v_lshrrev_b32 v5, 4, v207
    v_and_b32 v6, 15, v207
    v_lshrrev_b32 v7, 2, v6
    v_and_b32 v8, 3, v6
    v_lshrrev_b32 v9, 1, v5
    v_and_b32 v10, 1, v5
    v_lshl_add_u32 v11, v9, 2, v7
    v_mul_u32_u24 v11, 192, v11
    v_lshl_add_u32 v11, v10, 5, v11
    v_lshl_add_u32 v208, v8, 3, v11
    v_lshlrev_b32 v11, 7, v207
    v_mov_b32 v12, 0x7fffff00
    v_cmp_gt_u32 vcc, 8, v207
    s_nop 1
    v_cndmask_b32 v209, v12, v11, vcc
    v_lshlrev_b32 v11, 4, v9
    v_lshl_add_u32 v11, v10, 2, v11
    v_add_u32 v11, v11, v7
    v_mul_u32_u24 v11, 224, v11
    v_lshl_add_u32 v210, v8, 3, v11
    v_lshlrev_b32 v11, 9, v5
    v_lshl_add_u32 v212, v6, 4, v11
    v_lshrrev_b32 v11, 1, v7
    s_lshr_b32 s3, s48, 1
    v_xor_b32 v11, s3, v11
    v_lshlrev_b32 v11, 6, v11
    v_lshl_add_u32 v11, v10, 5, v11
    v_lshl_add_u32 v11, v8, 3, v11
    v_lshl_add_u32 v12, v9, 3, v7
    v_lshl_add_u32 v215, v12, 7, v11
    v_lshrrev_b32 v11, 3, v207
    v_and_b32 v12, 7, v207
    v_lshlrev_b32 v13, 2, v10
    v_xor_b32 v12, v12, v13
    v_lshlrev_b32 v11, 10, v11
    v_lshl_add_u32 v214, v12, 4, v11
    v_and_b32 v12, 31, v207
    v_lshlrev_b32 v13, 2, v9
    v_add_u32 v14, 0, v13
    v_cmp_le_u32 s[64:65], v14, v12
    v_add_u32 v14, 1, v13
    v_cmp_le_u32 s[66:67], v14, v12
    v_add_u32 v14, 2, v13
    v_cmp_le_u32 s[68:69], v14, v12
    v_add_u32 v14, 3, v13
    v_cmp_le_u32 s[70:71], v14, v12
    v_add_u32 v14, 8, v13
    v_cmp_le_u32 s[72:73], v14, v12
    v_add_u32 v14, 9, v13
    v_cmp_le_u32 s[74:75], v14, v12
    v_add_u32 v14, 10, v13
    v_cmp_le_u32 s[76:77], v14, v12
    v_add_u32 v14, 11, v13
    v_cmp_le_u32 s[78:79], v14, v12
    v_add_u32 v14, 16, v13
    v_cmp_le_u32 s[80:81], v14, v12
    v_add_u32 v14, 17, v13
    v_cmp_le_u32 s[82:83], v14, v12
    v_add_u32 v14, 18, v13
    v_cmp_le_u32 s[84:85], v14, v12
    v_add_u32 v14, 19, v13
    v_cmp_le_u32 s[86:87], v14, v12
    v_add_u32 v14, 24, v13
    v_cmp_le_u32 s[88:89], v14, v12
    v_add_u32 v14, 25, v13
    v_cmp_le_u32 s[90:91], v14, v12
    v_add_u32 v14, 26, v13
    v_cmp_le_u32 s[92:93], v14, v12
    v_add_u32 v14, 27, v13
    v_cmp_le_u32 s[94:95], v14, v12
    v_lshlrev_b32 v14, 7, v12
    v_bfe_u32 v15, v12, 1, 3
    v_lshl_add_u32 v14, v15, 4, v14
    v_lshl_add_u32 v14, v9, 3, v14
    v_add_u32 v224, s99, v14
    s_cmp_eq_u32 s48, 3
    s_cselect_b32 s3, 0, s48
    s_lshl_b32 s62, s3, 6
    v_add_u32 v192, 49152, v208
    v_cmp_eq_u32 vcc, v6, v10
    v_mov_b32 v14, 0x3f803f80
    v_add_u32 v236, s62, v208
    v_add_u32 v237, s62, v192
    v_cndmask_b32 v232, 0, v14, vcc
    v_mov_b32 v184, 0
    v_mov_b32 v185, 0
    v_mov_b32 v233, v232
    v_mov_b32 v234, v232
    v_mov_b32 v235, v232
    v_xor_b32 v225, 16, v224
    v_xor_b32 v226, 32, v224
    v_xor_b32 v227, 48, v224
    v_xor_b32 v228, 64, v224
    v_xor_b32 v229, 80, v224
    v_xor_b32 v230, 96, v224
    v_xor_b32 v231, 112, v224
    s_waitcnt vmcnt(9)
    s_barrier
    ds_read_b64 v[0:1], v224 offset:0
    ds_read_b64 v[2:3], v225 offset:0
    ds_read_b64_tr_b16 v[160:161], v208 offset:0
    ds_read_b64_tr_b16 v[162:163], v208 offset:1536
    ds_read_b64_tr_b16 v[164:165], v208 offset:64
    ds_read_b64_tr_b16 v[166:167], v208 offset:1600
    ds_read_b64_tr_b16 v[196:197], v236 offset:0
    ds_read_b64_tr_b16 v[198:199], v236 offset:1536
    s_waitcnt lgkmcnt(0)
    v_mfma_f32_32x32x16_bf16 v[128:143], v[160:163], v[0:3], 0
    ds_read_b64 v[4:5], v226 offset:0
    ds_read_b64 v[6:7], v227 offset:0
    ds_read_b64_tr_b16 v[168:169], v208 offset:3072
    ds_read_b64_tr_b16 v[170:171], v208 offset:4608
    ds_read_b64_tr_b16 v[172:173], v208 offset:3136
    v_mfma_f32_32x32x16_bf16 v[144:159], v[0:3], v[164:167], 0
    ds_read_b64_tr_b16 v[174:175], v208 offset:4672
    ds_read_b64_tr_b16 v[200:201], v236 offset:3072
    ds_read_b64_tr_b16 v[202:203], v236 offset:4608
    s_add_u32 s4, s100, 2
    s_and_b32 s4, s4, 7
    s_lshl_b32 s4, s4, 7
    s_add_u32 s3, s98, s4
    s_add_u32 m0, s99, 8192
    s_nop 0
    buffer_load_dwordx4 v216, s[28:31], s3 offen offset:0 lds
    buffer_load_dwordx4 v217, s[28:31], s3 offen offset:1024 lds
    buffer_load_dwordx4 v218, s[28:31], s3 offen offset:2048 lds
    v_mfma_f32_16x16x32_bf16 v[176:179], v[232:235], v[196:199], 0
    v_mfma_f32_16x16x32_bf16 v[180:183], v[232:235], v[0:3], 0
    v_dot2_f32_bf16 v184, v0, v0, v184
    v_dot2_f32_bf16 v185, v1, v1, v185
    v_dot2_f32_bf16 v184, v2, v2, v184
    v_dot2_f32_bf16 v185, v3, v3, v185
    s_waitcnt lgkmcnt(0)
    v_mfma_f32_32x32x16_bf16 v[128:143], v[168:171], v[4:7], v[128:143]
    ds_read_b64 v[8:9], v228 offset:0
    ds_read_b64 v[10:11], v229 offset:0
    ds_read_b64_tr_b16 v[160:161], v208 offset:6144
    ds_read_b64_tr_b16 v[162:163], v208 offset:7680
    ds_read_b64_tr_b16 v[164:165], v208 offset:6208
    v_mfma_f32_32x32x16_bf16 v[144:159], v[4:7], v[172:175], v[144:159]
    ds_read_b64_tr_b16 v[166:167], v208 offset:7744
    ds_read_b64_tr_b16 v[196:197], v236 offset:6144
    ds_read_b64_tr_b16 v[198:199], v236 offset:7680
    buffer_load_dwordx4 v219, s[28:31], s3 offen offset:3072 lds
    s_add_u32 s4, s100, 2
    s_and_b32 s4, s4, 7
    s_mul_i32 s4, s4, 196608
    s_add_u32 s3, s96, s4
    s_add_u32 m0, s97, 24576
    s_nop 0
    buffer_load_dwordx4 v193, s[12:15], s3 offen offset:0 lds
    v_mfma_f32_16x16x32_bf16 v[176:179], v[232:235], v[200:203], v[176:179]
    v_mfma_f32_16x16x32_bf16 v[180:183], v[232:235], v[4:7], v[180:183]
    v_dot2_f32_bf16 v184, v4, v4, v184
    v_dot2_f32_bf16 v185, v5, v5, v185
    v_dot2_f32_bf16 v184, v6, v6, v184
    v_dot2_f32_bf16 v185, v7, v7, v185
    s_waitcnt lgkmcnt(0)
    v_mfma_f32_32x32x16_bf16 v[128:143], v[160:163], v[8:11], v[128:143]
    ds_read_b64 v[12:13], v230 offset:0
    ds_read_b64 v[14:15], v231 offset:0
    ds_read_b64_tr_b16 v[168:169], v208 offset:9216
    ds_read_b64_tr_b16 v[170:171], v208 offset:10752
    ds_read_b64_tr_b16 v[172:173], v208 offset:9280
    v_mfma_f32_32x32x16_bf16 v[144:159], v[8:11], v[164:167], v[144:159]
    ds_read_b64_tr_b16 v[174:175], v208 offset:10816
    ds_read_b64_tr_b16 v[200:201], v236 offset:9216
    ds_read_b64_tr_b16 v[202:203], v236 offset:10752
    buffer_load_dwordx4 v194, s[12:15], s3 offen offset:1024 lds
    buffer_load_dwordx4 v195, s[12:15], s3 offen offset:2048 lds
    v_mfma_f32_16x16x32_bf16 v[176:179], v[232:235], v[196:199], v[176:179]
    v_mfma_f32_16x16x32_bf16 v[180:183], v[232:235], v[8:11], v[180:183]
    v_dot2_f32_bf16 v184, v8, v8, v184
    v_dot2_f32_bf16 v185, v9, v9, v185
    v_dot2_f32_bf16 v184, v10, v10, v184
    v_dot2_f32_bf16 v185, v11, v11, v185
    s_waitcnt lgkmcnt(0)
    v_mfma_f32_32x32x16_bf16 v[128:143], v[168:171], v[12:15], v[128:143]
    s_waitcnt vmcnt(7)
    s_barrier
    ds_read_b64 v[16:17], v224 offset:4096
    ds_read_b64 v[18:19], v225 offset:4096
    ds_read_b64_tr_b16 v[160:161], v208 offset:12288
    ds_read_b64_tr_b16 v[162:163], v208 offset:13824
    ds_read_b64_tr_b16 v[164:165], v208 offset:12352
    v_mfma_f32_32x32x16_bf16 v[144:159], v[12:15], v[172:175], v[144:159]
    ds_read_b64_tr_b16 v[166:167], v208 offset:13888
    ds_read_b64_tr_b16 v[196:197], v236 offset:12288
    ds_read_b64_tr_b16 v[198:199], v236 offset:13824
    v_mfma_f32_16x16x32_bf16 v[176:179], v[232:235], v[200:203], v[176:179]
    v_mfma_f32_16x16x32_bf16 v[180:183], v[232:235], v[12:15], v[180:183]
    v_dot2_f32_bf16 v184, v12, v12, v184
    v_dot2_f32_bf16 v185, v13, v13, v185
    v_dot2_f32_bf16 v184, v14, v14, v184
    v_dot2_f32_bf16 v185, v15, v15, v185
    s_waitcnt lgkmcnt(0)
    v_mfma_f32_32x32x16_bf16 v[128:143], v[160:163], v[16:19], v[128:143]
    ds_read_b64 v[20:21], v226 offset:4096
    ds_read_b64 v[22:23], v227 offset:4096
    ds_read_b64_tr_b16 v[168:169], v208 offset:15360
    ds_read_b64_tr_b16 v[170:171], v208 offset:16896
    ds_read_b64_tr_b16 v[172:173], v208 offset:15424
    v_mfma_f32_32x32x16_bf16 v[144:159], v[16:19], v[164:167], v[144:159]
    ds_read_b64_tr_b16 v[174:175], v208 offset:16960
    ds_read_b64_tr_b16 v[200:201], v236 offset:15360
    ds_read_b64_tr_b16 v[202:203], v236 offset:16896
    s_add_u32 s4, s100, 3
    s_and_b32 s4, s4, 7
    s_lshl_b32 s4, s4, 7
    s_add_u32 s3, s98, s4
    s_add_u32 m0, s99, 12288
    s_nop 0
    buffer_load_dwordx4 v216, s[28:31], s3 offen offset:0 lds
    buffer_load_dwordx4 v217, s[28:31], s3 offen offset:1024 lds
    buffer_load_dwordx4 v218, s[28:31], s3 offen offset:2048 lds
    v_mfma_f32_16x16x32_bf16 v[176:179], v[232:235], v[196:199], v[176:179]
    v_mfma_f32_16x16x32_bf16 v[180:183], v[232:235], v[16:19], v[180:183]
    v_dot2_f32_bf16 v184, v16, v16, v184
    v_dot2_f32_bf16 v185, v17, v17, v185
    v_dot2_f32_bf16 v184, v18, v18, v184
    v_dot2_f32_bf16 v185, v19, v19, v185
    s_waitcnt lgkmcnt(0)
    v_mfma_f32_32x32x16_bf16 v[128:143], v[168:171], v[20:23], v[128:143]
    ds_read_b64 v[24:25], v228 offset:4096
    ds_read_b64 v[26:27], v229 offset:4096
    ds_read_b64_tr_b16 v[160:161], v208 offset:18432
    ds_read_b64_tr_b16 v[162:163], v208 offset:19968
    ds_read_b64_tr_b16 v[164:165], v208 offset:18496
    v_mfma_f32_32x32x16_bf16 v[144:159], v[20:23], v[172:175], v[144:159]
    ds_read_b64_tr_b16 v[166:167], v208 offset:20032
    ds_read_b64_tr_b16 v[196:197], v236 offset:18432
    ds_read_b64_tr_b16 v[198:199], v236 offset:19968
    buffer_load_dwordx4 v219, s[28:31], s3 offen offset:3072 lds
    s_add_u32 s4, s100, 3
    s_and_b32 s4, s4, 7
    s_mul_i32 s4, s4, 196608
    s_add_u32 s3, s96, s4
    s_add_u32 m0, s97, 36864
    s_nop 0
    buffer_load_dwordx4 v193, s[12:15], s3 offen offset:0 lds
    v_mfma_f32_16x16x32_bf16 v[176:179], v[232:235], v[200:203], v[176:179]
    v_mfma_f32_16x16x32_bf16 v[180:183], v[232:235], v[20:23], v[180:183]
    v_dot2_f32_bf16 v184, v20, v20, v184
    v_dot2_f32_bf16 v185, v21, v21, v185
    v_dot2_f32_bf16 v184, v22, v22, v184
    v_dot2_f32_bf16 v185, v23, v23, v185
    s_waitcnt lgkmcnt(0)
    v_mfma_f32_32x32x16_bf16 v[128:143], v[160:163], v[24:27], v[128:143]
    ds_read_b64 v[28:29], v230 offset:4096
    ds_read_b64 v[30:31], v231 offset:4096
    ds_read_b64_tr_b16 v[168:169], v208 offset:21504
    ds_read_b64_tr_b16 v[170:171], v208 offset:23040
    ds_read_b64_tr_b16 v[172:173], v208 offset:21568
    v_mfma_f32_32x32x16_bf16 v[144:159], v[24:27], v[164:167], v[144:159]
    ds_read_b64_tr_b16 v[174:175], v208 offset:23104
    ds_read_b64_tr_b16 v[200:201], v236 offset:21504
    ds_read_b64_tr_b16 v[202:203], v236 offset:23040
    buffer_load_dwordx4 v194, s[12:15], s3 offen offset:1024 lds
    buffer_load_dwordx4 v195, s[12:15], s3 offen offset:2048 lds
    v_mfma_f32_16x16x32_bf16 v[176:179], v[232:235], v[196:199], v[176:179]
    v_mfma_f32_16x16x32_bf16 v[180:183], v[232:235], v[24:27], v[180:183]
    v_dot2_f32_bf16 v184, v24, v24, v184
    v_dot2_f32_bf16 v185, v25, v25, v185
    v_dot2_f32_bf16 v184, v26, v26, v184
    v_dot2_f32_bf16 v185, v27, v27, v185
    s_waitcnt lgkmcnt(0)
    v_mfma_f32_32x32x16_bf16 v[128:143], v[168:171], v[28:31], v[128:143]
    s_waitcnt vmcnt(7)
    s_barrier
    ds_read_b64 v[32:33], v224 offset:8192
    ds_read_b64 v[34:35], v225 offset:8192
    ds_read_b64_tr_b16 v[160:161], v208 offset:24576
    ds_read_b64_tr_b16 v[162:163], v208 offset:26112
    ds_read_b64_tr_b16 v[164:165], v208 offset:24640
    v_mfma_f32_32x32x16_bf16 v[144:159], v[28:31], v[172:175], v[144:159]
    ds_read_b64_tr_b16 v[166:167], v208 offset:26176
    ds_read_b64_tr_b16 v[196:197], v236 offset:24576
    ds_read_b64_tr_b16 v[198:199], v236 offset:26112
    v_mfma_f32_16x16x32_bf16 v[176:179], v[232:235], v[200:203], v[176:179]
    v_mfma_f32_16x16x32_bf16 v[180:183], v[232:235], v[28:31], v[180:183]
    v_dot2_f32_bf16 v184, v28, v28, v184
    v_dot2_f32_bf16 v185, v29, v29, v185
    v_dot2_f32_bf16 v184, v30, v30, v184
    v_dot2_f32_bf16 v185, v31, v31, v185
    s_waitcnt lgkmcnt(0)
    v_mfma_f32_32x32x16_bf16 v[128:143], v[160:163], v[32:35], v[128:143]
    ds_read_b64 v[36:37], v226 offset:8192
    ds_read_b64 v[38:39], v227 offset:8192
    ds_read_b64_tr_b16 v[168:169], v208 offset:27648
    ds_read_b64_tr_b16 v[170:171], v208 offset:29184
    ds_read_b64_tr_b16 v[172:173], v208 offset:27712
    v_mfma_f32_32x32x16_bf16 v[144:159], v[32:35], v[164:167], v[144:159]
    ds_read_b64_tr_b16 v[174:175], v208 offset:29248
    ds_read_b64_tr_b16 v[200:201], v236 offset:27648
    ds_read_b64_tr_b16 v[202:203], v236 offset:29184
    s_add_u32 s4, s100, 4
    s_and_b32 s4, s4, 7
    s_lshl_b32 s4, s4, 7
    s_add_u32 s3, s98, s4
    s_add_u32 m0, s99, 0
    s_nop 0
    buffer_load_dwordx4 v216, s[28:31], s3 offen offset:0 lds
    buffer_load_dwordx4 v217, s[28:31], s3 offen offset:1024 lds
    buffer_load_dwordx4 v218, s[28:31], s3 offen offset:2048 lds
    v_mfma_f32_16x16x32_bf16 v[176:179], v[232:235], v[196:199], v[176:179]
    v_mfma_f32_16x16x32_bf16 v[180:183], v[232:235], v[32:35], v[180:183]
    v_dot2_f32_bf16 v184, v32, v32, v184
    v_dot2_f32_bf16 v185, v33, v33, v185
    v_dot2_f32_bf16 v184, v34, v34, v184
    v_dot2_f32_bf16 v185, v35, v35, v185
    s_waitcnt lgkmcnt(0)
    v_mfma_f32_32x32x16_bf16 v[128:143], v[168:171], v[36:39], v[128:143]
    ds_read_b64 v[40:41], v228 offset:8192
    ds_read_b64 v[42:43], v229 offset:8192
    ds_read_b64_tr_b16 v[160:161], v208 offset:30720
    ds_read_b64_tr_b16 v[162:163], v208 offset:32256
    ds_read_b64_tr_b16 v[164:165], v208 offset:30784
    v_mfma_f32_32x32x16_bf16 v[144:159], v[36:39], v[172:175], v[144:159]
    ds_read_b64_tr_b16 v[166:167], v208 offset:32320
    ds_read_b64_tr_b16 v[196:197], v236 offset:30720
    ds_read_b64_tr_b16 v[198:199], v236 offset:32256
    buffer_load_dwordx4 v219, s[28:31], s3 offen offset:3072 lds
    s_add_u32 s4, s100, 4
    s_and_b32 s4, s4, 7
    s_mul_i32 s4, s4, 196608
    s_add_u32 s3, s96, s4
    s_add_u32 m0, s97, 49152
    s_nop 0
    buffer_load_dwordx4 v193, s[12:15], s3 offen offset:0 lds
    v_mfma_f32_16x16x32_bf16 v[176:179], v[232:235], v[200:203], v[176:179]
    v_mfma_f32_16x16x32_bf16 v[180:183], v[232:235], v[36:39], v[180:183]
    v_dot2_f32_bf16 v184, v36, v36, v184
    v_dot2_f32_bf16 v185, v37, v37, v185
    v_dot2_f32_bf16 v184, v38, v38, v184
    v_dot2_f32_bf16 v185, v39, v39, v185
    s_waitcnt lgkmcnt(0)
    v_mfma_f32_32x32x16_bf16 v[128:143], v[160:163], v[40:43], v[128:143]
    ds_read_b64 v[44:45], v230 offset:8192
    ds_read_b64 v[46:47], v231 offset:8192
    ds_read_b64_tr_b16 v[168:169], v208 offset:33792
    ds_read_b64_tr_b16 v[170:171], v208 offset:35328
    ds_read_b64_tr_b16 v[172:173], v208 offset:33856
    v_mfma_f32_32x32x16_bf16 v[144:159], v[40:43], v[164:167], v[144:159]
    ds_read_b64_tr_b16 v[174:175], v208 offset:35392
    ds_read_b64_tr_b16 v[200:201], v236 offset:33792
    ds_read_b64_tr_b16 v[202:203], v236 offset:35328
    buffer_load_dwordx4 v194, s[12:15], s3 offen offset:1024 lds
    buffer_load_dwordx4 v195, s[12:15], s3 offen offset:2048 lds
    v_mfma_f32_16x16x32_bf16 v[176:179], v[232:235], v[196:199], v[176:179]
    v_mfma_f32_16x16x32_bf16 v[180:183], v[232:235], v[40:43], v[180:183]
    v_dot2_f32_bf16 v184, v40, v40, v184
    v_dot2_f32_bf16 v185, v41, v41, v185
    v_dot2_f32_bf16 v184, v42, v42, v184
    v_dot2_f32_bf16 v185, v43, v43, v185
    s_waitcnt lgkmcnt(0)
    v_mfma_f32_32x32x16_bf16 v[128:143], v[168:171], v[44:47], v[128:143]
    s_waitcnt vmcnt(7)
    s_barrier
    ds_read_b64 v[48:49], v224 offset:12288
    ds_read_b64 v[50:51], v225 offset:12288
    ds_read_b64_tr_b16 v[160:161], v208 offset:36864
    ds_read_b64_tr_b16 v[162:163], v208 offset:38400
    ds_read_b64_tr_b16 v[164:165], v208 offset:36928
    v_mfma_f32_32x32x16_bf16 v[144:159], v[44:47], v[172:175], v[144:159]
    ds_read_b64_tr_b16 v[166:167], v208 offset:38464
    ds_read_b64_tr_b16 v[196:197], v236 offset:36864
    ds_read_b64_tr_b16 v[198:199], v236 offset:38400
    v_mfma_f32_16x16x32_bf16 v[176:179], v[232:235], v[200:203], v[176:179]
    v_mfma_f32_16x16x32_bf16 v[180:183], v[232:235], v[44:47], v[180:183]
    v_dot2_f32_bf16 v184, v44, v44, v184
    v_dot2_f32_bf16 v185, v45, v45, v185
    v_dot2_f32_bf16 v184, v46, v46, v184
    v_dot2_f32_bf16 v185, v47, v47, v185
    s_waitcnt lgkmcnt(0)
    v_mfma_f32_32x32x16_bf16 v[128:143], v[160:163], v[48:51], v[128:143]
    ds_read_b64 v[52:53], v226 offset:12288
    ds_read_b64 v[54:55], v227 offset:12288
    ds_read_b64_tr_b16 v[168:169], v208 offset:39936
    ds_read_b64_tr_b16 v[170:171], v208 offset:41472
    ds_read_b64_tr_b16 v[172:173], v208 offset:40000
    v_mfma_f32_32x32x16_bf16 v[144:159], v[48:51], v[164:167], v[144:159]
    ds_read_b64_tr_b16 v[174:175], v208 offset:41536
    ds_read_b64_tr_b16 v[200:201], v236 offset:39936
    ds_read_b64_tr_b16 v[202:203], v236 offset:41472
    s_add_u32 s4, s100, 5
    s_and_b32 s4, s4, 7
    s_lshl_b32 s4, s4, 7
    s_add_u32 s3, s98, s4
    s_add_u32 m0, s99, 4096
    s_nop 0
    buffer_load_dwordx4 v216, s[28:31], s3 offen offset:0 lds
    buffer_load_dwordx4 v217, s[28:31], s3 offen offset:1024 lds
    buffer_load_dwordx4 v218, s[28:31], s3 offen offset:2048 lds
    v_mfma_f32_16x16x32_bf16 v[176:179], v[232:235], v[196:199], v[176:179]
    v_mfma_f32_16x16x32_bf16 v[180:183], v[232:235], v[48:51], v[180:183]
    v_dot2_f32_bf16 v184, v48, v48, v184
    v_dot2_f32_bf16 v185, v49, v49, v185
    v_dot2_f32_bf16 v184, v50, v50, v184
    v_dot2_f32_bf16 v185, v51, v51, v185
    s_waitcnt lgkmcnt(0)
    v_mfma_f32_32x32x16_bf16 v[128:143], v[168:171], v[52:55], v[128:143]
    ds_read_b64 v[56:57], v228 offset:12288
    ds_read_b64 v[58:59], v229 offset:12288
    ds_read_b64_tr_b16 v[160:161], v208 offset:43008
    ds_read_b64_tr_b16 v[162:163], v208 offset:44544
    ds_read_b64_tr_b16 v[164:165], v208 offset:43072
    v_mfma_f32_32x32x16_bf16 v[144:159], v[52:55], v[172:175], v[144:159]
    ds_read_b64_tr_b16 v[166:167], v208 offset:44608
    ds_read_b64_tr_b16 v[196:197], v236 offset:43008
    ds_read_b64_tr_b16 v[198:199], v236 offset:44544
    buffer_load_dwordx4 v219, s[28:31], s3 offen offset:3072 lds
    s_add_u32 s4, s100, 5
    s_and_b32 s4, s4, 7
    s_mul_i32 s4, s4, 196608
    s_add_u32 s3, s96, s4
    s_add_u32 m0, s97, 61440
    s_nop 0
    buffer_load_dwordx4 v193, s[12:15], s3 offen offset:0 lds
    v_mfma_f32_16x16x32_bf16 v[176:179], v[232:235], v[200:203], v[176:179]
    v_mfma_f32_16x16x32_bf16 v[180:183], v[232:235], v[52:55], v[180:183]
    v_dot2_f32_bf16 v184, v52, v52, v184
    v_dot2_f32_bf16 v185, v53, v53, v185
    v_dot2_f32_bf16 v184, v54, v54, v184
    v_dot2_f32_bf16 v185, v55, v55, v185
    s_waitcnt lgkmcnt(0)
    v_mfma_f32_32x32x16_bf16 v[128:143], v[160:163], v[56:59], v[128:143]
    ds_read_b64 v[60:61], v230 offset:12288
    ds_read_b64 v[62:63], v231 offset:12288
    ds_read_b64_tr_b16 v[168:169], v208 offset:46080
    ds_read_b64_tr_b16 v[170:171], v208 offset:47616
    ds_read_b64_tr_b16 v[172:173], v208 offset:46144
    v_mfma_f32_32x32x16_bf16 v[144:159], v[56:59], v[164:167], v[144:159]
    ds_read_b64_tr_b16 v[174:175], v208 offset:47680
    ds_read_b64_tr_b16 v[200:201], v236 offset:46080
    ds_read_b64_tr_b16 v[202:203], v236 offset:47616
    buffer_load_dwordx4 v194, s[12:15], s3 offen offset:1024 lds
    buffer_load_dwordx4 v195, s[12:15], s3 offen offset:2048 lds
    v_mfma_f32_16x16x32_bf16 v[176:179], v[232:235], v[196:199], v[176:179]
    v_mfma_f32_16x16x32_bf16 v[180:183], v[232:235], v[56:59], v[180:183]
    v_dot2_f32_bf16 v184, v56, v56, v184
    v_dot2_f32_bf16 v185, v57, v57, v185
    v_dot2_f32_bf16 v184, v58, v58, v184
    v_dot2_f32_bf16 v185, v59, v59, v185
    s_waitcnt lgkmcnt(0)
    v_mfma_f32_32x32x16_bf16 v[128:143], v[168:171], v[60:63], v[128:143]
    s_waitcnt vmcnt(7)
    s_barrier
    ds_read_b64 v[64:65], v224 offset:0
    ds_read_b64 v[66:67], v225 offset:0
    ds_read_b64_tr_b16 v[160:161], v192 offset:0
    ds_read_b64_tr_b16 v[162:163], v192 offset:1536
    ds_read_b64_tr_b16 v[164:165], v192 offset:64
    v_mfma_f32_32x32x16_bf16 v[144:159], v[60:63], v[172:175], v[144:159]
    ds_read_b64_tr_b16 v[166:167], v192 offset:1600
    ds_read_b64_tr_b16 v[196:197], v237 offset:0
    ds_read_b64_tr_b16 v[198:199], v237 offset:1536
    v_mfma_f32_16x16x32_bf16 v[176:179], v[232:235], v[200:203], v[176:179]
    v_mfma_f32_16x16x32_bf16 v[180:183], v[232:235], v[60:63], v[180:183]
    v_dot2_f32_bf16 v184, v60, v60, v184
    v_dot2_f32_bf16 v185, v61, v61, v185
    v_dot2_f32_bf16 v184, v62, v62, v184
    v_dot2_f32_bf16 v185, v63, v63, v185
    s_waitcnt lgkmcnt(0)
    v_mfma_f32_32x32x16_bf16 v[128:143], v[160:163], v[64:67], v[128:143]
    ds_read_b64 v[68:69], v226 offset:0
    ds_read_b64 v[70:71], v227 offset:0
    ds_read_b64_tr_b16 v[168:169], v192 offset:3072
    ds_read_b64_tr_b16 v[170:171], v192 offset:4608
    ds_read_b64_tr_b16 v[172:173], v192 offset:3136
    v_mfma_f32_32x32x16_bf16 v[144:159], v[64:67], v[164:167], v[144:159]
    ds_read_b64_tr_b16 v[174:175], v192 offset:4672
    ds_read_b64_tr_b16 v[200:201], v237 offset:3072
    ds_read_b64_tr_b16 v[202:203], v237 offset:4608
    s_add_u32 s4, s100, 6
    s_and_b32 s4, s4, 7
    s_lshl_b32 s4, s4, 7
    s_add_u32 s3, s98, s4
    s_add_u32 m0, s99, 8192
    s_nop 0
    buffer_load_dwordx4 v216, s[28:31], s3 offen offset:0 lds
    buffer_load_dwordx4 v217, s[28:31], s3 offen offset:1024 lds
    buffer_load_dwordx4 v218, s[28:31], s3 offen offset:2048 lds
    v_mfma_f32_16x16x32_bf16 v[176:179], v[232:235], v[196:199], v[176:179]
    v_mfma_f32_16x16x32_bf16 v[180:183], v[232:235], v[64:67], v[180:183]
    v_dot2_f32_bf16 v184, v64, v64, v184
    v_dot2_f32_bf16 v185, v65, v65, v185
    v_dot2_f32_bf16 v184, v66, v66, v184
    v_dot2_f32_bf16 v185, v67, v67, v185
    s_waitcnt lgkmcnt(0)
    v_mfma_f32_32x32x16_bf16 v[128:143], v[168:171], v[68:71], v[128:143]
    ds_read_b64 v[72:73], v228 offset:0
    ds_read_b64 v[74:75], v229 offset:0
    ds_read_b64_tr_b16 v[160:161], v192 offset:6144
    ds_read_b64_tr_b16 v[162:163], v192 offset:7680
    ds_read_b64_tr_b16 v[164:165], v192 offset:6208
    v_mfma_f32_32x32x16_bf16 v[144:159], v[68:71], v[172:175], v[144:159]
    ds_read_b64_tr_b16 v[166:167], v192 offset:7744
    ds_read_b64_tr_b16 v[196:197], v237 offset:6144
    ds_read_b64_tr_b16 v[198:199], v237 offset:7680
    buffer_load_dwordx4 v219, s[28:31], s3 offen offset:3072 lds
    s_add_u32 s4, s100, 6
    s_and_b32 s4, s4, 7
    s_mul_i32 s4, s4, 196608
    s_add_u32 s3, s96, s4
    s_add_u32 m0, s97, 73728
    s_nop 0
    buffer_load_dwordx4 v193, s[12:15], s3 offen offset:0 lds
    v_mfma_f32_16x16x32_bf16 v[176:179], v[232:235], v[200:203], v[176:179]
    v_mfma_f32_16x16x32_bf16 v[180:183], v[232:235], v[68:71], v[180:183]
    v_dot2_f32_bf16 v184, v68, v68, v184
    v_dot2_f32_bf16 v185, v69, v69, v185
    v_dot2_f32_bf16 v184, v70, v70, v184
    v_dot2_f32_bf16 v185, v71, v71, v185
    s_waitcnt lgkmcnt(0)
    v_mfma_f32_32x32x16_bf16 v[128:143], v[160:163], v[72:75], v[128:143]
    ds_read_b64 v[76:77], v230 offset:0
    ds_read_b64 v[78:79], v231 offset:0
    ds_read_b64_tr_b16 v[168:169], v192 offset:9216
    ds_read_b64_tr_b16 v[170:171], v192 offset:10752
    ds_read_b64_tr_b16 v[172:173], v192 offset:9280
    v_mfma_f32_32x32x16_bf16 v[144:159], v[72:75], v[164:167], v[144:159]
    ds_read_b64_tr_b16 v[174:175], v192 offset:10816
    ds_read_b64_tr_b16 v[200:201], v237 offset:9216
    ds_read_b64_tr_b16 v[202:203], v237 offset:10752
    buffer_load_dwordx4 v194, s[12:15], s3 offen offset:1024 lds
    buffer_load_dwordx4 v195, s[12:15], s3 offen offset:2048 lds
    v_mfma_f32_16x16x32_bf16 v[176:179], v[232:235], v[196:199], v[176:179]
    v_mfma_f32_16x16x32_bf16 v[180:183], v[232:235], v[72:75], v[180:183]
    v_dot2_f32_bf16 v184, v72, v72, v184
    v_dot2_f32_bf16 v185, v73, v73, v185
    v_dot2_f32_bf16 v184, v74, v74, v184
    v_dot2_f32_bf16 v185, v75, v75, v185
    s_waitcnt lgkmcnt(0)
    v_mfma_f32_32x32x16_bf16 v[128:143], v[168:171], v[76:79], v[128:143]
    s_waitcnt vmcnt(7)
    s_barrier
    ds_read_b64 v[80:81], v224 offset:4096
    ds_read_b64 v[82:83], v225 offset:4096
    ds_read_b64_tr_b16 v[160:161], v192 offset:12288
    ds_read_b64_tr_b16 v[162:163], v192 offset:13824
    ds_read_b64_tr_b16 v[164:165], v192 offset:12352
    v_mfma_f32_32x32x16_bf16 v[144:159], v[76:79], v[172:175], v[144:159]
    ds_read_b64_tr_b16 v[166:167], v192 offset:13888
    ds_read_b64_tr_b16 v[196:197], v237 offset:12288
    ds_read_b64_tr_b16 v[198:199], v237 offset:13824
    v_mfma_f32_16x16x32_bf16 v[176:179], v[232:235], v[200:203], v[176:179]
    v_mfma_f32_16x16x32_bf16 v[180:183], v[232:235], v[76:79], v[180:183]
    v_dot2_f32_bf16 v184, v76, v76, v184
    v_dot2_f32_bf16 v185, v77, v77, v185
    v_dot2_f32_bf16 v184, v78, v78, v184
    v_dot2_f32_bf16 v185, v79, v79, v185
    s_waitcnt lgkmcnt(0)
    v_mfma_f32_32x32x16_bf16 v[128:143], v[160:163], v[80:83], v[128:143]
    ds_read_b64 v[84:85], v226 offset:4096
    ds_read_b64 v[86:87], v227 offset:4096
    ds_read_b64_tr_b16 v[168:169], v192 offset:15360
    ds_read_b64_tr_b16 v[170:171], v192 offset:16896
    ds_read_b64_tr_b16 v[172:173], v192 offset:15424
    v_mfma_f32_32x32x16_bf16 v[144:159], v[80:83], v[164:167], v[144:159]
    ds_read_b64_tr_b16 v[174:175], v192 offset:16960
    ds_read_b64_tr_b16 v[200:201], v237 offset:15360
    ds_read_b64_tr_b16 v[202:203], v237 offset:16896
    s_add_u32 s4, s100, 7
    s_and_b32 s4, s4, 7
    s_lshl_b32 s4, s4, 7
    s_add_u32 s3, s98, s4
    s_add_u32 m0, s99, 12288
    s_nop 0
    buffer_load_dwordx4 v216, s[28:31], s3 offen offset:0 lds
    buffer_load_dwordx4 v217, s[28:31], s3 offen offset:1024 lds
    buffer_load_dwordx4 v218, s[28:31], s3 offen offset:2048 lds
    v_mfma_f32_16x16x32_bf16 v[176:179], v[232:235], v[196:199], v[176:179]
    v_mfma_f32_16x16x32_bf16 v[180:183], v[232:235], v[80:83], v[180:183]
    v_dot2_f32_bf16 v184, v80, v80, v184
    v_dot2_f32_bf16 v185, v81, v81, v185
    v_dot2_f32_bf16 v184, v82, v82, v184
    v_dot2_f32_bf16 v185, v83, v83, v185
    s_waitcnt lgkmcnt(0)
    v_mfma_f32_32x32x16_bf16 v[128:143], v[168:171], v[84:87], v[128:143]
    ds_read_b64 v[88:89], v228 offset:4096
    ds_read_b64 v[90:91], v229 offset:4096
    ds_read_b64_tr_b16 v[160:161], v192 offset:18432
    ds_read_b64_tr_b16 v[162:163], v192 offset:19968
    ds_read_b64_tr_b16 v[164:165], v192 offset:18496
    v_mfma_f32_32x32x16_bf16 v[144:159], v[84:87], v[172:175], v[144:159]
    ds_read_b64_tr_b16 v[166:167], v192 offset:20032
    ds_read_b64_tr_b16 v[196:197], v237 offset:18432
    ds_read_b64_tr_b16 v[198:199], v237 offset:19968
    buffer_load_dwordx4 v219, s[28:31], s3 offen offset:3072 lds
    s_add_u32 s4, s100, 7
    s_and_b32 s4, s4, 7
    s_mul_i32 s4, s4, 196608
    s_add_u32 s3, s96, s4
    s_add_u32 m0, s97, 86016
    s_nop 0
    buffer_load_dwordx4 v193, s[12:15], s3 offen offset:0 lds
    v_mfma_f32_16x16x32_bf16 v[176:179], v[232:235], v[200:203], v[176:179]
    v_mfma_f32_16x16x32_bf16 v[180:183], v[232:235], v[84:87], v[180:183]
    v_dot2_f32_bf16 v184, v84, v84, v184
    v_dot2_f32_bf16 v185, v85, v85, v185
    v_dot2_f32_bf16 v184, v86, v86, v184
    v_dot2_f32_bf16 v185, v87, v87, v185
    s_waitcnt lgkmcnt(0)
    v_mfma_f32_32x32x16_bf16 v[128:143], v[160:163], v[88:91], v[128:143]
    ds_read_b64 v[92:93], v230 offset:4096
    ds_read_b64 v[94:95], v231 offset:4096
    ds_read_b64_tr_b16 v[168:169], v192 offset:21504
    ds_read_b64_tr_b16 v[170:171], v192 offset:23040
    ds_read_b64_tr_b16 v[172:173], v192 offset:21568
    v_mfma_f32_32x32x16_bf16 v[144:159], v[88:91], v[164:167], v[144:159]
    ds_read_b64_tr_b16 v[174:175], v192 offset:23104
    ds_read_b64_tr_b16 v[200:201], v237 offset:21504
    ds_read_b64_tr_b16 v[202:203], v237 offset:23040
    buffer_load_dwordx4 v194, s[12:15], s3 offen offset:1024 lds
    buffer_load_dwordx4 v195, s[12:15], s3 offen offset:2048 lds
    v_mfma_f32_16x16x32_bf16 v[176:179], v[232:235], v[196:199], v[176:179]
    v_mfma_f32_16x16x32_bf16 v[180:183], v[232:235], v[88:91], v[180:183]
    v_dot2_f32_bf16 v184, v88, v88, v184
    v_dot2_f32_bf16 v185, v89, v89, v185
    v_dot2_f32_bf16 v184, v90, v90, v184
    v_dot2_f32_bf16 v185, v91, v91, v185
    s_waitcnt lgkmcnt(0)
    v_mfma_f32_32x32x16_bf16 v[128:143], v[168:171], v[92:95], v[128:143]
    s_waitcnt vmcnt(7)
    s_barrier
    ds_read_b64 v[96:97], v224 offset:8192
    ds_read_b64 v[98:99], v225 offset:8192
    ds_read_b64_tr_b16 v[160:161], v192 offset:24576
    ds_read_b64_tr_b16 v[162:163], v192 offset:26112
    ds_read_b64_tr_b16 v[164:165], v192 offset:24640
    v_mfma_f32_32x32x16_bf16 v[144:159], v[92:95], v[172:175], v[144:159]
    ds_read_b64_tr_b16 v[166:167], v192 offset:26176
    ds_read_b64_tr_b16 v[196:197], v237 offset:24576
    ds_read_b64_tr_b16 v[198:199], v237 offset:26112
    v_mfma_f32_16x16x32_bf16 v[176:179], v[232:235], v[200:203], v[176:179]
    v_mfma_f32_16x16x32_bf16 v[180:183], v[232:235], v[92:95], v[180:183]
    v_dot2_f32_bf16 v184, v92, v92, v184
    v_dot2_f32_bf16 v185, v93, v93, v185
    v_dot2_f32_bf16 v184, v94, v94, v184
    v_dot2_f32_bf16 v185, v95, v95, v185
    s_waitcnt lgkmcnt(0)
    v_mfma_f32_32x32x16_bf16 v[128:143], v[160:163], v[96:99], v[128:143]
    ds_read_b64 v[100:101], v226 offset:8192
    ds_read_b64 v[102:103], v227 offset:8192
    ds_read_b64_tr_b16 v[168:169], v192 offset:27648
    ds_read_b64_tr_b16 v[170:171], v192 offset:29184
    ds_read_b64_tr_b16 v[172:173], v192 offset:27712
    v_mfma_f32_32x32x16_bf16 v[144:159], v[96:99], v[164:167], v[144:159]
    ds_read_b64_tr_b16 v[174:175], v192 offset:29248
    ds_read_b64_tr_b16 v[200:201], v237 offset:27648
    ds_read_b64_tr_b16 v[202:203], v237 offset:29184
    v_mfma_f32_16x16x32_bf16 v[176:179], v[232:235], v[196:199], v[176:179]
    v_mfma_f32_16x16x32_bf16 v[180:183], v[232:235], v[96:99], v[180:183]
    v_dot2_f32_bf16 v184, v96, v96, v184
    v_dot2_f32_bf16 v185, v97, v97, v185
    v_dot2_f32_bf16 v184, v98, v98, v184
    v_dot2_f32_bf16 v185, v99, v99, v185
    s_waitcnt lgkmcnt(0)
    v_mfma_f32_32x32x16_bf16 v[128:143], v[168:171], v[100:103], v[128:143]
    ds_read_b64 v[104:105], v228 offset:8192
    ds_read_b64 v[106:107], v229 offset:8192
    ds_read_b64_tr_b16 v[160:161], v192 offset:30720
    ds_read_b64_tr_b16 v[162:163], v192 offset:32256
    ds_read_b64_tr_b16 v[164:165], v192 offset:30784
    v_mfma_f32_32x32x16_bf16 v[144:159], v[100:103], v[172:175], v[144:159]
    ds_read_b64_tr_b16 v[166:167], v192 offset:32320
    ds_read_b64_tr_b16 v[196:197], v237 offset:30720
    ds_read_b64_tr_b16 v[198:199], v237 offset:32256
    v_mfma_f32_16x16x32_bf16 v[176:179], v[232:235], v[200:203], v[176:179]
    v_mfma_f32_16x16x32_bf16 v[180:183], v[232:235], v[100:103], v[180:183]
    v_dot2_f32_bf16 v184, v100, v100, v184
    v_dot2_f32_bf16 v185, v101, v101, v185
    v_dot2_f32_bf16 v184, v102, v102, v184
    v_dot2_f32_bf16 v185, v103, v103, v185
    s_waitcnt lgkmcnt(0)
    v_mfma_f32_32x32x16_bf16 v[128:143], v[160:163], v[104:107], v[128:143]
    ds_read_b64 v[108:109], v230 offset:8192
    ds_read_b64 v[110:111], v231 offset:8192
    ds_read_b64_tr_b16 v[168:169], v192 offset:33792
    ds_read_b64_tr_b16 v[170:171], v192 offset:35328
    ds_read_b64_tr_b16 v[172:173], v192 offset:33856
    v_mfma_f32_32x32x16_bf16 v[144:159], v[104:107], v[164:167], v[144:159]
    ds_read_b64_tr_b16 v[174:175], v192 offset:35392
    ds_read_b64_tr_b16 v[200:201], v237 offset:33792
    ds_read_b64_tr_b16 v[202:203], v237 offset:35328
    v_mfma_f32_16x16x32_bf16 v[176:179], v[232:235], v[196:199], v[176:179]
    v_mfma_f32_16x16x32_bf16 v[180:183], v[232:235], v[104:107], v[180:183]
    v_dot2_f32_bf16 v184, v104, v104, v184
    v_dot2_f32_bf16 v185, v105, v105, v185
    v_dot2_f32_bf16 v184, v106, v106, v184
    v_dot2_f32_bf16 v185, v107, v107, v185
    s_waitcnt lgkmcnt(0)
    v_mfma_f32_32x32x16_bf16 v[128:143], v[168:171], v[108:111], v[128:143]
    s_waitcnt vmcnt(0)
    s_barrier
    ds_read_b64 v[112:113], v224 offset:12288
    ds_read_b64 v[114:115], v225 offset:12288
    ds_read_b64_tr_b16 v[160:161], v192 offset:36864
    ds_read_b64_tr_b16 v[162:163], v192 offset:38400
    ds_read_b64_tr_b16 v[164:165], v192 offset:36928
    v_mfma_f32_32x32x16_bf16 v[144:159], v[108:111], v[172:175], v[144:159]
    ds_read_b64_tr_b16 v[166:167], v192 offset:38464
    ds_read_b64_tr_b16 v[196:197], v237 offset:36864
    ds_read_b64_tr_b16 v[198:199], v237 offset:38400
    v_mfma_f32_16x16x32_bf16 v[176:179], v[232:235], v[200:203], v[176:179]
    v_mfma_f32_16x16x32_bf16 v[180:183], v[232:235], v[108:111], v[180:183]
    v_dot2_f32_bf16 v184, v108, v108, v184
    v_dot2_f32_bf16 v185, v109, v109, v185
    v_dot2_f32_bf16 v184, v110, v110, v184
    v_dot2_f32_bf16 v185, v111, v111, v185
    s_waitcnt lgkmcnt(0)
    v_mfma_f32_32x32x16_bf16 v[128:143], v[160:163], v[112:115], v[128:143]
    ds_read_b64 v[116:117], v226 offset:12288
    ds_read_b64 v[118:119], v227 offset:12288
    ds_read_b64_tr_b16 v[168:169], v192 offset:39936
    ds_read_b64_tr_b16 v[170:171], v192 offset:41472
    ds_read_b64_tr_b16 v[172:173], v192 offset:40000
    v_mfma_f32_32x32x16_bf16 v[144:159], v[112:115], v[164:167], v[144:159]
    ds_read_b64_tr_b16 v[174:175], v192 offset:41536
    ds_read_b64_tr_b16 v[200:201], v237 offset:39936
    ds_read_b64_tr_b16 v[202:203], v237 offset:41472
    v_mfma_f32_16x16x32_bf16 v[176:179], v[232:235], v[196:199], v[176:179]
    v_mfma_f32_16x16x32_bf16 v[180:183], v[232:235], v[112:115], v[180:183]
    v_dot2_f32_bf16 v184, v112, v112, v184
    v_dot2_f32_bf16 v185, v113, v113, v185
    v_dot2_f32_bf16 v184, v114, v114, v184
    v_dot2_f32_bf16 v185, v115, v115, v185
    s_waitcnt lgkmcnt(0)
    v_mfma_f32_32x32x16_bf16 v[128:143], v[168:171], v[116:119], v[128:143]
    ds_read_b64 v[120:121], v228 offset:12288
    ds_read_b64 v[122:123], v229 offset:12288
    ds_read_b64_tr_b16 v[160:161], v192 offset:43008
    ds_read_b64_tr_b16 v[162:163], v192 offset:44544
    ds_read_b64_tr_b16 v[164:165], v192 offset:43072
    v_mfma_f32_32x32x16_bf16 v[144:159], v[116:119], v[172:175], v[144:159]
    ds_read_b64_tr_b16 v[166:167], v192 offset:44608
    ds_read_b64_tr_b16 v[196:197], v237 offset:43008
    ds_read_b64_tr_b16 v[198:199], v237 offset:44544
    v_mfma_f32_16x16x32_bf16 v[176:179], v[232:235], v[200:203], v[176:179]
    v_mfma_f32_16x16x32_bf16 v[180:183], v[232:235], v[116:119], v[180:183]
    v_dot2_f32_bf16 v184, v116, v116, v184
    v_dot2_f32_bf16 v185, v117, v117, v185
    v_dot2_f32_bf16 v184, v118, v118, v184
    v_dot2_f32_bf16 v185, v119, v119, v185
    s_waitcnt lgkmcnt(0)
    v_mfma_f32_32x32x16_bf16 v[128:143], v[160:163], v[120:123], v[128:143]
    ds_read_b64 v[124:125], v230 offset:12288
    ds_read_b64 v[126:127], v231 offset:12288
    ds_read_b64_tr_b16 v[168:169], v192 offset:46080
    ds_read_b64_tr_b16 v[170:171], v192 offset:47616
    ds_read_b64_tr_b16 v[172:173], v192 offset:46144
    v_mfma_f32_32x32x16_bf16 v[144:159], v[120:123], v[164:167], v[144:159]
    ds_read_b64_tr_b16 v[174:175], v192 offset:47680
    ds_read_b64_tr_b16 v[200:201], v237 offset:46080
    ds_read_b64_tr_b16 v[202:203], v237 offset:47616
    v_mfma_f32_16x16x32_bf16 v[176:179], v[232:235], v[196:199], v[176:179]
    v_mfma_f32_16x16x32_bf16 v[180:183], v[232:235], v[120:123], v[180:183]
    v_dot2_f32_bf16 v184, v120, v120, v184
    v_dot2_f32_bf16 v185, v121, v121, v185
    v_dot2_f32_bf16 v184, v122, v122, v184
    v_dot2_f32_bf16 v185, v123, v123, v185
    s_waitcnt lgkmcnt(0)
    v_mfma_f32_32x32x16_bf16 v[128:143], v[168:171], v[124:127], v[128:143]
    v_mfma_f32_32x32x16_bf16 v[144:159], v[124:127], v[172:175], v[144:159]
    v_mfma_f32_16x16x32_bf16 v[176:179], v[232:235], v[200:203], v[176:179]
    v_mfma_f32_16x16x32_bf16 v[180:183], v[232:235], v[124:127], v[180:183]
    v_dot2_f32_bf16 v184, v124, v124, v184
    v_dot2_f32_bf16 v185, v125, v125, v185
    v_dot2_f32_bf16 v184, v126, v126, v184
    v_dot2_f32_bf16 v185, v127, v127, v185
    v_and_b32 v196, 31, v207
    v_lshrrev_b32 v197, 5, v207
    v_lshlrev_b32 v196, 10, v196
    v_lshl_add_u32 v196, v197, 3, v196
    s_lshl_b32 s3, s55, 15
    s_lshl_b32 s4, s56, 5
    s_add_u32 s3, s3, s4
    buffer_load_dwordx2 v[216:217], v196, s[28:31], s3 offen offset:0
    buffer_load_dwordx2 v[218:219], v196, s[28:31], s3 offen offset:16
    buffer_load_dwordx2 v[220:221], v196, s[28:31], s3 offen offset:32
    buffer_load_dwordx2 v[222:223], v196, s[28:31], s3 offen offset:48
    v_readfirstlane_b32 s51, v204
    v_readlane_b32 s46, v204, 1
    s_mov_b32 s47, 0
    s_lshr_b32 s3, s2, 3
    s_lshl_b32 s3, s3, 2
    s_add_u32 s3, s3, s48
    s_lshl_b32 s31, s3, 10
    s_mov_b32 s29, s31
    s_mov_b32 s30, s31
    s_mov_b32 s28, s31
    s_sub_u32 s46, s46, s51
    s_add_u32 s51, s51, 64
    s_getreg_b32 s52, hwreg(HW_REG_XCC_ID, 0, 4)
    s_mov_b32 s100, 0x0000ffff
    s_mov_b32 s101, 0x0000ffff
    v_add_f32 v184, v184, v185
    v_permlane16_swap_b32 v176, v177
    v_permlane16_swap_b32 v180, v181
    v_mov_b32 v185, v184
    s_barrier
    s_lshl_b32 s3, s62, 1
    s_add_u32 s4, s3, 98304
    s_add_u32 s3, s3, s59
    v_add_u32 v196, s4, v213
    s_mov_b32 s4, -1
    s_mov_b32 s5, 0
    s_mov_b64 exec, s[4:5]
    buffer_store_dword v176, v213, s[8:11], s3 offen sc1
    ds_write_b32 v196, v176
    s_mov_b64 exec, -1
    v_permlane32_swap_b32 v184, v185
    v_add_f32 v184, v184, v185
    s_nop 1
    v_permlane32_swap_b32 v180, v184
    s_lshl_b32 s5, s48, 8
    s_add_u32 s5, s5, 99328
    v_and_b32 v203, 31, v207
    v_lshl_add_u32 v203, v203, 2, s5
    v_lshrrev_b32 v199, 5, v207
    v_lshlrev_b32 v199, 4, v199
    v_add_u32 v198, s5, v199
    v_add_u32 v199, 98304, v199
    v_and_b32 v197, 31, v207
    v_lshlrev_b32 v197, 2, v197
    v_add_u32 v197, 98432, v197
    v_mov_b32 v181, v180
    s_nop 1
    v_permlane32_swap_b32 v180, v181
    v_mul_f32 v180, 0x3b000000, v180
    v_mul_f32 v181, 0x3b000000, v181
    v_fma_f32 v181, -v180, v180, v181
    v_max_f32 v181, 0, v181
    v_cvt_pk_bf16_f32 v180, v180, v180
    v_lshlrev_b32 v180, 16, v180
    v_cvt_pk_bf16_f32 v181, v181, v181
    v_lshlrev_b32 v181, 16, v181
    v_add_f32 v181, 0x3727c5ac, v181
    v_cvt_pk_bf16_f32 v181, v181, v181
    v_lshlrev_b32 v181, 16, v181
    v_sqrt_f32 v181, v181
    v_sub_f32 v200, 0, v180
    v_cvt_pk_bf16_f32 v181, v181, v181
    v_lshlrev_b32 v181, 16, v181
    v_rcp_f32 v202, v181
    s_nop 0
    v_mul_f32 v194, 0x3eb8aa3b, v202
    ds_write_b32 v203, v200
    ds_write_b32 v203, v202 offset:128
    s_waitcnt lgkmcnt(0)
    s_barrier
    ds_read_b128 v[176:179], v199 offset:0
    ds_read_b128 v[180:183], v199 offset:32
    ds_read_b128 v[184:187], v199 offset:64
    ds_read_b128 v[188:191], v199 offset:96
    s_branch L_p1epi
L_layer:
    s_cmp_lg_u32 s48, 0
    s_cbranch_scc1 Lpw_1
    v_mov_b32 v202, v206
    s_mov_b32 s3, s61
    s_mov_b64 exec, 0xffff
    s_mov_b32 s6, 0
Lpp_2:
    buffer_load_dwordx2 v[200:201], v202, s[8:11], s3 offen sc1
    s_add_u32 s6, s6, 1
    s_cmp_ge_u32 s6, 0x40000
    s_cbranch_scc1 Lpd_3
    s_waitcnt vmcnt(0)
    v_lshlrev_b32 v204, 4, v200
    v_subrev_u32 v200, s51, v200
    v_xor_b32 v201, 0x5bd1e990, v201
    v_cmp_gt_u32 vcc, 32, v200
    v_xor_b32 v201, v201, v204
    v_cmp_gt_u32 s[4:5], 16, v201
    s_nop 0
    s_and_b64 vcc, vcc, s[4:5]
    s_cmp_eq_u64 vcc, exec
    s_cbranch_scc0 Lpp_2
Lpd_3:
    s_waitcnt vmcnt(0)
    s_mov_b64 exec, -1
Lpw_1:
    s_barrier
    buffer_load_dwordx4 v[0:3], v206, s[8:11], s96 offen offset:0 sc1
    buffer_load_dwordx4 v[4:7], v206, s[8:11], s96 offen offset:1024 sc1
    buffer_load_dwordx4 v[8:11], v206, s[8:11], s96 offen offset:2048 sc1
    buffer_load_dwordx4 v[12:15], v206, s[8:11], s96 offen offset:3072 sc1
    s_add_u32 s96, s96, 4096
    buffer_load_dwordx4 v[16:19], v206, s[8:11], s96 offen offset:0 sc1
    buffer_load_dwordx4 v[20:23], v206, s[8:11], s96 offen offset:1024 sc1
    buffer_load_dwordx4 v[24:27], v206, s[8:11], s96 offen offset:2048 sc1
    buffer_load_dwordx4 v[28:31], v206, s[8:11], s96 offen offset:3072 sc1
    s_add_u32 s96, s96, 4096
    buffer_load_dwordx4 v[32:35], v206, s[8:11], s96 offen offset:0 sc1
    buffer_load_dwordx4 v[36:39], v206, s[8:11], s96 offen offset:1024 sc1
    ds_read_b64_tr_b16 v[160:161], v208 offset:0
    ds_read_b64_tr_b16 v[162:163], v208 offset:1536
    ds_read_b64_tr_b16 v[164:165], v208 offset:64
    ds_read_b64_tr_b16 v[166:167], v208 offset:1600
    ds_read_b64_tr_b16 v[168:169], v208 offset:3072
    ds_read_b64_tr_b16 v[170:171], v208 offset:4608
    buffer_load_dwordx4 v[40:43], v206, s[8:11], s96 offen offset:2048 sc1
    buffer_load_dword v176, v213, s[8:11], s97 offen offset:0 sc1
    ds_read_b64_tr_b16 v[172:173], v208 offset:3136
    ds_read_b64_tr_b16 v[174:175], v208 offset:4672
    s_waitcnt vmcnt(11) lgkmcnt(6)
    v_mfma_f32_32x32x16_bf16 v[128:143], v[160:163], v[0:3], 0
    buffer_load_dword v177, v213, s[8:11], s97 offen offset:256 sc1
    ds_read_b64_tr_b16 v[160:161], v208 offset:6144
    ds_read_b64_tr_b16 v[162:163], v208 offset:7680
    s_waitcnt lgkmcnt(6)
    v_mfma_f32_32x32x16_bf16 v[144:159], v[0:3], v[164:167], 0
    buffer_load_dwordx4 v[44:47], v206, s[8:11], s96 offen offset:3072 sc1
    s_add_u32 s96, s96, 4096
    buffer_load_dword v178, v213, s[8:11], s97 offen offset:512 sc1
    ds_read_b64_tr_b16 v[164:165], v208 offset:6208
    ds_read_b64_tr_b16 v[166:167], v208 offset:7744
    s_waitcnt vmcnt(13) lgkmcnt(6)
    v_mfma_f32_32x32x16_bf16 v[128:143], v[168:171], v[4:7], v[128:143]
    buffer_load_dword v179, v213, s[8:11], s97 offen offset:768 sc1
    ds_read_b64_tr_b16 v[168:169], v208 offset:9216
    ds_read_b64_tr_b16 v[170:171], v208 offset:10752
    s_waitcnt lgkmcnt(6)
    v_mfma_f32_32x32x16_bf16 v[144:159], v[4:7], v[172:175], v[144:159]
    buffer_load_dwordx4 v[48:51], v206, s[8:11], s96 offen offset:0 sc1
    buffer_load_dword v180, v213, s[8:11], s97 offen offset:1024 sc1
    ds_read_b64_tr_b16 v[172:173], v208 offset:9280
    ds_read_b64_tr_b16 v[174:175], v208 offset:10816
    s_waitcnt vmcnt(15) lgkmcnt(6)
    v_mfma_f32_32x32x16_bf16 v[128:143], v[160:163], v[8:11], v[128:143]
    buffer_load_dword v181, v213, s[8:11], s97 offen offset:1280 sc1
    ds_read_b64_tr_b16 v[160:161], v208 offset:12288
    ds_read_b64_tr_b16 v[162:163], v208 offset:13824
    s_waitcnt lgkmcnt(6)
    v_mfma_f32_32x32x16_bf16 v[144:159], v[8:11], v[164:167], v[144:159]
    buffer_load_dwordx4 v[52:55], v206, s[8:11], s96 offen offset:1024 sc1
    buffer_load_dword v182, v213, s[8:11], s97 offen offset:1536 sc1
    ds_read_b64_tr_b16 v[164:165], v208 offset:12352
    ds_read_b64_tr_b16 v[166:167], v208 offset:13888
    s_waitcnt vmcnt(17) lgkmcnt(6)
    v_mfma_f32_32x32x16_bf16 v[128:143], v[168:171], v[12:15], v[128:143]
    buffer_load_dword v183, v213, s[8:11], s97 offen offset:1792 sc1
    ds_read_b64_tr_b16 v[168:169], v208 offset:15360
    ds_read_b64_tr_b16 v[170:171], v208 offset:16896
    s_waitcnt lgkmcnt(6)
    v_mfma_f32_32x32x16_bf16 v[144:159], v[12:15], v[172:175], v[144:159]
    buffer_load_dwordx4 v[56:59], v206, s[8:11], s96 offen offset:2048 sc1
    buffer_load_dword v184, v213, s[8:11], s97 offen offset:2048 sc1
    ds_read_b64_tr_b16 v[172:173], v208 offset:15424
    ds_read_b64_tr_b16 v[174:175], v208 offset:16960
    s_waitcnt vmcnt(19) lgkmcnt(6)
    v_mfma_f32_32x32x16_bf16 v[128:143], v[160:163], v[16:19], v[128:143]
    buffer_load_dword v185, v213, s[8:11], s97 offen offset:2304 sc1
    ds_read_b64_tr_b16 v[160:161], v208 offset:18432
    ds_read_b64_tr_b16 v[162:163], v208 offset:19968
    s_waitcnt lgkmcnt(6)
    v_mfma_f32_32x32x16_bf16 v[144:159], v[16:19], v[164:167], v[144:159]
    buffer_load_dwordx4 v[60:63], v206, s[8:11], s96 offen offset:3072 sc1
    s_add_u32 s96, s96, 4096
    buffer_load_dword v186, v213, s[8:11], s97 offen offset:2560 sc1
    ds_read_b64_tr_b16 v[164:165], v208 offset:18496
    ds_read_b64_tr_b16 v[166:167], v208 offset:20032
    s_waitcnt vmcnt(21) lgkmcnt(6)
    v_mfma_f32_32x32x16_bf16 v[128:143], v[168:171], v[20:23], v[128:143]
    buffer_load_dword v187, v213, s[8:11], s97 offen offset:2816 sc1
    ds_read_b64_tr_b16 v[168:169], v208 offset:21504
    ds_read_b64_tr_b16 v[170:171], v208 offset:23040
    s_waitcnt lgkmcnt(6)
    v_mfma_f32_32x32x16_bf16 v[144:159], v[20:23], v[172:175], v[144:159]
    buffer_load_dwordx4 v[64:67], v206, s[8:11], s96 offen offset:0 sc1
    buffer_load_dword v188, v213, s[8:11], s97 offen offset:3072 sc1
    ds_read_b64_tr_b16 v[172:173], v208 offset:21568
    ds_read_b64_tr_b16 v[174:175], v208 offset:23104
    s_waitcnt vmcnt(23) lgkmcnt(6)
    v_mfma_f32_32x32x16_bf16 v[128:143], v[160:163], v[24:27], v[128:143]
    buffer_load_dword v189, v213, s[8:11], s97 offen offset:3328 sc1
    ds_read_b64_tr_b16 v[160:161], v208 offset:24576
    ds_read_b64_tr_b16 v[162:163], v208 offset:26112
    s_waitcnt lgkmcnt(6)
    v_mfma_f32_32x32x16_bf16 v[144:159], v[24:27], v[164:167], v[144:159]
    buffer_load_dwordx4 v[68:71], v206, s[8:11], s96 offen offset:1024 sc1
    buffer_load_dword v190, v213, s[8:11], s97 offen offset:3584 sc1
    ds_read_b64_tr_b16 v[164:165], v208 offset:24640
    ds_read_b64_tr_b16 v[166:167], v208 offset:26176
    s_waitcnt vmcnt(25) lgkmcnt(6)
    v_mfma_f32_32x32x16_bf16 v[128:143], v[168:171], v[28:31], v[128:143]
    buffer_load_dword v191, v213, s[8:11], s97 offen offset:3840 sc1
    ds_read_b64_tr_b16 v[168:169], v208 offset:27648
    ds_read_b64_tr_b16 v[170:171], v208 offset:29184
    s_waitcnt lgkmcnt(6)
    v_mfma_f32_32x32x16_bf16 v[144:159], v[28:31], v[172:175], v[144:159]
    buffer_load_dwordx4 v[72:75], v206, s[8:11], s96 offen offset:2048 sc1
    ds_read_b64_tr_b16 v[172:173], v208 offset:27712
    ds_read_b64_tr_b16 v[174:175], v208 offset:29248
    s_waitcnt vmcnt(26) lgkmcnt(6)
    v_mfma_f32_32x32x16_bf16 v[128:143], v[160:163], v[32:35], v[128:143]
    ds_read_b64_tr_b16 v[160:161], v208 offset:30720
    ds_read_b64_tr_b16 v[162:163], v208 offset:32256
    s_waitcnt lgkmcnt(6)
    v_mfma_f32_32x32x16_bf16 v[144:159], v[32:35], v[164:167], v[144:159]
    buffer_load_dwordx4 v[76:79], v206, s[8:11], s96 offen offset:3072 sc1
    s_add_u32 s96, s96, 4096
    ds_read_b64_tr_b16 v[164:165], v208 offset:30784
    ds_read_b64_tr_b16 v[166:167], v208 offset:32320
    s_waitcnt vmcnt(26) lgkmcnt(6)
    v_mfma_f32_32x32x16_bf16 v[128:143], v[168:171], v[36:39], v[128:143]
    ds_read_b64_tr_b16 v[168:169], v208 offset:33792
    ds_read_b64_tr_b16 v[170:171], v208 offset:35328
    s_waitcnt lgkmcnt(6)
    v_mfma_f32_32x32x16_bf16 v[144:159], v[36:39], v[172:175], v[144:159]
    buffer_load_dwordx4 v[80:83], v206, s[8:11], s96 offen offset:0 sc1
    ds_read_b64_tr_b16 v[172:173], v208 offset:33856
    ds_read_b64_tr_b16 v[174:175], v208 offset:35392
    s_waitcnt vmcnt(26) lgkmcnt(6)
    v_mfma_f32_32x32x16_bf16 v[128:143], v[160:163], v[40:43], v[128:143]
    ds_read_b64_tr_b16 v[160:161], v208 offset:36864
    ds_read_b64_tr_b16 v[162:163], v208 offset:38400
    s_waitcnt lgkmcnt(6)
    v_mfma_f32_32x32x16_bf16 v[144:159], v[40:43], v[164:167], v[144:159]
    buffer_load_dwordx4 v[84:87], v206, s[8:11], s96 offen offset:1024 sc1
    ds_read_b64_tr_b16 v[164:165], v208 offset:36928
    ds_read_b64_tr_b16 v[166:167], v208 offset:38464
    s_waitcnt vmcnt(24) lgkmcnt(6)
    v_mfma_f32_32x32x16_bf16 v[128:143], v[168:171], v[44:47], v[128:143]
    ds_read_b64_tr_b16 v[168:169], v208 offset:39936
    ds_read_b64_tr_b16 v[170:171], v208 offset:41472
    s_waitcnt lgkmcnt(6)
    v_mfma_f32_32x32x16_bf16 v[144:159], v[44:47], v[172:175], v[144:159]
    buffer_load_dwordx4 v[88:91], v206, s[8:11], s96 offen offset:2048 sc1
    ds_read_b64_tr_b16 v[172:173], v208 offset:40000
    ds_read_b64_tr_b16 v[174:175], v208 offset:41536
    s_waitcnt vmcnt(22) lgkmcnt(6)
    v_mfma_f32_32x32x16_bf16 v[128:143], v[160:163], v[48:51], v[128:143]
    ds_read_b64_tr_b16 v[160:161], v208 offset:43008
    ds_read_b64_tr_b16 v[162:163], v208 offset:44544
    s_waitcnt lgkmcnt(6)
    v_mfma_f32_32x32x16_bf16 v[144:159], v[48:51], v[164:167], v[144:159]
    buffer_load_dwordx4 v[92:95], v206, s[8:11], s96 offen offset:3072 sc1
    s_add_u32 s96, s96, 4096
    ds_read_b64_tr_b16 v[164:165], v208 offset:43072
    ds_read_b64_tr_b16 v[166:167], v208 offset:44608
    s_waitcnt vmcnt(20) lgkmcnt(6)
    v_mfma_f32_32x32x16_bf16 v[128:143], v[168:171], v[52:55], v[128:143]
    ds_read_b64_tr_b16 v[168:169], v208 offset:46080
    ds_read_b64_tr_b16 v[170:171], v208 offset:47616
    s_waitcnt lgkmcnt(6)
    v_mfma_f32_32x32x16_bf16 v[144:159], v[52:55], v[172:175], v[144:159]
    buffer_load_dwordx4 v[96:99], v206, s[8:11], s96 offen offset:0 sc1
    ds_read_b64_tr_b16 v[172:173], v208 offset:46144
    ds_read_b64_tr_b16 v[174:175], v208 offset:47680
    s_waitcnt vmcnt(18) lgkmcnt(6)
    v_mfma_f32_32x32x16_bf16 v[128:143], v[160:163], v[56:59], v[128:143]
    ds_read_b64_tr_b16 v[160:161], v192 offset:0
    ds_read_b64_tr_b16 v[162:163], v192 offset:1536
    s_waitcnt lgkmcnt(6)
    v_mfma_f32_32x32x16_bf16 v[144:159], v[56:59], v[164:167], v[144:159]
    buffer_load_dwordx4 v[100:103], v206, s[8:11], s96 offen offset:1024 sc1
    ds_read_b64_tr_b16 v[164:165], v192 offset:64
    ds_read_b64_tr_b16 v[166:167], v192 offset:1600
    s_waitcnt vmcnt(16) lgkmcnt(6)
    v_mfma_f32_32x32x16_bf16 v[128:143], v[168:171], v[60:63], v[128:143]
    ds_read_b64_tr_b16 v[168:169], v192 offset:3072
    ds_read_b64_tr_b16 v[170:171], v192 offset:4608
    s_waitcnt lgkmcnt(6)
    v_mfma_f32_32x32x16_bf16 v[144:159], v[60:63], v[172:175], v[144:159]
    buffer_load_dwordx4 v[104:107], v206, s[8:11], s96 offen offset:2048 sc1
    ds_read_b64_tr_b16 v[172:173], v192 offset:3136
    ds_read_b64_tr_b16 v[174:175], v192 offset:4672
    s_waitcnt vmcnt(14) lgkmcnt(6)
    v_mfma_f32_32x32x16_bf16 v[128:143], v[160:163], v[64:67], v[128:143]
    ds_read_b64_tr_b16 v[160:161], v192 offset:6144
    ds_read_b64_tr_b16 v[162:163], v192 offset:7680
    s_waitcnt lgkmcnt(6)
    v_mfma_f32_32x32x16_bf16 v[144:159], v[64:67], v[164:167], v[144:159]
    buffer_load_dwordx4 v[108:111], v206, s[8:11], s96 offen offset:3072 sc1
    s_add_u32 s96, s96, 4096
    ds_read_b64_tr_b16 v[164:165], v192 offset:6208
    ds_read_b64_tr_b16 v[166:167], v192 offset:7744
    s_waitcnt vmcnt(12) lgkmcnt(6)
    v_mfma_f32_32x32x16_bf16 v[128:143], v[168:171], v[68:71], v[128:143]
    ds_read_b64_tr_b16 v[168:169], v192 offset:9216
    ds_read_b64_tr_b16 v[170:171], v192 offset:10752
    s_waitcnt lgkmcnt(6)
    v_mfma_f32_32x32x16_bf16 v[144:159], v[68:71], v[172:175], v[144:159]
    buffer_load_dwordx4 v[112:115], v206, s[8:11], s96 offen offset:0 sc1
    ds_read_b64_tr_b16 v[172:173], v192 offset:9280
    ds_read_b64_tr_b16 v[174:175], v192 offset:10816
    s_waitcnt vmcnt(10) lgkmcnt(6)
    v_mfma_f32_32x32x16_bf16 v[128:143], v[160:163], v[72:75], v[128:143]
    ds_read_b64_tr_b16 v[160:161], v192 offset:12288
    ds_read_b64_tr_b16 v[162:163], v192 offset:13824
    s_waitcnt lgkmcnt(6)
    v_mfma_f32_32x32x16_bf16 v[144:159], v[72:75], v[164:167], v[144:159]
    buffer_load_dwordx4 v[116:119], v206, s[8:11], s96 offen offset:1024 sc1
    ds_read_b64_tr_b16 v[164:165], v192 offset:12352
    ds_read_b64_tr_b16 v[166:167], v192 offset:13888
    s_waitcnt vmcnt(10) lgkmcnt(6)
    v_mfma_f32_32x32x16_bf16 v[128:143], v[168:171], v[76:79], v[128:143]
    v_add_f32 v176, v176, v184
    v_add_f32 v177, v177, v185
    ds_read_b64_tr_b16 v[168:169], v192 offset:15360
    ds_read_b64_tr_b16 v[170:171], v192 offset:16896
    s_waitcnt lgkmcnt(6)
    v_mfma_f32_32x32x16_bf16 v[144:159], v[76:79], v[172:175], v[144:159]
    v_add_f32 v178, v178, v186
    v_add_f32 v179, v179, v187
    buffer_load_dwordx4 v[120:123], v206, s[8:11], s96 offen offset:2048 sc1
    ds_read_b64_tr_b16 v[172:173], v192 offset:15424
    ds_read_b64_tr_b16 v[174:175], v192 offset:16960
    s_waitcnt vmcnt(10) lgkmcnt(6)
    v_mfma_f32_32x32x16_bf16 v[128:143], v[160:163], v[80:83], v[128:143]
    v_add_f32 v180, v180, v188
    v_add_f32 v181, v181, v189
    ds_read_b64_tr_b16 v[160:161], v192 offset:18432
    ds_read_b64_tr_b16 v[162:163], v192 offset:19968
    s_waitcnt lgkmcnt(6)
    v_mfma_f32_32x32x16_bf16 v[144:159], v[80:83], v[164:167], v[144:159]
    v_add_f32 v182, v182, v190
    v_add_f32 v183, v183, v191
    buffer_load_dwordx4 v[124:127], v206, s[8:11], s96 offen offset:3072 sc1
    ds_read_b64_tr_b16 v[164:165], v192 offset:18496
    ds_read_b64_tr_b16 v[166:167], v192 offset:20032
    s_waitcnt vmcnt(10) lgkmcnt(6)
    v_mfma_f32_32x32x16_bf16 v[128:143], v[168:171], v[84:87], v[128:143]
    v_add_f32 v176, v176, v180
    v_add_f32 v177, v177, v181
    ds_read_b64_tr_b16 v[168:169], v192 offset:21504
    ds_read_b64_tr_b16 v[170:171], v192 offset:23040
    s_waitcnt lgkmcnt(6)
    v_mfma_f32_32x32x16_bf16 v[144:159], v[84:87], v[172:175], v[144:159]
    v_add_f32 v178, v178, v182
    v_add_f32 v179, v179, v183
    ds_read_b64_tr_b16 v[172:173], v192 offset:21568
    ds_read_b64_tr_b16 v[174:175], v192 offset:23104
    s_waitcnt vmcnt(9) lgkmcnt(6)
    v_mfma_f32_32x32x16_bf16 v[128:143], v[160:163], v[88:91], v[128:143]
    v_add_f32 v176, v176, v178
    v_add_f32 v177, v177, v179
    ds_read_b64_tr_b16 v[160:161], v192 offset:24576
    ds_read_b64_tr_b16 v[162:163], v192 offset:26112
    s_waitcnt lgkmcnt(6)
    v_mfma_f32_32x32x16_bf16 v[144:159], v[88:91], v[164:167], v[144:159]
    v_add_f32 v176, v176, v177
    v_mov_b32 v177, v176
    ds_read_b64_tr_b16 v[164:165], v192 offset:24640
    ds_read_b64_tr_b16 v[166:167], v192 offset:26176
    s_waitcnt vmcnt(8) lgkmcnt(6)
    v_mfma_f32_32x32x16_bf16 v[128:143], v[168:171], v[92:95], v[128:143]
    v_permlane32_swap_b32 v176, v177
    v_mul_f32 v176, 0x3b000000, v176
    ds_read_b64_tr_b16 v[168:169], v192 offset:27648
    ds_read_b64_tr_b16 v[170:171], v192 offset:29184
    s_waitcnt lgkmcnt(6)
    v_mfma_f32_32x32x16_bf16 v[144:159], v[92:95], v[172:175], v[144:159]
    v_mul_f32 v177, 0x3b000000, v177
    v_fma_f32 v177, -v176, v176, v177
    ds_read_b64_tr_b16 v[172:173], v192 offset:27712
    ds_read_b64_tr_b16 v[174:175], v192 offset:29248
    s_waitcnt vmcnt(7) lgkmcnt(6)
    v_mfma_f32_32x32x16_bf16 v[128:143], v[160:163], v[96:99], v[128:143]
    v_max_f32 v177, 0, v177
    v_cvt_pk_bf16_f32 v176, v176, v176
    ds_read_b64_tr_b16 v[160:161], v192 offset:30720
    ds_read_b64_tr_b16 v[162:163], v192 offset:32256
    s_waitcnt lgkmcnt(6)
    v_mfma_f32_32x32x16_bf16 v[144:159], v[96:99], v[164:167], v[144:159]
    v_lshlrev_b32 v176, 16, v176
    v_cvt_pk_bf16_f32 v177, v177, v177
    ds_read_b64_tr_b16 v[164:165], v192 offset:30784
    ds_read_b64_tr_b16 v[166:167], v192 offset:32320
    s_waitcnt vmcnt(6) lgkmcnt(6)
    v_mfma_f32_32x32x16_bf16 v[128:143], v[168:171], v[100:103], v[128:143]
    v_lshlrev_b32 v177, 16, v177
    v_add_f32 v177, 0x3727c5ac, v177
    ds_read_b64_tr_b16 v[168:169], v192 offset:33792
    ds_read_b64_tr_b16 v[170:171], v192 offset:35328
    s_waitcnt lgkmcnt(6)
    v_mfma_f32_32x32x16_bf16 v[144:159], v[100:103], v[172:175], v[144:159]
    v_cvt_pk_bf16_f32 v177, v177, v177
    v_lshlrev_b32 v177, 16, v177
    ds_read_b64_tr_b16 v[172:173], v192 offset:33856
    ds_read_b64_tr_b16 v[174:175], v192 offset:35392
    s_waitcnt vmcnt(5) lgkmcnt(6)
    v_mfma_f32_32x32x16_bf16 v[128:143], v[160:163], v[104:107], v[128:143]
    v_sqrt_f32 v177, v177
    v_sub_f32 v200, 0, v176
    ds_read_b64_tr_b16 v[160:161], v192 offset:36864
    ds_read_b64_tr_b16 v[162:163], v192 offset:38400
    s_waitcnt lgkmcnt(6)
    v_mfma_f32_32x32x16_bf16 v[144:159], v[104:107], v[164:167], v[144:159]
    v_cvt_pk_bf16_f32 v177, v177, v177
    v_lshlrev_b32 v177, 16, v177
    ds_read_b64_tr_b16 v[164:165], v192 offset:36928
    ds_read_b64_tr_b16 v[166:167], v192 offset:38464
    s_waitcnt vmcnt(4) lgkmcnt(6)
    v_mfma_f32_32x32x16_bf16 v[128:143], v[168:171], v[108:111], v[128:143]
    v_rcp_f32 v202, v177
    s_nop 0
    v_mul_f32 v194, 0x3eb8aa3b, v202
    ds_read_b64_tr_b16 v[168:169], v192 offset:39936
    ds_read_b64_tr_b16 v[170:171], v192 offset:41472
    s_waitcnt lgkmcnt(6)
    v_mfma_f32_32x32x16_bf16 v[144:159], v[108:111], v[172:175], v[144:159]
    ds_write_b32 v203, v200
    ds_write_b32 v203, v202 offset:128
    ds_read_b64_tr_b16 v[172:173], v192 offset:40000
    ds_read_b64_tr_b16 v[174:175], v192 offset:41536
    s_waitcnt vmcnt(3) lgkmcnt(8)
    v_mfma_f32_32x32x16_bf16 v[128:143], v[160:163], v[112:115], v[128:143]
    ds_read_b64_tr_b16 v[160:161], v192 offset:43008
    ds_read_b64_tr_b16 v[162:163], v192 offset:44544
    s_waitcnt lgkmcnt(8)
    v_mfma_f32_32x32x16_bf16 v[144:159], v[112:115], v[164:167], v[144:159]
    ds_read_b64_tr_b16 v[164:165], v192 offset:43072
    ds_read_b64_tr_b16 v[166:167], v192 offset:44608
    s_waitcnt vmcnt(2) lgkmcnt(8)
    v_mfma_f32_32x32x16_bf16 v[128:143], v[168:171], v[116:119], v[128:143]
    ds_read_b64_tr_b16 v[168:169], v192 offset:46080
    ds_read_b64_tr_b16 v[170:171], v192 offset:47616
    s_waitcnt lgkmcnt(6)
    v_mfma_f32_32x32x16_bf16 v[144:159], v[116:119], v[172:175], v[144:159]
    ds_read_b64_tr_b16 v[172:173], v192 offset:46144
    ds_read_b64_tr_b16 v[174:175], v192 offset:47680
    s_waitcnt vmcnt(1) lgkmcnt(6)
    v_mfma_f32_32x32x16_bf16 v[128:143], v[160:163], v[120:123], v[128:143]
    ds_read_b128 v[176:179], v199 offset:0
    ds_read_b128 v[180:183], v199 offset:32
    ds_read_b128 v[184:187], v199 offset:64
    ds_read_b128 v[188:191], v199 offset:96
    s_waitcnt lgkmcnt(8)
    v_mfma_f32_32x32x16_bf16 v[144:159], v[120:123], v[164:167], v[144:159]
    s_waitcnt vmcnt(0) lgkmcnt(6)
    v_mfma_f32_32x32x16_bf16 v[128:143], v[168:171], v[124:127], v[128:143]
    s_waitcnt lgkmcnt(4)
    v_mfma_f32_32x32x16_bf16 v[144:159], v[124:127], v[172:175], v[144:159]
L_p1epi:
    ds_read_b128 v[160:163], v198 offset:0
    ds_read_b128 v[164:167], v198 offset:32
    ds_read_b128 v[168:171], v198 offset:64
    ds_read_b128 v[172:175], v198 offset:96
    ds_read_b32 v196, v197
    s_lshl_b32 s3, s50, 18
    s_lshl_b32 s4, s54, 12
    s_add_u32 s3, s3, s4
    s_lshl_b32 s4, s53, 22
    s_add_u32 s3, s3, s4
    s_add_u32 s3, s3, 14680064
    s_lshl_b32 s4, s48, 12
    s_add_u32 s4, s4, 147456
    v_add_u32 v203, s4, v206
    s_waitcnt lgkmcnt(5)
    v_pk_fma_f32 v[128:129], v[176:177], v[200:201], v[128:129] op_sel_hi:[1,0,1]
    v_pk_fma_f32 v[130:131], v[178:179], v[200:201], v[130:131] op_sel_hi:[1,0,1]
    v_pk_fma_f32 v[132:133], v[180:181], v[200:201], v[132:133] op_sel_hi:[1,0,1]
    v_pk_fma_f32 v[134:135], v[182:183], v[200:201], v[134:135] op_sel_hi:[1,0,1]
    v_pk_fma_f32 v[136:137], v[184:185], v[200:201], v[136:137] op_sel_hi:[1,0,1]
    v_pk_fma_f32 v[138:139], v[186:187], v[200:201], v[138:139] op_sel_hi:[1,0,1]
    v_pk_fma_f32 v[140:141], v[188:189], v[200:201], v[140:141] op_sel_hi:[1,0,1]
    v_pk_fma_f32 v[142:143], v[190:191], v[200:201], v[142:143] op_sel_hi:[1,0,1]
    ds_read_b128 v[176:179], v198 offset:128
    ds_read_b128 v[180:183], v198 offset:160
    ds_read_b128 v[184:187], v198 offset:192
    ds_read_b128 v[188:191], v198 offset:224
    v_pk_mul_f32 v[128:129], v[128:129], v[202:203] op_sel_hi:[1,0]
    v_pk_mul_f32 v[130:131], v[130:131], v[202:203] op_sel_hi:[1,0]
    v_pk_mul_f32 v[132:133], v[132:133], v[202:203] op_sel_hi:[1,0]
    v_pk_mul_f32 v[134:135], v[134:135], v[202:203] op_sel_hi:[1,0]
    v_pk_mul_f32 v[136:137], v[136:137], v[202:203] op_sel_hi:[1,0]
    v_pk_mul_f32 v[138:139], v[138:139], v[202:203] op_sel_hi:[1,0]
    v_pk_mul_f32 v[140:141], v[140:141], v[202:203] op_sel_hi:[1,0]
    v_pk_mul_f32 v[142:143], v[142:143], v[202:203] op_sel_hi:[1,0]
    v_cvt_pk_bf16_f32 v128, v128, v129
    v_cvt_pk_bf16_f32 v129, v130, v131
    v_cvt_pk_bf16_f32 v130, v132, v133
    v_cvt_pk_bf16_f32 v131, v134, v135
    v_cvt_pk_bf16_f32 v132, v136, v137
    v_cvt_pk_bf16_f32 v133, v138, v139
    v_cvt_pk_bf16_f32 v134, v140, v141
    v_cvt_pk_bf16_f32 v135, v142, v143
    buffer_store_dwordx4 v[128:131], v206, s[8:11], s3 offen offset:0 sc1
    buffer_store_dwordx4 v[132:135], v206, s[8:11], s3 offen offset:1024 sc1
    s_waitcnt lgkmcnt(4)
    v_pk_fma_f32 v[144:145], v[160:161], v[196:197], v[144:145] op_sel_hi:[1,0,1]
    v_pk_fma_f32 v[146:147], v[162:163], v[196:197], v[146:147] op_sel_hi:[1,0,1]
    v_pk_fma_f32 v[148:149], v[164:165], v[196:197], v[148:149] op_sel_hi:[1,0,1]
    v_pk_fma_f32 v[150:151], v[166:167], v[196:197], v[150:151] op_sel_hi:[1,0,1]
    v_pk_fma_f32 v[152:153], v[168:169], v[196:197], v[152:153] op_sel_hi:[1,0,1]
    v_pk_fma_f32 v[154:155], v[170:171], v[196:197], v[154:155] op_sel_hi:[1,0,1]
    v_pk_fma_f32 v[156:157], v[172:173], v[196:197], v[156:157] op_sel_hi:[1,0,1]
    v_pk_fma_f32 v[158:159], v[174:175], v[196:197], v[158:159] op_sel_hi:[1,0,1]
    s_waitcnt lgkmcnt(0)
    v_pk_mul_f32 v[144:145], v[144:145], v[176:177]
    v_pk_mul_f32 v[146:147], v[146:147], v[178:179]
    v_pk_mul_f32 v[148:149], v[148:149], v[180:181]
    v_pk_mul_f32 v[150:151], v[150:151], v[182:183]
    v_pk_mul_f32 v[152:153], v[152:153], v[184:185]
    v_pk_mul_f32 v[154:155], v[154:155], v[186:187]
    v_pk_mul_f32 v[156:157], v[156:157], v[188:189]
    v_pk_mul_f32 v[158:159], v[158:159], v[190:191]
    v_cvt_pk_bf16_f32 v144, v144, v145
    v_cvt_pk_bf16_f32 v145, v146, v147
    v_cvt_pk_bf16_f32 v146, v148, v149
    v_cvt_pk_bf16_f32 v147, v150, v151
    v_cvt_pk_bf16_f32 v148, v152, v153
    v_cvt_pk_bf16_f32 v149, v154, v155
    v_cvt_pk_bf16_f32 v150, v156, v157
    v_cvt_pk_bf16_f32 v151, v158, v159
    buffer_store_dwordx4 v[144:147], v206, s[8:11], s3 offen offset:2048 sc1
    buffer_store_dwordx4 v[148:151], v206, s[8:11], s3 offen offset:3072 sc1
    ds_read_b64_tr_b16 v[136:137], v208 offset:128
    ds_read_b64_tr_b16 v[138:139], v208 offset:1664
    ds_read_b64_tr_b16 v[140:141], v208 offset:3200
    ds_read_b64_tr_b16 v[142:143], v208 offset:4736
    ds_read_b64_tr_b16 v[152:153], v208 offset:6272
    ds_read_b64_tr_b16 v[154:155], v208 offset:7808
    ds_write_b128 v203, v[128:131] offset:0
    ds_write_b128 v203, v[132:135] offset:1024
    ds_write_b128 v203, v[144:147] offset:2048
    ds_write_b128 v203, v[148:151] offset:3072
    ds_read_b128 v[176:179], v199 offset:256
    ds_read_b128 v[180:183], v199 offset:288
    ds_read_b128 v[184:187], v199 offset:320
    ds_read_b128 v[188:191], v199 offset:352
    v_mov_b32 v196, v200
    v_mov_b32 v198, 0xf149f2ca
    v_mov_b32 v199, 0
    s_cmp_ge_u32 s49, 2
    s_cselect_b32 s3, 0xf149f2ca, 0
    v_mov_b32 v197, s3
    ds_read_b64_tr_b16 v[156:157], v208 offset:9344
    ds_read_b64_tr_b16 v[158:159], v208 offset:10880
    s_waitcnt lgkmcnt(14)
    v_mfma_f32_32x32x16_bf16 v[160:175], v[136:139], v[0:3], 0
    s_lshl_b32 s28, s57, 1
    s_sub_u32 s97, 3, s28
    s_add_u32 s51, s51, 1
    s_lshl_b32 s62, s60, 1
    ds_read_b64_tr_b16 v[136:137], v208 offset:12416
    ds_read_b64_tr_b16 v[138:139], v208 offset:13952
    s_waitcnt lgkmcnt(14)
    v_mfma_f32_32x32x16_bf16 v[160:175], v[140:143], v[4:7], v[160:175]
    s_lshl_b32 s3, s48, 3
    s_add_u32 s62, s62, s3
    s_add_u32 s62, s62, 12288
    s_lshl_b32 s3, s51, 4
    ds_read_b64_tr_b16 v[140:141], v208 offset:15488
    ds_read_b64_tr_b16 v[142:143], v208 offset:17024
    s_waitcnt lgkmcnt(14)
    v_mfma_f32_32x32x16_bf16 v[160:175], v[152:155], v[8:11], v[160:175]
    s_xor_b32 s3, s3, 0x5bd1e990
    s_or_b32 s3, s3, s52
    v_mov_b32 v200, s51
    v_mov_b32 v201, s3
    ds_read_b64_tr_b16 v[152:153], v208 offset:18560
    ds_read_b64_tr_b16 v[154:155], v208 offset:20096
    s_waitcnt lgkmcnt(6)
    v_mfma_f32_32x32x16_bf16 v[160:175], v[156:159], v[12:15], v[160:175]
    v_mov_b32 v202, 0
    s_lshl_b32 s4, s48, 11
    s_add_u32 s4, s4, 102400
    v_add_u32 v203, s4, v206
    ds_read_b64_tr_b16 v[156:157], v208 offset:21632
    ds_read_b64_tr_b16 v[158:159], v208 offset:23168
    s_waitcnt lgkmcnt(6)
    v_mfma_f32_32x32x16_bf16 v[160:175], v[136:139], v[16:19], v[160:175]
    ds_read_b64_tr_b16 v[136:137], v208 offset:24704
    ds_read_b64_tr_b16 v[138:139], v208 offset:26240
    s_waitcnt lgkmcnt(6)
    v_mfma_f32_32x32x16_bf16 v[160:175], v[140:143], v[20:23], v[160:175]
    v_cndmask_b32 v0, v198, v199, s[64:65]
    v_cndmask_b32 v1, v198, v199, s[66:67]
    v_cndmask_b32 v2, v198, v199, s[68:69]
    v_cndmask_b32 v3, v198, v199, s[70:71]
    ds_read_b64_tr_b16 v[140:141], v208 offset:27776
    ds_read_b64_tr_b16 v[142:143], v208 offset:29312
    s_waitcnt lgkmcnt(6)
    v_mfma_f32_32x32x16_bf16 v[160:175], v[152:155], v[24:27], v[160:175]
    v_cndmask_b32 v4, v198, v199, s[72:73]
    v_cndmask_b32 v5, v198, v199, s[74:75]
    v_cndmask_b32 v6, v198, v199, s[76:77]
    v_cndmask_b32 v7, v198, v199, s[78:79]
    ds_read_b64_tr_b16 v[152:153], v208 offset:30848
    ds_read_b64_tr_b16 v[154:155], v208 offset:32384
    s_waitcnt lgkmcnt(6)
    v_mfma_f32_32x32x16_bf16 v[160:175], v[156:159], v[28:31], v[160:175]
    v_cndmask_b32 v8, v198, v199, s[80:81]
    v_cndmask_b32 v9, v198, v199, s[82:83]
    v_cndmask_b32 v10, v198, v199, s[84:85]
    v_cndmask_b32 v11, v198, v199, s[86:87]
    ds_read_b64_tr_b16 v[156:157], v208 offset:33920
    ds_read_b64_tr_b16 v[158:159], v208 offset:35456
    s_waitcnt lgkmcnt(6)
    v_mfma_f32_32x32x16_bf16 v[160:175], v[136:139], v[32:35], v[160:175]
    v_cndmask_b32 v12, v198, v199, s[88:89]
    v_cndmask_b32 v13, v198, v199, s[90:91]
    v_cndmask_b32 v14, v198, v199, s[92:93]
    v_cndmask_b32 v15, v198, v199, s[94:95]
    ds_read_b64_tr_b16 v[136:137], v208 offset:36992
    ds_read_b64_tr_b16 v[138:139], v208 offset:38528
    s_waitcnt lgkmcnt(6)
    v_mfma_f32_32x32x16_bf16 v[160:175], v[140:143], v[36:39], v[160:175]
    v_cndmask_b32 v16, v199, v197, s[64:65]
    v_cndmask_b32 v17, v199, v197, s[66:67]
    v_cndmask_b32 v18, v199, v197, s[68:69]
    v_cndmask_b32 v19, v199, v197, s[70:71]
    ds_read_b64_tr_b16 v[140:141], v208 offset:40064
    ds_read_b64_tr_b16 v[142:143], v208 offset:41600
    s_waitcnt lgkmcnt(6)
    v_mfma_f32_32x32x16_bf16 v[160:175], v[152:155], v[40:43], v[160:175]
    v_cndmask_b32 v20, v199, v197, s[72:73]
    v_cndmask_b32 v21, v199, v197, s[74:75]
    v_cndmask_b32 v22, v199, v197, s[76:77]
    v_cndmask_b32 v23, v199, v197, s[78:79]
    ds_read_b64_tr_b16 v[152:153], v208 offset:43136
    ds_read_b64_tr_b16 v[154:155], v208 offset:44672
    s_waitcnt lgkmcnt(6)
    v_mfma_f32_32x32x16_bf16 v[160:175], v[156:159], v[44:47], v[160:175]
    v_cndmask_b32 v24, v199, v197, s[80:81]
    v_cndmask_b32 v25, v199, v197, s[82:83]
    v_cndmask_b32 v26, v199, v197, s[84:85]
    v_cndmask_b32 v27, v199, v197, s[86:87]
    ds_read_b64_tr_b16 v[156:157], v208 offset:46208
    ds_read_b64_tr_b16 v[158:159], v208 offset:47744
    s_waitcnt lgkmcnt(6)
    v_mfma_f32_32x32x16_bf16 v[160:175], v[136:139], v[48:51], v[160:175]
    v_cndmask_b32 v28, v199, v197, s[88:89]
    v_cndmask_b32 v29, v199, v197, s[90:91]
    v_cndmask_b32 v30, v199, v197, s[92:93]
    v_cndmask_b32 v31, v199, v197, s[94:95]
    ds_read_b64_tr_b16 v[136:137], v192 offset:128
    ds_read_b64_tr_b16 v[138:139], v192 offset:1664
    s_waitcnt lgkmcnt(6)
    v_mfma_f32_32x32x16_bf16 v[160:175], v[140:143], v[52:55], v[160:175]
    v_mov_b32 v32, 0x3f803f80
    v_mov_b32 v33, 0x3f803f80
    v_mov_b32 v34, 0x3f803f80
    v_mov_b32 v35, 0x3f803f80
    ds_read_b64_tr_b16 v[140:141], v192 offset:3200
    ds_read_b64_tr_b16 v[142:143], v192 offset:4736
    s_waitcnt lgkmcnt(6)
    v_mfma_f32_32x32x16_bf16 v[160:175], v[152:155], v[56:59], v[160:175]
    v_mov_b32 v36, 0x3f803f80
    v_mov_b32 v37, 0x3f803f80
    v_mov_b32 v38, 0x3f803f80
    v_mov_b32 v39, 0x3f803f80
    ds_read_b64_tr_b16 v[152:153], v192 offset:6272
    ds_read_b64_tr_b16 v[154:155], v192 offset:7808
    s_waitcnt lgkmcnt(6)
    v_mfma_f32_32x32x16_bf16 v[160:175], v[156:159], v[60:63], v[160:175]
    v_mov_b32 v40, 0x3f803f80
    v_mov_b32 v41, 0x3f803f80
    v_mov_b32 v42, 0x3f803f80
    v_mov_b32 v43, 0x3f803f80
    ds_read_b64_tr_b16 v[156:157], v192 offset:9344
    ds_read_b64_tr_b16 v[158:159], v192 offset:10880
    s_waitcnt lgkmcnt(6)
    v_mfma_f32_32x32x16_bf16 v[160:175], v[136:139], v[64:67], v[160:175]
    v_mov_b32 v44, 0x3f803f80
    v_mov_b32 v45, 0x3f803f80
    v_mov_b32 v46, 0x3f803f80
    v_mov_b32 v47, 0x3f803f80
    ds_read_b64_tr_b16 v[136:137], v192 offset:12416
    ds_read_b64_tr_b16 v[138:139], v192 offset:13952
    s_waitcnt lgkmcnt(6)
    v_mfma_f32_32x32x16_bf16 v[160:175], v[140:143], v[68:71], v[160:175]
    ds_read_b64_tr_b16 v[140:141], v192 offset:15488
    ds_read_b64_tr_b16 v[142:143], v192 offset:17024
    s_waitcnt lgkmcnt(6)
    v_mfma_f32_32x32x16_bf16 v[160:175], v[152:155], v[72:75], v[160:175]
    ds_read_b64_tr_b16 v[152:153], v192 offset:18560
    ds_read_b64_tr_b16 v[154:155], v192 offset:20096
    s_waitcnt lgkmcnt(6)
    v_mfma_f32_32x32x16_bf16 v[160:175], v[156:159], v[76:79], v[160:175]
    ds_read_b64_tr_b16 v[156:157], v192 offset:21632
    ds_read_b64_tr_b16 v[158:159], v192 offset:23168
    s_waitcnt lgkmcnt(6)
    v_mfma_f32_32x32x16_bf16 v[160:175], v[136:139], v[80:83], v[160:175]
    ds_read_b64_tr_b16 v[136:137], v192 offset:24704
    ds_read_b64_tr_b16 v[138:139], v192 offset:26240
    s_waitcnt lgkmcnt(6)
    v_mfma_f32_32x32x16_bf16 v[160:175], v[140:143], v[84:87], v[160:175]
    v_mov_b64 v[48:49], 0
    v_mov_b64 v[50:51], 0
    v_mov_b64 v[52:53], 0
    v_mov_b64 v[54:55], 0
    ds_read_b64_tr_b16 v[140:141], v192 offset:27776
    ds_read_b64_tr_b16 v[142:143], v192 offset:29312
    s_waitcnt lgkmcnt(6)
    v_mfma_f32_32x32x16_bf16 v[160:175], v[152:155], v[88:91], v[160:175]
    v_mov_b64 v[56:57], 0
    v_mov_b64 v[58:59], 0
    v_mov_b64 v[60:61], 0
    v_mov_b64 v[62:63], 0
    ds_read_b64_tr_b16 v[152:153], v192 offset:30848
    ds_read_b64_tr_b16 v[154:155], v192 offset:32384
    s_waitcnt lgkmcnt(6)
    v_mfma_f32_32x32x16_bf16 v[160:175], v[156:159], v[92:95], v[160:175]
    v_mov_b64 v[64:65], 0
    v_mov_b64 v[66:67], 0
    v_mov_b64 v[68:69], 0
    v_mov_b64 v[70:71], 0
    ds_read_b64_tr_b16 v[156:157], v192 offset:33920
    ds_read_b64_tr_b16 v[158:159], v192 offset:35456
    s_waitcnt lgkmcnt(6)
    v_mfma_f32_32x32x16_bf16 v[160:175], v[136:139], v[96:99], v[160:175]
    v_mov_b64 v[72:73], 0
    v_mov_b64 v[74:75], 0
    v_mov_b64 v[76:77], 0
    v_mov_b64 v[78:79], 0
    s_waitcnt vmcnt(0)
    s_mov_b64 exec, 1
    buffer_store_dwordx2 v[200:201], v202, s[8:11], s62 offen sc1
    s_mov_b64 exec, -1
    s_cmp_lg_u32 s53, 0
    s_cbranch_scc1 Ll0_4
    v_lshlrev_b32 v238, 7, v207
    s_lshl_b32 s6, s2, 2
    s_add_u32 s6, s6, s48
    s_lshl_b32 s6, s6, 11
    s_mov_b64 exec, 0xffff
    buffer_load_dword v211, v238, s[16:19], s6 offen
    buffer_load_dword v211, v238, s[20:23], s6 offen
    buffer_load_dword v211, v238, s[24:27], s6 offen
    s_mov_b64 exec, -1
Ll0_4:
    ds_read_b64_tr_b16 v[136:137], v192 offset:36992
    ds_read_b64_tr_b16 v[138:139], v192 offset:38528
    s_waitcnt lgkmcnt(6)
    v_mfma_f32_32x32x16_bf16 v[160:175], v[140:143], v[100:103], v[160:175]
    ds_read_b64_tr_b16 v[140:141], v192 offset:40064
    ds_read_b64_tr_b16 v[142:143], v192 offset:41600
    s_waitcnt lgkmcnt(6)
    v_mfma_f32_32x32x16_bf16 v[160:175], v[152:155], v[104:107], v[160:175]
    s_lshr_b32 s3, s48, 1
    s_lshl_b32 s4, s3, 10
    s_lshl_b32 s5, s28, 11
    s_add_u32 s5, s5, s4
    ds_read_b64_tr_b16 v[152:153], v192 offset:43136
    ds_read_b64_tr_b16 v[154:155], v192 offset:44672
    s_waitcnt lgkmcnt(6)
    v_mfma_f32_32x32x16_bf16 v[160:175], v[156:159], v[108:111], v[160:175]
    s_add_u32 s5, s5, 102400
    v_add_u32 v80, s5, v206
    s_lshl_b32 s5, s97, 11
    s_add_u32 s5, s5, s4
    ds_read_b64_tr_b16 v[156:157], v192 offset:46208
    ds_read_b64_tr_b16 v[158:159], v192 offset:47744
    s_waitcnt lgkmcnt(6)
    v_mfma_f32_32x32x16_bf16 v[160:175], v[136:139], v[112:115], v[160:175]
    s_add_u32 s5, s5, 102400
    v_add_u32 v81, s5, v206
    s_add_u32 s5, s4, 114688
    v_add_u32 v82, s5, v206
    s_waitcnt lgkmcnt(4)
    v_mfma_f32_32x32x16_bf16 v[160:175], v[140:143], v[116:119], v[160:175]
    v_and_b32 v83, 0x2f0, v206
    s_lshl_b32 s5, s3, 8
    s_add_u32 s5, s5, 116736
    v_add_u32 v83, s5, v83
    s_waitcnt lgkmcnt(2)
    v_mfma_f32_32x32x16_bf16 v[160:175], v[152:155], v[120:123], v[160:175]
    s_lshl_b32 s4, s28, 12
    s_lshl_b32 s5, s97, 12
    v_add_u32 v84, s4, v82
    v_add_u32 v85, s5, v82
    s_waitcnt lgkmcnt(0)
    v_mfma_f32_32x32x16_bf16 v[160:175], v[156:159], v[124:127], v[160:175]
    s_mul_i32 s96, s48, 131072
    s_add_u32 s96, s96, s63
    s_add_u32 s96, s96, 0
    s_mul_i32 s3, s48, 28672
    s_mov_b32 m0, s3
    s_nop 6
    v_pk_fma_f32 v[160:161], v[176:177], v[196:197], v[160:161] op_sel_hi:[1,0,1]
    v_pk_fma_f32 v[162:163], v[178:179], v[196:197], v[162:163] op_sel_hi:[1,0,1]
    v_pk_fma_f32 v[164:165], v[180:181], v[196:197], v[164:165] op_sel_hi:[1,0,1]
    v_pk_fma_f32 v[166:167], v[182:183], v[196:197], v[166:167] op_sel_hi:[1,0,1]
    v_pk_fma_f32 v[168:169], v[184:185], v[196:197], v[168:169] op_sel_hi:[1,0,1]
    v_pk_fma_f32 v[170:171], v[186:187], v[196:197], v[170:171] op_sel_hi:[1,0,1]
    v_pk_fma_f32 v[172:173], v[188:189], v[196:197], v[172:173] op_sel_hi:[1,0,1]
    v_pk_fma_f32 v[174:175], v[190:191], v[196:197], v[174:175] op_sel_hi:[1,0,1]
    v_pk_mul_f32 v[160:161], v[160:161], v[194:195] op_sel_hi:[1,0]
    v_pk_mul_f32 v[162:163], v[162:163], v[194:195] op_sel_hi:[1,0]
    v_pk_mul_f32 v[164:165], v[164:165], v[194:195] op_sel_hi:[1,0]
    v_pk_mul_f32 v[166:167], v[166:167], v[194:195] op_sel_hi:[1,0]
    v_pk_mul_f32 v[168:169], v[168:169], v[194:195] op_sel_hi:[1,0]
    v_pk_mul_f32 v[170:171], v[170:171], v[194:195] op_sel_hi:[1,0]
    v_pk_mul_f32 v[172:173], v[172:173], v[194:195] op_sel_hi:[1,0]
    v_pk_mul_f32 v[174:175], v[174:175], v[194:195] op_sel_hi:[1,0]
    v_cvt_pk_bf16_f32 v160, v160, v161
    v_cvt_pk_bf16_f32 v161, v162, v163
    v_cvt_pk_bf16_f32 v162, v164, v165
    v_cvt_pk_bf16_f32 v163, v166, v167
    v_cvt_pk_bf16_f32 v164, v168, v169
    v_cvt_pk_bf16_f32 v165, v170, v171
    v_cvt_pk_bf16_f32 v166, v172, v173
    v_cvt_pk_bf16_f32 v167, v174, v175
    ds_write_b128 v203, v[160:163]
    ds_write_b128 v203, v[164:167] offset:1024
    v_mov_b32 v186, v82
    v_mov_b32 v187, v83
    v_mul_u32_u24 v190, 4682, v207
    v_lshrrev_b32 v190, 16, v190
    v_mul_u32_u24 v191, 14, v190
    v_sub_u32 v191, v207, v191
    v_mul_u32_u24 v190, 3584, v190
    v_lshl_add_u32 v190, v191, 4, v190
    s_waitcnt lgkmcnt(0)
    s_barrier
    ds_read_b128 v[192:195], v80
    ds_read_b128 v[176:179], v84 offset:32768
    ds_read_b128 v[196:199], v81
    ds_read_b128 v[180:183], v85 offset:32768
    s_lshr_b32 s4, s48, 1
    s_add_u32 s4, s4, s49
    s_sub_i32 s4, s4, 2
    s_cmp_lt_i32 s4, 0
    s_cselect_b32 s99, 1, 0
    s_max_i32 s4, s4, 0
    s_lshl_b32 s62, s4, 9
    s_lshl_b32 s4, s50, 5
    s_add_u32 s62, s62, s4
    s_lshl_b32 s4, s57, 4
    s_add_u32 s62, s62, s4
    s_add_u32 s62, s62, 12288
    s_waitcnt lgkmcnt(2)
    v_mfma_f32_32x32x16_bf16 v[112:127], v[176:179], v[192:195], v[0:15]
    s_waitcnt lgkmcnt(0)
    v_mfma_f32_32x32x16_bf16 v[128:143], v[180:183], v[196:199], v[0:15]
    s_cmp_lg_u32 s53, 0
    s_cbranch_scc1 Ll0_5
    s_mul_i32 s3, s48, 24576
    v_add_u32 v188, s3, v206
    ds_read_b128 a[128:131], v188 offset:0
    ds_read_b128 a[132:135], v188 offset:1024
    ds_read_b128 a[136:139], v188 offset:2048
    ds_read_b128 a[140:143], v188 offset:3072
    ds_read_b128 a[144:147], v188 offset:4096
    ds_read_b128 a[148:151], v188 offset:5120
    s_waitcnt lgkmcnt(6)
    ds_read_b128 a[152:155], v188 offset:6144
    ds_read_b128 a[156:159], v188 offset:7168
    ds_read_b128 a[160:163], v188 offset:8192
    ds_read_b128 a[164:167], v188 offset:9216
    ds_read_b128 a[168:171], v188 offset:10240
    ds_read_b128 a[172:175], v188 offset:11264
    s_waitcnt lgkmcnt(6)
    ds_read_b128 a[176:179], v188 offset:12288
    ds_read_b128 a[180:183], v188 offset:13312
    ds_read_b128 a[184:187], v188 offset:14336
    ds_read_b128 a[188:191], v188 offset:15360
    ds_read_b128 a[192:195], v188 offset:16384
    ds_read_b128 a[196:199], v188 offset:17408
    s_waitcnt lgkmcnt(6)
    ds_read_b128 a[200:203], v188 offset:18432
    ds_read_b128 a[204:207], v188 offset:19456
    ds_read_b128 a[208:211], v188 offset:20480
    ds_read_b128 a[212:215], v188 offset:21504
    ds_read_b128 a[216:219], v188 offset:22528
    ds_read_b128 a[220:223], v188 offset:23552
    s_waitcnt lgkmcnt(0)
Ll0_5:
    s_barrier
    v_max3_f32 v200, v112, v113, v114
    v_max3_f32 v200, v200, v115, v116
    v_max3_f32 v200, v200, v117, v118
    v_max3_f32 v200, v200, v119, v120
    v_max3_f32 v200, v200, v121, v122
    v_max3_f32 v200, v200, v123, v124
    v_max3_f32 v200, v200, v125, v126
    v_max_f32 v200, v200, v127
    v_mov_b32 v201, v200
    v_max3_f32 v202, v128, v129, v130
    v_max3_f32 v202, v202, v131, v132
    v_max3_f32 v202, v202, v133, v134
    v_max3_f32 v202, v202, v135, v136
    v_max3_f32 v202, v202, v137, v138
    v_max3_f32 v202, v202, v139, v140
    v_max3_f32 v202, v202, v141, v142
    v_max_f32 v202, v202, v143
    v_mov_b32 v203, v202
    v_permlane32_swap_b32 v200, v201
    s_nop 0
    v_permlane32_swap_b32 v202, v203
    v_max_f32 v200, v200, v201
    v_sub_f32 v200, 0, v200
    v_mov_b32 v201, v200
    v_max_f32 v202, v202, v203
    v_sub_f32 v202, 0, v202
    v_mov_b32 v203, v202
    v_pk_add_f32 v[112:113], v[112:113], v[200:201]
    v_pk_add_f32 v[114:115], v[114:115], v[200:201]
    v_pk_add_f32 v[116:117], v[116:117], v[200:201]
    v_pk_add_f32 v[118:119], v[118:119], v[200:201]
    v_pk_add_f32 v[120:121], v[120:121], v[200:201]
    v_pk_add_f32 v[122:123], v[122:123], v[200:201]
    v_pk_add_f32 v[124:125], v[124:125], v[200:201]
    v_pk_add_f32 v[126:127], v[126:127], v[200:201]
    v_mov_b64 v[80:81], v[200:201]
    v_mov_b64 v[82:83], v[200:201]
    v_mov_b64 v[84:85], v[200:201]
    v_mov_b64 v[86:87], v[200:201]
    v_mov_b64 v[88:89], v[200:201]
    v_mov_b64 v[90:91], v[200:201]
    v_mov_b64 v[92:93], v[200:201]
    v_mov_b64 v[94:95], v[200:201]
    v_pk_add_f32 v[128:129], v[128:129], v[202:203]
    v_pk_add_f32 v[130:131], v[130:131], v[202:203]
    v_pk_add_f32 v[132:133], v[132:133], v[202:203]
    v_pk_add_f32 v[134:135], v[134:135], v[202:203]
    v_pk_add_f32 v[136:137], v[136:137], v[202:203]
    v_pk_add_f32 v[138:139], v[138:139], v[202:203]
    v_pk_add_f32 v[140:141], v[140:141], v[202:203]
    v_pk_add_f32 v[142:143], v[142:143], v[202:203]
    v_mov_b64 v[96:97], v[202:203]
    v_mov_b64 v[98:99], v[202:203]
    v_mov_b64 v[100:101], v[202:203]
    v_mov_b64 v[102:103], v[202:203]
    v_mov_b64 v[104:105], v[202:203]
    v_mov_b64 v[106:107], v[202:203]
    v_mov_b64 v[108:109], v[202:203]
    v_mov_b64 v[110:111], v[202:203]
    s_cmp_lg_u32 s53, 0
    s_cbranch_scc1 L_own1
    v_mov_b32 v204, 0
    s_mov_b64 exec, 1
    buffer_load_dwordx4 v[200:203], v204, s[8:11], s62 offen sc1
    s_mov_b64 exec, -1
    v_add_u32 v240, 7168, v214
    v_add_u32 v241, 14336, v214
    s_mul_i32 s29, s48, 28672
    s_add_u32 s31, s29, 16384
    s_mul_i32 s30, s48, 458752
    s_add_u32 s30, s30, s63
    s_add_u32 s30, s30, 0
    s_mov_b32 m0, s29
    s_add_u32 s29, s29, 1024
    buffer_load_dwordx4 v214, s[16:19], s96 offen offset:0 lds
    s_add_u32 s96, s96, 8192
    s_mov_b32 m0, s31
    s_add_u32 s31, s31, 2048
    buffer_load_dwordx4 v214, s[24:27], s30 offen offset:0 lds
    buffer_load_dwordx4 v240, s[24:27], s30 offen offset:1024 lds
    s_add_u32 s30, s30, 16384
    s_mov_b32 s3, 8
    s_add_u32 s4, s28, 8
    s_lshl_b32 s3, s3, 12
    s_lshl_b32 s4, s4, 12
    v_add_u32 v184, s3, v186
    v_add_u32 v185, s3, v187
    s_sub_u32 s5, s4, 4096
    v_add_u32 v188, s5, v186
    v_add_u32 v189, s4, v187
    ds_read_b128 v[180:183], v188
    s_mov_b64 exec, s[100:101]
    ds_read_b128 v[32:35], v189 offset:0
    ds_read_b128 v[36:39], v189 offset:1024
    s_mov_b64 exec, -1
    s_cmp_eq_u32 s57, 0
    s_cbranch_scc1 Loa0_0
Loa0_2:
    v_exp_f32 v112, v112
    v_exp_f32 v113, v113
    s_mov_b32 m0, s29
    s_add_u32 s29, s29, 3072
    buffer_load_dwordx4 v214, s[16:19], s96 offen offset:0 lds
    buffer_load_dwordx4 v240, s[16:19], s96 offen offset:1024 lds
    buffer_load_dwordx4 v241, s[16:19], s96 offen offset:2048 lds
    s_add_u32 s96, s96, 24576
    v_exp_f32 v114, v114
    v_exp_f32 v115, v115
    v_exp_f32 v116, v116
    s_waitcnt lgkmcnt(2)
    v_mfma_f32_32x32x16_bf16 v[144:159], v[180:183], v[192:195], v[80:95]
    ds_read_b128 v[176:179], v184 offset:0
    v_exp_f32 v117, v117
    v_exp_f32 v118, v118
    v_exp_f32 v119, v119
    v_exp_f32 v120, v120
    v_cvt_pk_bf16_f32 v160, v112, v113
    v_cvt_pk_bf16_f32 v161, v114, v115
    v_cvt_pk_bf16_f32 v162, v116, v117
    v_cvt_pk_bf16_f32 v163, v118, v119
    s_waitcnt lgkmcnt(1)
    s_nop 0
    v_mfma_f32_32x32x16_bf16 v[48:63], v[32:35], v[160:163], v[48:63]
    s_mov_b64 exec, s[100:101]
    ds_read_b128 v[40:43], v185 offset:4096
    ds_read_b128 v[44:47], v185 offset:5120
    s_mov_b64 exec, -1
    v_exp_f32 v121, v121
    v_exp_f32 v122, v122
    v_exp_f32 v123, v123
    s_mov_b32 m0, s31
    s_add_u32 s31, s31, 2048
    buffer_load_dwordx4 v214, s[24:27], s30 offen offset:0 lds
    buffer_load_dwordx4 v240, s[24:27], s30 offen offset:1024 lds
    s_add_u32 s30, s30, 16384
    v_exp_f32 v124, v124
    v_exp_f32 v125, v125
    v_exp_f32 v126, v126
    v_exp_f32 v127, v127
    v_cvt_pk_bf16_f32 v164, v120, v121
    v_cvt_pk_bf16_f32 v165, v122, v123
    v_cvt_pk_bf16_f32 v166, v124, v125
    v_cvt_pk_bf16_f32 v167, v126, v127
    s_nop 1
    v_mfma_f32_32x32x16_bf16 v[48:63], v[36:39], v[164:167], v[48:63]
Loa0_1:
    v_exp_f32 v144, v144
    v_exp_f32 v145, v145
    s_mov_b32 m0, s29
    s_add_u32 s29, s29, 3072
    buffer_load_dwordx4 v214, s[16:19], s96 offen offset:0 lds
    buffer_load_dwordx4 v240, s[16:19], s96 offen offset:1024 lds
    buffer_load_dwordx4 v241, s[16:19], s96 offen offset:2048 lds
    s_add_u32 s96, s96, 24576
    v_exp_f32 v146, v146
    v_exp_f32 v147, v147
    v_exp_f32 v148, v148
    s_waitcnt lgkmcnt(2)
    v_mfma_f32_32x32x16_bf16 v[112:127], v[176:179], v[192:195], v[80:95]
    v_exp_f32 v149, v149
    v_exp_f32 v150, v150
    v_exp_f32 v151, v151
    v_exp_f32 v152, v152
    v_cvt_pk_bf16_f32 v168, v144, v145
    v_cvt_pk_bf16_f32 v169, v146, v147
    v_cvt_pk_bf16_f32 v170, v148, v149
    v_cvt_pk_bf16_f32 v171, v150, v151
    s_waitcnt lgkmcnt(0)
    s_nop 0
    v_mfma_f32_32x32x16_bf16 v[48:63], v[40:43], v[168:171], v[48:63]
    s_mov_b64 exec, s[100:101]
    ds_read_b128 v[32:35], v185 offset:0
    ds_read_b128 v[36:39], v185 offset:1024
    s_mov_b64 exec, -1
    v_exp_f32 v153, v153
    v_exp_f32 v154, v154
    v_exp_f32 v155, v155
    s_mov_b32 m0, s31
    s_add_u32 s31, s31, 2048
    buffer_load_dwordx4 v214, s[24:27], s30 offen offset:0 lds
    buffer_load_dwordx4 v240, s[24:27], s30 offen offset:1024 lds
    s_add_u32 s30, s30, 16384
    v_exp_f32 v156, v156
    v_exp_f32 v157, v157
    v_exp_f32 v158, v158
    v_exp_f32 v159, v159
    v_cvt_pk_bf16_f32 v172, v152, v153
    v_cvt_pk_bf16_f32 v173, v154, v155
    v_cvt_pk_bf16_f32 v174, v156, v157
    v_cvt_pk_bf16_f32 v175, v158, v159
    s_nop 1
    v_mfma_f32_32x32x16_bf16 v[48:63], v[44:47], v[172:175], v[48:63]
Loa0_0:
    v_exp_f32 v112, v112
    v_exp_f32 v113, v113
    s_mov_b32 m0, s29
    s_add_u32 s29, s29, 3072
    buffer_load_dwordx4 v214, s[16:19], s96 offen offset:0 lds
    buffer_load_dwordx4 v240, s[16:19], s96 offen offset:1024 lds
    buffer_load_dwordx4 v241, s[16:19], s96 offen offset:2048 lds
    s_add_u32 s96, s96, 24576
    v_exp_f32 v114, v114
    v_exp_f32 v115, v115
    v_exp_f32 v116, v116
    v_exp_f32 v117, v117
    v_exp_f32 v118, v118
    v_exp_f32 v119, v119
    v_exp_f32 v120, v120
    v_cvt_pk_bf16_f32 v160, v112, v113
    v_cvt_pk_bf16_f32 v161, v114, v115
    v_cvt_pk_bf16_f32 v162, v116, v117
    v_cvt_pk_bf16_f32 v163, v118, v119
    s_waitcnt lgkmcnt(0)
    s_nop 0
    v_mfma_f32_32x32x16_bf16 v[48:63], v[32:35], v[160:163], v[48:63]
    v_exp_f32 v121, v121
    v_exp_f32 v122, v122
    v_exp_f32 v123, v123
    s_mov_b32 m0, s31
    s_add_u32 s31, s31, 2048
    buffer_load_dwordx4 v214, s[24:27], s30 offen offset:0 lds
    buffer_load_dwordx4 v240, s[24:27], s30 offen offset:1024 lds
    s_add_u32 s30, s30, 16384
    v_exp_f32 v124, v124
    v_exp_f32 v125, v125
    v_exp_f32 v126, v126
    v_exp_f32 v127, v127
    v_cvt_pk_bf16_f32 v164, v120, v121
    v_cvt_pk_bf16_f32 v165, v122, v123
    v_cvt_pk_bf16_f32 v166, v124, v125
    v_cvt_pk_bf16_f32 v167, v126, v127
    s_nop 1
    v_mfma_f32_32x32x16_bf16 v[48:63], v[36:39], v[164:167], v[48:63]
    s_mov_b32 s3, 8
    s_add_u32 s4, s97, 8
    s_lshl_b32 s3, s3, 12
    s_lshl_b32 s4, s4, 12
    v_add_u32 v184, s3, v186
    v_add_u32 v185, s3, v187
    s_sub_u32 s5, s4, 4096
    v_add_u32 v188, s5, v186
    v_add_u32 v189, s4, v187
    ds_read_b128 v[176:179], v188
    s_mov_b64 exec, s[100:101]
    ds_read_b128 v[40:43], v189 offset:0
    ds_read_b128 v[44:47], v189 offset:1024
    s_mov_b64 exec, -1
    s_add_u32 s7, s51, s46
    s_waitcnt vmcnt(8)
    v_readfirstlane_b32 s3, v200
    v_readfirstlane_b32 s4, v201
    v_readfirstlane_b32 s5, v202
    v_readfirstlane_b32 s6, v203
    s_lshl_b32 s98, s3, 4
    s_xor_b32 s4, s4, s98
    s_lshl_b32 s98, s5, 4
    s_xor_b32 s6, s6, s98
    s_sub_u32 s3, s3, s7
    s_sub_u32 s5, s5, s7
    s_or_b32 s3, s3, s5
    s_xor_b32 s4, s4, 0x5bd1e990
    s_xor_b32 s6, s6, 0x5bd1e990
    s_or_b32 s4, s4, s6
    s_lshr_b32 s3, s3, 5
    s_lshr_b32 s4, s4, 4
    s_or_b32 s3, s3, s4
    s_or_b32 s3, s3, s99
    s_cmp_lg_u32 s3, 0
    s_cbranch_scc1 L_try0
    s_mov_b32 s98, m0
    s_lshl_b32 s3, s49, 2
    s_lshl_b32 s4, s48, 1
    s_add_u32 s3, s3, s4
    s_sub_i32 s3, s3, 8
    s_lshl_b32 s5, s3, 12
    s_lshl_b32 s4, s50, 18
    s_add_u32 s5, s5, s4
    s_lshl_b32 s4, s53, 22
    s_add_u32 s5, s5, s4
    s_add_u32 s5, s5, 14680064
    s_lshl_b32 s3, s48, 13
    s_add_u32 m0, s3, 114688
    s_nop 0
    buffer_load_dwordx4 v206, s[8:11], s5 offen offset:0 sc1 lds
    buffer_load_dwordx4 v206, s[8:11], s5 offen offset:1024 sc1 lds
    buffer_load_dwordx4 v206, s[8:11], s5 offen offset:2048 sc1 lds
    buffer_load_dwordx4 v206, s[8:11], s5 offen offset:3072 sc1 lds
    s_add_u32 s5, s5, 4096
    s_add_u32 m0, m0, 4096
    s_nop 0
    buffer_load_dwordx4 v206, s[8:11], s5 offen offset:0 sc1 lds
    buffer_load_dwordx4 v206, s[8:11], s5 offen offset:1024 sc1 lds
    buffer_load_dwordx4 v206, s[8:11], s5 offen offset:2048 sc1 lds
    buffer_load_dwordx4 v206, s[8:11], s5 offen offset:3072 sc1 lds
    s_mov_b32 m0, s98
    s_mov_b32 s99, 1
L_try0:
    s_cmp_lg_u32 s57, 0
    s_cbranch_scc1 Lob0_1
Lob0_3:
    v_exp_f32 v128, v128
    v_exp_f32 v129, v129
    s_mov_b32 m0, s29
    s_add_u32 s29, s29, 3072
    buffer_load_dwordx4 v214, s[16:19], s96 offen offset:0 lds
    buffer_load_dwordx4 v240, s[16:19], s96 offen offset:1024 lds
    buffer_load_dwordx4 v241, s[16:19], s96 offen offset:2048 lds
    s_add_u32 s96, s96, 24576
    v_exp_f32 v130, v130
    v_exp_f32 v131, v131
    v_exp_f32 v132, v132
    s_waitcnt lgkmcnt(2)
    v_mfma_f32_32x32x16_bf16 v[144:159], v[176:179], v[196:199], v[96:111]
    ds_read_b128 v[180:183], v184 offset:4096
    v_exp_f32 v133, v133
    v_exp_f32 v134, v134
    v_exp_f32 v135, v135
    v_exp_f32 v136, v136
    v_cvt_pk_bf16_f32 v168, v128, v129
    v_cvt_pk_bf16_f32 v169, v130, v131
    v_cvt_pk_bf16_f32 v170, v132, v133
    v_cvt_pk_bf16_f32 v171, v134, v135
    s_waitcnt lgkmcnt(1)
    s_nop 0
    v_mfma_f32_32x32x16_bf16 v[64:79], v[40:43], v[168:171], v[64:79]
    s_mov_b64 exec, s[100:101]
    ds_read_b128 v[32:35], v185 offset:8192
    ds_read_b128 v[36:39], v185 offset:9216
    s_mov_b64 exec, -1
    v_exp_f32 v137, v137
    v_exp_f32 v138, v138
    v_exp_f32 v139, v139
    s_mov_b32 m0, s31
    s_add_u32 s31, s31, 2048
    buffer_load_dwordx4 v214, s[24:27], s30 offen offset:0 lds
    buffer_load_dwordx4 v240, s[24:27], s30 offen offset:1024 lds
    s_add_u32 s30, s30, 16384
    v_exp_f32 v140, v140
    v_exp_f32 v141, v141
    v_exp_f32 v142, v142
    v_exp_f32 v143, v143
    v_cvt_pk_bf16_f32 v172, v136, v137
    v_cvt_pk_bf16_f32 v173, v138, v139
    v_cvt_pk_bf16_f32 v174, v140, v141
    v_cvt_pk_bf16_f32 v175, v142, v143
    s_nop 1
    v_mfma_f32_32x32x16_bf16 v[64:79], v[44:47], v[172:175], v[64:79]
Lob0_2:
    v_exp_f32 v144, v144
    v_exp_f32 v145, v145
    s_mov_b32 m0, s29
    s_add_u32 s29, s29, 3072
    buffer_load_dwordx4 v214, s[16:19], s96 offen offset:0 lds
    buffer_load_dwordx4 v240, s[16:19], s96 offen offset:1024 lds
    buffer_load_dwordx4 v241, s[16:19], s96 offen offset:2048 lds
    s_add_u32 s96, s96, 24576
    v_exp_f32 v146, v146
    v_exp_f32 v147, v147
    v_exp_f32 v148, v148
    s_waitcnt lgkmcnt(2)
    v_mfma_f32_32x32x16_bf16 v[128:143], v[180:183], v[196:199], v[96:111]
    ds_read_b128 v[176:179], v184 offset:0
    v_exp_f32 v149, v149
    v_exp_f32 v150, v150
    v_exp_f32 v151, v151
    v_exp_f32 v152, v152
    v_cvt_pk_bf16_f32 v160, v144, v145
    v_cvt_pk_bf16_f32 v161, v146, v147
    v_cvt_pk_bf16_f32 v162, v148, v149
    v_cvt_pk_bf16_f32 v163, v150, v151
    s_waitcnt lgkmcnt(1)
    s_nop 0
    v_mfma_f32_32x32x16_bf16 v[64:79], v[32:35], v[160:163], v[64:79]
    s_mov_b64 exec, s[100:101]
    ds_read_b128 v[40:43], v185 offset:4096
    ds_read_b128 v[44:47], v185 offset:5120
    s_mov_b64 exec, -1
    v_exp_f32 v153, v153
    v_exp_f32 v154, v154
    v_exp_f32 v155, v155
    s_mov_b32 m0, s31
    s_add_u32 s31, s31, 2048
    buffer_load_dwordx4 v214, s[24:27], s30 offen offset:0 lds
    buffer_load_dwordx4 v240, s[24:27], s30 offen offset:1024 lds
    s_add_u32 s30, s30, 16384
    v_exp_f32 v156, v156
    v_exp_f32 v157, v157
    v_exp_f32 v158, v158
    v_exp_f32 v159, v159
    v_cvt_pk_bf16_f32 v164, v152, v153
    v_cvt_pk_bf16_f32 v165, v154, v155
    v_cvt_pk_bf16_f32 v166, v156, v157
    v_cvt_pk_bf16_f32 v167, v158, v159
    s_nop 1
    v_mfma_f32_32x32x16_bf16 v[64:79], v[36:39], v[164:167], v[64:79]
Lob0_1:
    v_exp_f32 v128, v128
    v_exp_f32 v129, v129
    s_mov_b32 m0, s29
    s_add_u32 s29, s29, 3072
    buffer_load_dwordx4 v214, s[16:19], s96 offen offset:0 lds
    buffer_load_dwordx4 v240, s[16:19], s96 offen offset:1024 lds
    buffer_load_dwordx4 v241, s[16:19], s96 offen offset:2048 lds
    s_add_u32 s96, s96, 24576
    v_exp_f32 v130, v130
    v_exp_f32 v131, v131
    v_exp_f32 v132, v132
    s_waitcnt lgkmcnt(2)
    v_mfma_f32_32x32x16_bf16 v[144:159], v[176:179], v[196:199], v[96:111]
    v_exp_f32 v133, v133
    v_exp_f32 v134, v134
    v_exp_f32 v135, v135
    v_exp_f32 v136, v136
    v_cvt_pk_bf16_f32 v168, v128, v129
    v_cvt_pk_bf16_f32 v169, v130, v131
    v_cvt_pk_bf16_f32 v170, v132, v133
    v_cvt_pk_bf16_f32 v171, v134, v135
    s_waitcnt lgkmcnt(0)
    s_nop 0
    v_mfma_f32_32x32x16_bf16 v[64:79], v[40:43], v[168:171], v[64:79]
    s_mov_b64 exec, s[100:101]
    ds_read_b128 v[32:35], v185 offset:0
    ds_read_b128 v[36:39], v185 offset:1024
    s_mov_b64 exec, -1
    v_exp_f32 v137, v137
    v_exp_f32 v138, v138
    v_exp_f32 v139, v139
    s_mov_b32 m0, s31
    s_add_u32 s31, s31, 2048
    buffer_load_dwordx4 v214, s[24:27], s30 offen offset:0 lds
    buffer_load_dwordx4 v240, s[24:27], s30 offen offset:1024 lds
    s_add_u32 s30, s30, 16384
    v_exp_f32 v140, v140
    v_exp_f32 v141, v141
    v_exp_f32 v142, v142
    v_exp_f32 v143, v143
    v_cvt_pk_bf16_f32 v172, v136, v137
    v_cvt_pk_bf16_f32 v173, v138, v139
    v_cvt_pk_bf16_f32 v174, v140, v141
    v_cvt_pk_bf16_f32 v175, v142, v143
    s_nop 1
    v_mfma_f32_32x32x16_bf16 v[64:79], v[44:47], v[172:175], v[64:79]
Lob0_0:
    v_exp_f32 v144, v144
    v_exp_f32 v145, v145
    s_mov_b32 m0, s29
    s_add_u32 s29, s29, 3072
    buffer_load_dwordx4 v214, s[16:19], s96 offen offset:0 lds
    buffer_load_dwordx4 v240, s[16:19], s96 offen offset:1024 lds
    buffer_load_dwordx4 v241, s[16:19], s96 offen offset:2048 lds
    s_add_u32 s96, s96, 24576
    v_exp_f32 v146, v146
    v_exp_f32 v147, v147
    v_exp_f32 v148, v148
    v_exp_f32 v149, v149
    v_exp_f32 v150, v150
    v_exp_f32 v151, v151
    v_exp_f32 v152, v152
    v_cvt_pk_bf16_f32 v160, v144, v145
    v_cvt_pk_bf16_f32 v161, v146, v147
    v_cvt_pk_bf16_f32 v162, v148, v149
    v_cvt_pk_bf16_f32 v163, v150, v151
    s_waitcnt lgkmcnt(0)
    s_nop 0
    v_mfma_f32_32x32x16_bf16 v[64:79], v[32:35], v[160:163], v[64:79]
    v_exp_f32 v153, v153
    v_exp_f32 v154, v154
    v_exp_f32 v155, v155
    s_mov_b32 m0, s31
    s_add_u32 s31, s31, 2048
    buffer_load_dwordx4 v214, s[24:27], s30 offen offset:0 lds
    buffer_load_dwordx4 v240, s[24:27], s30 offen offset:1024 lds
    s_add_u32 s30, s30, 16384
    v_exp_f32 v156, v156
    v_exp_f32 v157, v157
    v_exp_f32 v158, v158
    v_exp_f32 v159, v159
    v_cvt_pk_bf16_f32 v164, v152, v153
    v_cvt_pk_bf16_f32 v165, v154, v155
    v_cvt_pk_bf16_f32 v166, v156, v157
    v_cvt_pk_bf16_f32 v167, v158, v159
    s_nop 1
    v_mfma_f32_32x32x16_bf16 v[64:79], v[36:39], v[164:167], v[64:79]
    s_branch L_own2
L_own1:
    s_nop 3
    v_mov_b32 v204, 0
    s_mov_b64 exec, 1
    buffer_load_dwordx4 v[200:203], v204, s[8:11], s62 offen sc1
    s_mov_b64 exec, -1
    s_mov_b32 s3, 8
    s_add_u32 s4, s28, 8
    s_lshl_b32 s3, s3, 12
    s_lshl_b32 s4, s4, 12
    v_add_u32 v184, s3, v186
    v_add_u32 v185, s3, v187
    s_sub_u32 s5, s4, 4096
    v_add_u32 v188, s5, v186
    v_add_u32 v189, s4, v187
    ds_read_b128 v[180:183], v188
    s_mov_b64 exec, s[100:101]
    ds_read_b128 v[32:35], v189 offset:0
    ds_read_b128 v[36:39], v189 offset:1024
    s_mov_b64 exec, -1
    s_cmp_eq_u32 s57, 0
    s_cbranch_scc1 Loa1_0
Loa1_2:
    v_exp_f32 v112, v112
    v_exp_f32 v113, v113
    v_exp_f32 v114, v114
    v_exp_f32 v115, v115
    v_exp_f32 v116, v116
    s_waitcnt lgkmcnt(2)
    v_mfma_f32_32x32x16_bf16 v[144:159], v[180:183], v[192:195], v[80:95]
    ds_read_b128 v[176:179], v184 offset:0
    v_exp_f32 v117, v117
    v_exp_f32 v118, v118
    v_exp_f32 v119, v119
    v_exp_f32 v120, v120
    v_cvt_pk_bf16_f32 v160, v112, v113
    v_cvt_pk_bf16_f32 v161, v114, v115
    v_cvt_pk_bf16_f32 v162, v116, v117
    v_cvt_pk_bf16_f32 v163, v118, v119
    s_waitcnt lgkmcnt(1)
    s_nop 0
    v_mfma_f32_32x32x16_bf16 v[48:63], v[32:35], v[160:163], v[48:63]
    s_mov_b64 exec, s[100:101]
    ds_read_b128 v[40:43], v185 offset:4096
    ds_read_b128 v[44:47], v185 offset:5120
    s_mov_b64 exec, -1
    v_exp_f32 v121, v121
    v_exp_f32 v122, v122
    v_exp_f32 v123, v123
    v_exp_f32 v124, v124
    v_exp_f32 v125, v125
    v_exp_f32 v126, v126
    v_exp_f32 v127, v127
    v_cvt_pk_bf16_f32 v164, v120, v121
    v_cvt_pk_bf16_f32 v165, v122, v123
    v_cvt_pk_bf16_f32 v166, v124, v125
    v_cvt_pk_bf16_f32 v167, v126, v127
    s_nop 1
    v_mfma_f32_32x32x16_bf16 v[48:63], v[36:39], v[164:167], v[48:63]
Loa1_1:
    v_exp_f32 v144, v144
    v_exp_f32 v145, v145
    v_exp_f32 v146, v146
    v_exp_f32 v147, v147
    v_exp_f32 v148, v148
    s_waitcnt lgkmcnt(2)
    v_mfma_f32_32x32x16_bf16 v[112:127], v[176:179], v[192:195], v[80:95]
    v_exp_f32 v149, v149
    v_exp_f32 v150, v150
    v_exp_f32 v151, v151
    v_exp_f32 v152, v152
    v_cvt_pk_bf16_f32 v168, v144, v145
    v_cvt_pk_bf16_f32 v169, v146, v147
    v_cvt_pk_bf16_f32 v170, v148, v149
    v_cvt_pk_bf16_f32 v171, v150, v151
    s_waitcnt lgkmcnt(0)
    s_nop 0
    v_mfma_f32_32x32x16_bf16 v[48:63], v[40:43], v[168:171], v[48:63]
    s_mov_b64 exec, s[100:101]
    ds_read_b128 v[32:35], v185 offset:0
    ds_read_b128 v[36:39], v185 offset:1024
    s_mov_b64 exec, -1
    v_exp_f32 v153, v153
    v_exp_f32 v154, v154
    v_exp_f32 v155, v155
    v_exp_f32 v156, v156
    v_exp_f32 v157, v157
    v_exp_f32 v158, v158
    v_exp_f32 v159, v159
    v_cvt_pk_bf16_f32 v172, v152, v153
    v_cvt_pk_bf16_f32 v173, v154, v155
    v_cvt_pk_bf16_f32 v174, v156, v157
    v_cvt_pk_bf16_f32 v175, v158, v159
    s_nop 1
    v_mfma_f32_32x32x16_bf16 v[48:63], v[44:47], v[172:175], v[48:63]
Loa1_0:
    v_exp_f32 v112, v112
    v_exp_f32 v113, v113
    v_exp_f32 v114, v114
    v_exp_f32 v115, v115
    v_exp_f32 v116, v116
    v_exp_f32 v117, v117
    v_exp_f32 v118, v118
    v_exp_f32 v119, v119
    v_exp_f32 v120, v120
    v_cvt_pk_bf16_f32 v160, v112, v113
    v_cvt_pk_bf16_f32 v161, v114, v115
    v_cvt_pk_bf16_f32 v162, v116, v117
    v_cvt_pk_bf16_f32 v163, v118, v119
    s_waitcnt lgkmcnt(0)
    s_nop 0
    v_mfma_f32_32x32x16_bf16 v[48:63], v[32:35], v[160:163], v[48:63]
    v_exp_f32 v121, v121
    v_exp_f32 v122, v122
    v_exp_f32 v123, v123
    v_exp_f32 v124, v124
    v_exp_f32 v125, v125
    v_exp_f32 v126, v126
    v_exp_f32 v127, v127
    v_cvt_pk_bf16_f32 v164, v120, v121
    v_cvt_pk_bf16_f32 v165, v122, v123
    v_cvt_pk_bf16_f32 v166, v124, v125
    v_cvt_pk_bf16_f32 v167, v126, v127
    s_nop 1
    v_mfma_f32_32x32x16_bf16 v[48:63], v[36:39], v[164:167], v[48:63]
    s_mov_b32 s3, 8
    s_add_u32 s4, s97, 8
    s_lshl_b32 s3, s3, 12
    s_lshl_b32 s4, s4, 12
    v_add_u32 v184, s3, v186
    v_add_u32 v185, s3, v187
    s_sub_u32 s5, s4, 4096
    v_add_u32 v188, s5, v186
    v_add_u32 v189, s4, v187
    ds_read_b128 v[176:179], v188
    s_mov_b64 exec, s[100:101]
    ds_read_b128 v[40:43], v189 offset:0
    ds_read_b128 v[44:47], v189 offset:1024
    s_mov_b64 exec, -1
    s_add_u32 s7, s51, s46
    s_waitcnt vmcnt(0)
    v_readfirstlane_b32 s3, v200
    v_readfirstlane_b32 s4, v201
    v_readfirstlane_b32 s5, v202
    v_readfirstlane_b32 s6, v203
    s_lshl_b32 s98, s3, 4
    s_xor_b32 s4, s4, s98
    s_lshl_b32 s98, s5, 4
    s_xor_b32 s6, s6, s98
    s_sub_u32 s3, s3, s7
    s_sub_u32 s5, s5, s7
    s_or_b32 s3, s3, s5
    s_xor_b32 s4, s4, 0x5bd1e990
    s_xor_b32 s6, s6, 0x5bd1e990
    s_or_b32 s4, s4, s6
    s_lshr_b32 s3, s3, 5
    s_lshr_b32 s4, s4, 4
    s_or_b32 s3, s3, s4
    s_or_b32 s3, s3, s99
    s_cmp_lg_u32 s3, 0
    s_cbranch_scc1 L_try1
    s_mov_b32 s98, m0
    s_lshl_b32 s3, s49, 2
    s_lshl_b32 s4, s48, 1
    s_add_u32 s3, s3, s4
    s_sub_i32 s3, s3, 8
    s_lshl_b32 s5, s3, 12
    s_lshl_b32 s4, s50, 18
    s_add_u32 s5, s5, s4
    s_lshl_b32 s4, s53, 22
    s_add_u32 s5, s5, s4
    s_add_u32 s5, s5, 14680064
    s_lshl_b32 s3, s48, 13
    s_add_u32 m0, s3, 114688
    s_nop 0
    buffer_load_dwordx4 v206, s[8:11], s5 offen offset:0 sc1 lds
    buffer_load_dwordx4 v206, s[8:11], s5 offen offset:1024 sc1 lds
    buffer_load_dwordx4 v206, s[8:11], s5 offen offset:2048 sc1 lds
    buffer_load_dwordx4 v206, s[8:11], s5 offen offset:3072 sc1 lds
    s_add_u32 s5, s5, 4096
    s_add_u32 m0, m0, 4096
    s_nop 0
    buffer_load_dwordx4 v206, s[8:11], s5 offen offset:0 sc1 lds
    buffer_load_dwordx4 v206, s[8:11], s5 offen offset:1024 sc1 lds
    buffer_load_dwordx4 v206, s[8:11], s5 offen offset:2048 sc1 lds
    buffer_load_dwordx4 v206, s[8:11], s5 offen offset:3072 sc1 lds
    s_mov_b32 m0, s98
    s_mov_b32 s99, 1
L_try1:
    s_cmp_lg_u32 s57, 0
    s_cbranch_scc1 Lob1_1
Lob1_3:
    v_exp_f32 v128, v128
    v_exp_f32 v129, v129
    v_exp_f32 v130, v130
    v_exp_f32 v131, v131
    v_exp_f32 v132, v132
    s_waitcnt lgkmcnt(2)
    v_mfma_f32_32x32x16_bf16 v[144:159], v[176:179], v[196:199], v[96:111]
    ds_read_b128 v[180:183], v184 offset:4096
    v_exp_f32 v133, v133
    v_exp_f32 v134, v134
    v_exp_f32 v135, v135
    v_exp_f32 v136, v136
    v_cvt_pk_bf16_f32 v168, v128, v129
    v_cvt_pk_bf16_f32 v169, v130, v131
    v_cvt_pk_bf16_f32 v170, v132, v133
    v_cvt_pk_bf16_f32 v171, v134, v135
    s_waitcnt lgkmcnt(1)
    s_nop 0
    v_mfma_f32_32x32x16_bf16 v[64:79], v[40:43], v[168:171], v[64:79]
    s_mov_b64 exec, s[100:101]
    ds_read_b128 v[32:35], v185 offset:8192
    ds_read_b128 v[36:39], v185 offset:9216
    s_mov_b64 exec, -1
    v_exp_f32 v137, v137
    v_exp_f32 v138, v138
    v_exp_f32 v139, v139
    v_exp_f32 v140, v140
    v_exp_f32 v141, v141
    v_exp_f32 v142, v142
    v_exp_f32 v143, v143
    v_cvt_pk_bf16_f32 v172, v136, v137
    v_cvt_pk_bf16_f32 v173, v138, v139
    v_cvt_pk_bf16_f32 v174, v140, v141
    v_cvt_pk_bf16_f32 v175, v142, v143
    s_nop 1
    v_mfma_f32_32x32x16_bf16 v[64:79], v[44:47], v[172:175], v[64:79]
Lob1_2:
    v_exp_f32 v144, v144
    v_exp_f32 v145, v145
    v_exp_f32 v146, v146
    v_exp_f32 v147, v147
    v_exp_f32 v148, v148
    s_waitcnt lgkmcnt(2)
    v_mfma_f32_32x32x16_bf16 v[128:143], v[180:183], v[196:199], v[96:111]
    ds_read_b128 v[176:179], v184 offset:0
    v_exp_f32 v149, v149
    v_exp_f32 v150, v150
    v_exp_f32 v151, v151
    v_exp_f32 v152, v152
    v_cvt_pk_bf16_f32 v160, v144, v145
    v_cvt_pk_bf16_f32 v161, v146, v147
    v_cvt_pk_bf16_f32 v162, v148, v149
    v_cvt_pk_bf16_f32 v163, v150, v151
    s_waitcnt lgkmcnt(1)
    s_nop 0
    v_mfma_f32_32x32x16_bf16 v[64:79], v[32:35], v[160:163], v[64:79]
    s_mov_b64 exec, s[100:101]
    ds_read_b128 v[40:43], v185 offset:4096
    ds_read_b128 v[44:47], v185 offset:5120
    s_mov_b64 exec, -1
    v_exp_f32 v153, v153
    v_exp_f32 v154, v154
    v_exp_f32 v155, v155
    v_exp_f32 v156, v156
    v_exp_f32 v157, v157
    v_exp_f32 v158, v158
    v_exp_f32 v159, v159
    v_cvt_pk_bf16_f32 v164, v152, v153
    v_cvt_pk_bf16_f32 v165, v154, v155
    v_cvt_pk_bf16_f32 v166, v156, v157
    v_cvt_pk_bf16_f32 v167, v158, v159
    s_nop 1
    v_mfma_f32_32x32x16_bf16 v[64:79], v[36:39], v[164:167], v[64:79]
Lob1_1:
    v_exp_f32 v128, v128
    v_exp_f32 v129, v129
    v_exp_f32 v130, v130
    v_exp_f32 v131, v131
    v_exp_f32 v132, v132
    s_waitcnt lgkmcnt(2)
    v_mfma_f32_32x32x16_bf16 v[144:159], v[176:179], v[196:199], v[96:111]
    v_exp_f32 v133, v133
    v_exp_f32 v134, v134
    v_exp_f32 v135, v135
    v_exp_f32 v136, v136
    v_cvt_pk_bf16_f32 v168, v128, v129
    v_cvt_pk_bf16_f32 v169, v130, v131
    v_cvt_pk_bf16_f32 v170, v132, v133
    v_cvt_pk_bf16_f32 v171, v134, v135
    s_waitcnt lgkmcnt(0)
    s_nop 0
    v_mfma_f32_32x32x16_bf16 v[64:79], v[40:43], v[168:171], v[64:79]
    s_mov_b64 exec, s[100:101]
    ds_read_b128 v[32:35], v185 offset:0
    ds_read_b128 v[36:39], v185 offset:1024
    s_mov_b64 exec, -1
    v_exp_f32 v137, v137
    v_exp_f32 v138, v138
    v_exp_f32 v139, v139
    v_exp_f32 v140, v140
    v_exp_f32 v141, v141
    v_exp_f32 v142, v142
    v_exp_f32 v143, v143
    v_cvt_pk_bf16_f32 v172, v136, v137
    v_cvt_pk_bf16_f32 v173, v138, v139
    v_cvt_pk_bf16_f32 v174, v140, v141
    v_cvt_pk_bf16_f32 v175, v142, v143
    s_nop 1
    v_mfma_f32_32x32x16_bf16 v[64:79], v[44:47], v[172:175], v[64:79]
Lob1_0:
    v_exp_f32 v144, v144
    v_exp_f32 v145, v145
    v_exp_f32 v146, v146
    v_exp_f32 v147, v147
    v_exp_f32 v148, v148
    v_exp_f32 v149, v149
    v_exp_f32 v150, v150
    v_exp_f32 v151, v151
    v_exp_f32 v152, v152
    v_cvt_pk_bf16_f32 v160, v144, v145
    v_cvt_pk_bf16_f32 v161, v146, v147
    v_cvt_pk_bf16_f32 v162, v148, v149
    v_cvt_pk_bf16_f32 v163, v150, v151
    s_waitcnt lgkmcnt(0)
    s_nop 0
    v_mfma_f32_32x32x16_bf16 v[64:79], v[32:35], v[160:163], v[64:79]
    v_exp_f32 v153, v153
    v_exp_f32 v154, v154
    v_exp_f32 v155, v155
    v_exp_f32 v156, v156
    v_exp_f32 v157, v157
    v_exp_f32 v158, v158
    v_exp_f32 v159, v159
    v_cvt_pk_bf16_f32 v164, v152, v153
    v_cvt_pk_bf16_f32 v165, v154, v155
    v_cvt_pk_bf16_f32 v166, v156, v157
    v_cvt_pk_bf16_f32 v167, v158, v159
    s_nop 1
    v_mfma_f32_32x32x16_bf16 v[64:79], v[36:39], v[164:167], v[64:79]
L_own2:
    s_cmp_eq_u32 s99, 0
    s_cbranch_scc1 L_kvlate
L_kvdone:
    s_mul_i32 s96, s48, 458752
    s_xor_b32 s5, s50, 3
    s_mul_i32 s5, s5, 224
    s_add_u32 s96, s96, s5
    s_add_u32 s98, s96, 430080
    s_mul_i32 s3, s48, 28672
    s_mov_b32 m0, s3
    s_waitcnt vmcnt(0)
    s_cmp_lg_u32 s53, 0
    s_cbranch_scc1 Ll0_6
    v_lshrrev_b32 v200, 5, v207
    v_lshlrev_b32 v200, 9, v200
    v_sub_u32 v200, v215, v200
    v_add_u32 v200, s3, v200
    v_xor_b32 v201, 64, v200
    ds_read_b64_tr_b16 a[224:225], v200 offset:0
    ds_read_b64_tr_b16 a[226:227], v200 offset:1024
    ds_read_b64_tr_b16 a[228:229], v201 offset:0
    ds_read_b64_tr_b16 a[230:231], v201 offset:1024
    ds_read_b64_tr_b16 a[232:233], v200 offset:2048
    ds_read_b64_tr_b16 a[234:235], v200 offset:3072
    ds_read_b64_tr_b16 a[236:237], v201 offset:2048
    ds_read_b64_tr_b16 a[238:239], v201 offset:3072
    s_waitcnt lgkmcnt(7)
    ds_read_b64_tr_b16 a[240:241], v200 offset:4096
    ds_read_b64_tr_b16 a[242:243], v200 offset:5120
    ds_read_b64_tr_b16 a[244:245], v201 offset:4096
    ds_read_b64_tr_b16 a[246:247], v201 offset:5120
    ds_read_b64_tr_b16 a[248:249], v200 offset:6144
    ds_read_b64_tr_b16 a[250:251], v200 offset:7168
    ds_read_b64_tr_b16 a[252:253], v201 offset:6144
    ds_read_b64_tr_b16 a[254:255], v201 offset:7168
    s_waitcnt lgkmcnt(7)
    ds_read_b64_tr_b16 v[224:225], v200 offset:8192
    ds_read_b64_tr_b16 v[226:227], v200 offset:9216
    ds_read_b64_tr_b16 v[228:229], v201 offset:8192
    ds_read_b64_tr_b16 v[230:231], v201 offset:9216
    ds_read_b64_tr_b16 v[232:233], v200 offset:10240
    ds_read_b64_tr_b16 v[234:235], v200 offset:11264
    ds_read_b64_tr_b16 v[236:237], v201 offset:10240
    ds_read_b64_tr_b16 v[238:239], v201 offset:11264
    s_waitcnt lgkmcnt(7)
    ds_read_b64_tr_b16 v[240:241], v200 offset:12288
    ds_read_b64_tr_b16 v[242:243], v200 offset:13312
    ds_read_b64_tr_b16 v[244:245], v201 offset:12288
    ds_read_b64_tr_b16 v[246:247], v201 offset:13312
    ds_read_b64_tr_b16 v[248:249], v200 offset:14336
    ds_read_b64_tr_b16 v[250:251], v200 offset:15360
    ds_read_b64_tr_b16 v[252:253], v201 offset:14336
    ds_read_b64_tr_b16 v[254:255], v201 offset:15360
    s_waitcnt lgkmcnt(7)
    s_waitcnt lgkmcnt(0)
    v_add_u32 v200, s3, v215
    v_xor_b32 v201, 64, v200
    ds_read_b64_tr_b16 a[0:1], v200 offset:16384
    ds_read_b64_tr_b16 a[2:3], v200 offset:16896
    ds_read_b64_tr_b16 a[4:5], v201 offset:16384
    ds_read_b64_tr_b16 a[6:7], v201 offset:16896
    ds_read_b64_tr_b16 a[8:9], v200 offset:18432
    ds_read_b64_tr_b16 a[10:11], v200 offset:18944
    ds_read_b64_tr_b16 a[12:13], v201 offset:18432
    ds_read_b64_tr_b16 a[14:15], v201 offset:18944
    s_waitcnt lgkmcnt(7)
    ds_read_b64_tr_b16 a[16:17], v200 offset:20480
    ds_read_b64_tr_b16 a[18:19], v200 offset:20992
    ds_read_b64_tr_b16 a[20:21], v201 offset:20480
    ds_read_b64_tr_b16 a[22:23], v201 offset:20992
    ds_read_b64_tr_b16 a[24:25], v200 offset:22528
    ds_read_b64_tr_b16 a[26:27], v200 offset:23040
    ds_read_b64_tr_b16 a[28:29], v201 offset:22528
    ds_read_b64_tr_b16 a[30:31], v201 offset:23040
    s_waitcnt lgkmcnt(7)
    ds_read_b64_tr_b16 a[32:33], v200 offset:24576
    ds_read_b64_tr_b16 a[34:35], v200 offset:25088
    ds_read_b64_tr_b16 a[36:37], v201 offset:24576
    ds_read_b64_tr_b16 a[38:39], v201 offset:25088
    ds_read_b64_tr_b16 a[40:41], v200 offset:26624
    ds_read_b64_tr_b16 a[42:43], v200 offset:27136
    ds_read_b64_tr_b16 a[44:45], v201 offset:26624
    ds_read_b64_tr_b16 a[46:47], v201 offset:27136
    s_waitcnt lgkmcnt(7)
    s_waitcnt lgkmcnt(0)
Ll0_6:
    s_add_u32 s58, s58, 0x200000
    s_cmp_gt_u32 s53, s33
    s_cselect_b32 s58, 0x800000, s58
    s_barrier
    v_lshlrev_b32 v204, 5, v207
    s_lshl_b32 s3, s49, 9
    s_add_u32 s3, s3, 12288
    s_mov_b64 exec, 0xffff
    buffer_load_dwordx2 v[202:203], v204, s[8:11], s3 offen sc1
    s_mov_b64 exec, -1
    s_cmp_lt_u32 s49, 2
    s_cbranch_scc1 L_g01
    ds_read_b128 v[180:183], v186 offset:28672
    buffer_load_dwordx4 v190, s[20:23], s96 offen lds
    s_add_u32 s96, s96, 14336
    s_add_u32 m0, m0, 896
    s_waitcnt lgkmcnt(0)
    v_mfma_f32_32x32x16_bf16 v[112:127], v[180:183], v[192:195], v[80:95]
    v_mfma_f32_32x32x16_bf16 v[128:143], v[180:183], v[196:199], v[96:111]
    s_mov_b32 s3, s28
    s_mov_b32 s4, 7
    s_lshl_b32 s3, s3, 12
    s_lshl_b32 s4, s4, 12
    v_add_u32 v184, s3, v186
    v_add_u32 v185, s3, v187
    s_sub_u32 s5, s4, 4096
    v_add_u32 v188, s5, v186
    v_add_u32 v189, s4, v187
    ds_read_b128 v[176:179], v188
    s_mov_b64 exec, s[100:101]
    ds_read_b128 v[40:43], v189 offset:0
    ds_read_b128 v[44:47], v189 offset:1024
    s_mov_b64 exec, -1
    buffer_load_dwordx4 v190, s[20:23], s96 offen lds
    s_add_u32 s96, s96, 14336
    s_add_u32 m0, m0, 896
    s_cmp_lg_u32 s57, 0
    s_cbranch_scc1 Lfa_5
Lfa_7:
    v_exp_f32 v112, v112
    v_exp_f32 v113, v113
    buffer_load_dwordx4 v190, s[20:23], s96 offen lds
    s_add_u32 s96, s96, 14336
    s_add_u32 m0, m0, 896
    v_exp_f32 v114, v114
    v_exp_f32 v115, v115
    v_exp_f32 v116, v116
    s_waitcnt lgkmcnt(2)
    v_mfma_f32_32x32x16_bf16 v[144:159], v[176:179], v[192:195], v[80:95]
    ds_read_b128 v[180:183], v184 offset:20480
    v_exp_f32 v117, v117
    v_exp_f32 v118, v118
    v_exp_f32 v119, v119
    v_exp_f32 v120, v120
    v_cvt_pk_bf16_f32 v168, v112, v113
    v_cvt_pk_bf16_f32 v169, v114, v115
    v_cvt_pk_bf16_f32 v170, v116, v117
    v_cvt_pk_bf16_f32 v171, v118, v119
    s_waitcnt lgkmcnt(1)
    s_nop 0
    v_mfma_f32_32x32x16_bf16 v[48:63], v[40:43], v[168:171], v[48:63]
    s_mov_b64 exec, s[100:101]
    ds_read_b128 v[32:35], v185 offset:24576
    ds_read_b128 v[36:39], v185 offset:25600
    s_mov_b64 exec, -1
    v_exp_f32 v121, v121
    v_exp_f32 v122, v122
    v_exp_f32 v123, v123
    buffer_load_dwordx4 v190, s[20:23], s96 offen lds
    s_add_u32 s96, s96, 14336
    s_add_u32 m0, m0, 896
    v_exp_f32 v124, v124
    v_exp_f32 v125, v125
    v_exp_f32 v126, v126
    v_exp_f32 v127, v127
    v_cvt_pk_bf16_f32 v172, v120, v121
    v_cvt_pk_bf16_f32 v173, v122, v123
    v_cvt_pk_bf16_f32 v174, v124, v125
    v_cvt_pk_bf16_f32 v175, v126, v127
    s_nop 1
    v_mfma_f32_32x32x16_bf16 v[48:63], v[44:47], v[172:175], v[48:63]
Lfa_6:
    v_exp_f32 v144, v144
    v_exp_f32 v145, v145
    buffer_load_dwordx4 v190, s[20:23], s96 offen lds
    s_add_u32 s96, s96, 14336
    s_add_u32 m0, m0, 896
    v_exp_f32 v146, v146
    v_exp_f32 v147, v147
    v_exp_f32 v148, v148
    s_waitcnt lgkmcnt(2)
    v_mfma_f32_32x32x16_bf16 v[112:127], v[180:183], v[192:195], v[80:95]
    ds_read_b128 v[176:179], v184 offset:16384
    v_exp_f32 v149, v149
    v_exp_f32 v150, v150
    v_exp_f32 v151, v151
    v_exp_f32 v152, v152
    v_cvt_pk_bf16_f32 v160, v144, v145
    v_cvt_pk_bf16_f32 v161, v146, v147
    v_cvt_pk_bf16_f32 v162, v148, v149
    v_cvt_pk_bf16_f32 v163, v150, v151
    s_waitcnt lgkmcnt(1)
    s_nop 0
    v_mfma_f32_32x32x16_bf16 v[48:63], v[32:35], v[160:163], v[48:63]
    s_mov_b64 exec, s[100:101]
    ds_read_b128 v[40:43], v185 offset:20480
    ds_read_b128 v[44:47], v185 offset:21504
    s_mov_b64 exec, -1
    v_exp_f32 v153, v153
    v_exp_f32 v154, v154
    v_exp_f32 v155, v155
    buffer_load_dwordx4 v190, s[20:23], s96 offen lds
    s_add_u32 s96, s96, 14336
    s_add_u32 m0, m0, 896
    v_exp_f32 v156, v156
    v_exp_f32 v157, v157
    v_exp_f32 v158, v158
    v_exp_f32 v159, v159
    v_cvt_pk_bf16_f32 v164, v152, v153
    v_cvt_pk_bf16_f32 v165, v154, v155
    v_cvt_pk_bf16_f32 v166, v156, v157
    v_cvt_pk_bf16_f32 v167, v158, v159
    s_nop 1
    v_mfma_f32_32x32x16_bf16 v[48:63], v[36:39], v[164:167], v[48:63]
Lfa_5:
    v_exp_f32 v112, v112
    v_exp_f32 v113, v113
    buffer_load_dwordx4 v190, s[20:23], s96 offen lds
    s_add_u32 s96, s96, 14336
    s_add_u32 m0, m0, 896
    v_exp_f32 v114, v114
    v_exp_f32 v115, v115
    v_exp_f32 v116, v116
    s_waitcnt lgkmcnt(2)
    v_mfma_f32_32x32x16_bf16 v[144:159], v[176:179], v[192:195], v[80:95]
    ds_read_b128 v[180:183], v184 offset:12288
    v_exp_f32 v117, v117
    v_exp_f32 v118, v118
    v_exp_f32 v119, v119
    v_exp_f32 v120, v120
    v_cvt_pk_bf16_f32 v168, v112, v113
    v_cvt_pk_bf16_f32 v169, v114, v115
    v_cvt_pk_bf16_f32 v170, v116, v117
    v_cvt_pk_bf16_f32 v171, v118, v119
    s_waitcnt lgkmcnt(1)
    s_nop 0
    v_mfma_f32_32x32x16_bf16 v[48:63], v[40:43], v[168:171], v[48:63]
    s_mov_b64 exec, s[100:101]
    ds_read_b128 v[32:35], v185 offset:16384
    ds_read_b128 v[36:39], v185 offset:17408
    s_mov_b64 exec, -1
    v_exp_f32 v121, v121
    v_exp_f32 v122, v122
    v_exp_f32 v123, v123
    buffer_load_dwordx4 v190, s[20:23], s96 offen lds
    s_add_u32 s96, s96, 14336
    s_add_u32 m0, m0, 896
    v_exp_f32 v124, v124
    v_exp_f32 v125, v125
    v_exp_f32 v126, v126
    v_exp_f32 v127, v127
    v_cvt_pk_bf16_f32 v172, v120, v121
    v_cvt_pk_bf16_f32 v173, v122, v123
    v_cvt_pk_bf16_f32 v174, v124, v125
    v_cvt_pk_bf16_f32 v175, v126, v127
    s_nop 1
    v_mfma_f32_32x32x16_bf16 v[48:63], v[44:47], v[172:175], v[48:63]
Lfa_4:
    v_exp_f32 v144, v144
    v_exp_f32 v145, v145
    buffer_load_dwordx4 v190, s[20:23], s96 offen lds
    s_add_u32 s96, s96, 14336
    s_add_u32 m0, m0, 896
    v_exp_f32 v146, v146
    v_exp_f32 v147, v147
    v_exp_f32 v148, v148
    s_waitcnt lgkmcnt(2)
    v_mfma_f32_32x32x16_bf16 v[112:127], v[180:183], v[192:195], v[80:95]
    ds_read_b128 v[176:179], v184 offset:8192
    v_exp_f32 v149, v149
    v_exp_f32 v150, v150
    v_exp_f32 v151, v151
    v_exp_f32 v152, v152
    v_cvt_pk_bf16_f32 v160, v144, v145
    v_cvt_pk_bf16_f32 v161, v146, v147
    v_cvt_pk_bf16_f32 v162, v148, v149
    v_cvt_pk_bf16_f32 v163, v150, v151
    s_waitcnt lgkmcnt(1)
    s_nop 0
    v_mfma_f32_32x32x16_bf16 v[48:63], v[32:35], v[160:163], v[48:63]
    s_mov_b64 exec, s[100:101]
    ds_read_b128 v[40:43], v185 offset:12288
    ds_read_b128 v[44:47], v185 offset:13312
    s_mov_b64 exec, -1
    v_exp_f32 v153, v153
    v_exp_f32 v154, v154
    v_exp_f32 v155, v155
    buffer_load_dwordx4 v190, s[20:23], s96 offen lds
    s_add_u32 s96, s96, 14336
    s_add_u32 m0, m0, 896
    v_exp_f32 v156, v156
    v_exp_f32 v157, v157
    v_exp_f32 v158, v158
    v_exp_f32 v159, v159
    v_cvt_pk_bf16_f32 v164, v152, v153
    v_cvt_pk_bf16_f32 v165, v154, v155
    v_cvt_pk_bf16_f32 v166, v156, v157
    v_cvt_pk_bf16_f32 v167, v158, v159
    s_nop 1
    v_mfma_f32_32x32x16_bf16 v[48:63], v[36:39], v[164:167], v[48:63]
Lfa_3:
    v_exp_f32 v112, v112
    v_exp_f32 v113, v113
    buffer_load_dwordx4 v190, s[20:23], s96 offen lds
    s_add_u32 s96, s96, 14336
    s_add_u32 m0, m0, 896
    v_exp_f32 v114, v114
    v_exp_f32 v115, v115
    v_exp_f32 v116, v116
    s_waitcnt lgkmcnt(2)
    v_mfma_f32_32x32x16_bf16 v[144:159], v[176:179], v[192:195], v[80:95]
    ds_read_b128 v[180:183], v184 offset:4096
    v_exp_f32 v117, v117
    v_exp_f32 v118, v118
    v_exp_f32 v119, v119
    v_exp_f32 v120, v120
    v_cvt_pk_bf16_f32 v168, v112, v113
    v_cvt_pk_bf16_f32 v169, v114, v115
    v_cvt_pk_bf16_f32 v170, v116, v117
    v_cvt_pk_bf16_f32 v171, v118, v119
    s_waitcnt lgkmcnt(1)
    s_nop 0
    v_mfma_f32_32x32x16_bf16 v[48:63], v[40:43], v[168:171], v[48:63]
    s_mov_b64 exec, s[100:101]
    ds_read_b128 v[32:35], v185 offset:8192
    ds_read_b128 v[36:39], v185 offset:9216
    s_mov_b64 exec, -1
    v_exp_f32 v121, v121
    v_exp_f32 v122, v122
    v_exp_f32 v123, v123
    buffer_load_dwordx4 v190, s[20:23], s96 offen lds
    s_add_u32 s96, s96, 14336
    s_add_u32 m0, m0, 896
    v_exp_f32 v124, v124
    v_exp_f32 v125, v125
    v_exp_f32 v126, v126
    v_exp_f32 v127, v127
    v_cvt_pk_bf16_f32 v172, v120, v121
    v_cvt_pk_bf16_f32 v173, v122, v123
    v_cvt_pk_bf16_f32 v174, v124, v125
    v_cvt_pk_bf16_f32 v175, v126, v127
    s_nop 1
    v_mfma_f32_32x32x16_bf16 v[48:63], v[44:47], v[172:175], v[48:63]
Lfa_2:
    v_exp_f32 v144, v144
    v_exp_f32 v145, v145
    buffer_load_dwordx4 v190, s[20:23], s96 offen lds
    s_add_u32 s96, s96, 14336
    s_add_u32 m0, m0, 896
    v_exp_f32 v146, v146
    v_exp_f32 v147, v147
    v_exp_f32 v148, v148
    s_waitcnt lgkmcnt(2)
    v_mfma_f32_32x32x16_bf16 v[112:127], v[180:183], v[192:195], v[80:95]
    ds_read_b128 v[176:179], v184 offset:0
    v_exp_f32 v149, v149
    v_exp_f32 v150, v150
    v_exp_f32 v151, v151
    v_exp_f32 v152, v152
    v_cvt_pk_bf16_f32 v160, v144, v145
    v_cvt_pk_bf16_f32 v161, v146, v147
    v_cvt_pk_bf16_f32 v162, v148, v149
    v_cvt_pk_bf16_f32 v163, v150, v151
    s_waitcnt lgkmcnt(1)
    s_nop 0
    v_mfma_f32_32x32x16_bf16 v[48:63], v[32:35], v[160:163], v[48:63]
    s_mov_b64 exec, s[100:101]
    ds_read_b128 v[40:43], v185 offset:4096
    ds_read_b128 v[44:47], v185 offset:5120
    s_mov_b64 exec, -1
    v_exp_f32 v153, v153
    v_exp_f32 v154, v154
    v_exp_f32 v155, v155
    buffer_load_dwordx4 v190, s[20:23], s96 offen lds
    s_add_u32 s96, s96, 14336
    s_add_u32 m0, m0, 896
    v_exp_f32 v156, v156
    v_exp_f32 v157, v157
    v_exp_f32 v158, v158
    v_exp_f32 v159, v159
    v_cvt_pk_bf16_f32 v164, v152, v153
    v_cvt_pk_bf16_f32 v165, v154, v155
    v_cvt_pk_bf16_f32 v166, v156, v157
    v_cvt_pk_bf16_f32 v167, v158, v159
    s_nop 1
    v_mfma_f32_32x32x16_bf16 v[48:63], v[36:39], v[164:167], v[48:63]
Lfa_1:
    v_exp_f32 v112, v112
    v_exp_f32 v113, v113
    buffer_load_dwordx4 v190, s[20:23], s96 offen lds
    s_add_u32 s96, s96, 14336
    s_add_u32 m0, m0, 896
    v_exp_f32 v114, v114
    v_exp_f32 v115, v115
    v_exp_f32 v116, v116
    v_pk_add_f32 v[144:145], v[80:81], v[16:17]
    v_pk_add_f32 v[146:147], v[82:83], v[18:19]
    v_pk_add_f32 v[148:149], v[84:85], v[20:21]
    v_pk_add_f32 v[150:151], v[86:87], v[22:23]
    v_pk_add_f32 v[152:153], v[88:89], v[24:25]
    v_pk_add_f32 v[154:155], v[90:91], v[26:27]
    v_pk_add_f32 v[156:157], v[92:93], v[28:29]
    v_pk_add_f32 v[158:159], v[94:95], v[30:31]
    s_waitcnt lgkmcnt(2)
    s_nop 0
    v_mfma_f32_32x32x16_bf16 v[144:159], v[176:179], v[192:195], v[144:159]
    v_exp_f32 v117, v117
    v_exp_f32 v118, v118
    v_exp_f32 v119, v119
    v_exp_f32 v120, v120
    v_cvt_pk_bf16_f32 v168, v112, v113
    v_cvt_pk_bf16_f32 v169, v114, v115
    v_cvt_pk_bf16_f32 v170, v116, v117
    v_cvt_pk_bf16_f32 v171, v118, v119
    s_waitcnt lgkmcnt(0)
    s_nop 0
    v_mfma_f32_32x32x16_bf16 v[48:63], v[40:43], v[168:171], v[48:63]
    s_mov_b64 exec, s[100:101]
    ds_read_b128 v[32:35], v185 offset:0
    ds_read_b128 v[36:39], v185 offset:1024
    s_mov_b64 exec, -1
    v_exp_f32 v121, v121
    v_exp_f32 v122, v122
    v_exp_f32 v123, v123
    buffer_load_dwordx4 v190, s[20:23], s96 offen lds
    s_add_u32 s96, s96, 14336
    s_add_u32 m0, m0, 896
    v_exp_f32 v124, v124
    v_exp_f32 v125, v125
    v_exp_f32 v126, v126
    v_exp_f32 v127, v127
    v_cvt_pk_bf16_f32 v172, v120, v121
    v_cvt_pk_bf16_f32 v173, v122, v123
    v_cvt_pk_bf16_f32 v174, v124, v125
    v_cvt_pk_bf16_f32 v175, v126, v127
    s_nop 1
    v_mfma_f32_32x32x16_bf16 v[48:63], v[44:47], v[172:175], v[48:63]
Lfa_0:
    v_exp_f32 v144, v144
    v_exp_f32 v145, v145
    buffer_load_dwordx4 v190, s[20:23], s96 offen lds
    s_add_u32 s96, s96, 14336
    s_add_u32 m0, m0, 896
    v_exp_f32 v146, v146
    v_exp_f32 v147, v147
    v_exp_f32 v148, v148
    v_exp_f32 v149, v149
    v_exp_f32 v150, v150
    v_exp_f32 v151, v151
    v_exp_f32 v152, v152
    v_cvt_pk_bf16_f32 v160, v144, v145
    v_cvt_pk_bf16_f32 v161, v146, v147
    v_cvt_pk_bf16_f32 v162, v148, v149
    v_cvt_pk_bf16_f32 v163, v150, v151
    s_waitcnt lgkmcnt(0)
    s_nop 0
    v_mfma_f32_32x32x16_bf16 v[48:63], v[32:35], v[160:163], v[48:63]
    v_exp_f32 v153, v153
    v_exp_f32 v154, v154
    v_exp_f32 v155, v155
    buffer_load_dwordx4 v190, s[20:23], s96 offen lds
    s_add_u32 s96, s96, 14336
    s_add_u32 m0, m0, 896
    v_exp_f32 v156, v156
    v_exp_f32 v157, v157
    v_exp_f32 v158, v158
    v_exp_f32 v159, v159
    v_cvt_pk_bf16_f32 v164, v152, v153
    v_cvt_pk_bf16_f32 v165, v154, v155
    v_cvt_pk_bf16_f32 v166, v156, v157
    v_cvt_pk_bf16_f32 v167, v158, v159
    s_nop 1
    v_mfma_f32_32x32x16_bf16 v[48:63], v[36:39], v[164:167], v[48:63]
    s_cmp_eq_u32 s49, 1
    s_cbranch_scc1 L_g1b
    s_mov_b32 s3, s97
    s_mov_b32 s4, 7
    s_lshl_b32 s3, s3, 12
    s_lshl_b32 s4, s4, 12
    v_add_u32 v184, s3, v186
    v_add_u32 v185, s3, v187
    s_sub_u32 s5, s4, 4096
    v_add_u32 v188, s5, v186
    v_add_u32 v189, s4, v187
    ds_read_b128 v[180:183], v188
    s_mov_b64 exec, s[100:101]
    ds_read_b128 v[32:35], v189 offset:0
    ds_read_b128 v[36:39], v189 offset:1024
    s_mov_b64 exec, -1
    s_cmp_eq_u32 s57, 0
    s_cbranch_scc1 Lfb_4
Lfb_6:
    v_exp_f32 v128, v128
    v_exp_f32 v129, v129
    buffer_load_dwordx4 v190, s[20:23], s96 offen lds
    s_add_u32 s96, s96, 14336
    s_add_u32 m0, m0, 896
    v_exp_f32 v130, v130
    v_exp_f32 v131, v131
    v_exp_f32 v132, v132
    s_waitcnt lgkmcnt(2)
    v_mfma_f32_32x32x16_bf16 v[144:159], v[180:183], v[196:199], v[96:111]
    ds_read_b128 v[176:179], v184 offset:16384
    v_exp_f32 v133, v133
    v_exp_f32 v134, v134
    v_exp_f32 v135, v135
    v_exp_f32 v136, v136
    v_cvt_pk_bf16_f32 v160, v128, v129
    v_cvt_pk_bf16_f32 v161, v130, v131
    v_cvt_pk_bf16_f32 v162, v132, v133
    v_cvt_pk_bf16_f32 v163, v134, v135
    s_waitcnt lgkmcnt(1)
    s_nop 0
    v_mfma_f32_32x32x16_bf16 v[64:79], v[32:35], v[160:163], v[64:79]
    s_mov_b64 exec, s[100:101]
    ds_read_b128 v[40:43], v185 offset:20480
    ds_read_b128 v[44:47], v185 offset:21504
    s_mov_b64 exec, -1
    v_exp_f32 v137, v137
    v_exp_f32 v138, v138
    v_exp_f32 v139, v139
    buffer_load_dwordx4 v190, s[20:23], s96 offen lds
    s_add_u32 s96, s96, 14336
    s_add_u32 m0, m0, 896
    v_exp_f32 v140, v140
    v_exp_f32 v141, v141
    v_exp_f32 v142, v142
    v_exp_f32 v143, v143
    v_cvt_pk_bf16_f32 v164, v136, v137
    v_cvt_pk_bf16_f32 v165, v138, v139
    v_cvt_pk_bf16_f32 v166, v140, v141
    v_cvt_pk_bf16_f32 v167, v142, v143
    s_nop 1
    v_mfma_f32_32x32x16_bf16 v[64:79], v[36:39], v[164:167], v[64:79]
Lfb_5:
    v_exp_f32 v144, v144
    v_exp_f32 v145, v145
    buffer_load_dwordx4 v190, s[20:23], s96 offen lds
    s_add_u32 s96, s96, 14336
    s_add_u32 m0, m0, 896
    v_exp_f32 v146, v146
    v_exp_f32 v147, v147
    v_exp_f32 v148, v148
    s_waitcnt lgkmcnt(2)
    v_mfma_f32_32x32x16_bf16 v[128:143], v[176:179], v[196:199], v[96:111]
    ds_read_b128 v[180:183], v184 offset:12288
    v_exp_f32 v149, v149
    v_exp_f32 v150, v150
    v_exp_f32 v151, v151
    v_exp_f32 v152, v152
    v_cvt_pk_bf16_f32 v168, v144, v145
    v_cvt_pk_bf16_f32 v169, v146, v147
    v_cvt_pk_bf16_f32 v170, v148, v149
    v_cvt_pk_bf16_f32 v171, v150, v151
    s_waitcnt lgkmcnt(1)
    s_nop 0
    v_mfma_f32_32x32x16_bf16 v[64:79], v[40:43], v[168:171], v[64:79]
    s_mov_b64 exec, s[100:101]
    ds_read_b128 v[32:35], v185 offset:16384
    ds_read_b128 v[36:39], v185 offset:17408
    s_mov_b64 exec, -1
    v_exp_f32 v153, v153
    v_exp_f32 v154, v154
    v_exp_f32 v155, v155
    buffer_load_dwordx4 v190, s[20:23], s96 offen lds
    s_add_u32 s96, s96, 14336
    s_add_u32 m0, m0, 896
    v_exp_f32 v156, v156
    v_exp_f32 v157, v157
    v_exp_f32 v158, v158
    v_exp_f32 v159, v159
    v_cvt_pk_bf16_f32 v172, v152, v153
    v_cvt_pk_bf16_f32 v173, v154, v155
    v_cvt_pk_bf16_f32 v174, v156, v157
    v_cvt_pk_bf16_f32 v175, v158, v159
    s_nop 1
    v_mfma_f32_32x32x16_bf16 v[64:79], v[44:47], v[172:175], v[64:79]
Lfb_4:
    v_exp_f32 v128, v128
    v_exp_f32 v129, v129
    buffer_load_dwordx4 v190, s[20:23], s96 offen lds
    s_add_u32 s96, s96, 14336
    s_add_u32 m0, m0, 896
    v_exp_f32 v130, v130
    v_exp_f32 v131, v131
    v_exp_f32 v132, v132
    s_waitcnt lgkmcnt(2)
    v_mfma_f32_32x32x16_bf16 v[144:159], v[180:183], v[196:199], v[96:111]
    ds_read_b128 v[176:179], v184 offset:8192
    v_exp_f32 v133, v133
    v_exp_f32 v134, v134
    v_exp_f32 v135, v135
    v_exp_f32 v136, v136
    v_cvt_pk_bf16_f32 v160, v128, v129
    v_cvt_pk_bf16_f32 v161, v130, v131
    v_cvt_pk_bf16_f32 v162, v132, v133
    v_cvt_pk_bf16_f32 v163, v134, v135
    s_waitcnt lgkmcnt(1)
    s_nop 0
    v_mfma_f32_32x32x16_bf16 v[64:79], v[32:35], v[160:163], v[64:79]
    s_mov_b64 exec, s[100:101]
    ds_read_b128 v[40:43], v185 offset:12288
    ds_read_b128 v[44:47], v185 offset:13312
    s_mov_b64 exec, -1
    v_exp_f32 v137, v137
    v_exp_f32 v138, v138
    v_exp_f32 v139, v139
    buffer_load_dwordx4 v190, s[20:23], s96 offen lds
    s_add_u32 s96, s96, 14336
    s_add_u32 m0, m0, 896
    v_exp_f32 v140, v140
    v_exp_f32 v141, v141
    v_exp_f32 v142, v142
    v_exp_f32 v143, v143
    v_cvt_pk_bf16_f32 v164, v136, v137
    v_cvt_pk_bf16_f32 v165, v138, v139
    v_cvt_pk_bf16_f32 v166, v140, v141
    v_cvt_pk_bf16_f32 v167, v142, v143
    s_nop 1
    v_mfma_f32_32x32x16_bf16 v[64:79], v[36:39], v[164:167], v[64:79]
Lfb_3:
    v_exp_f32 v144, v144
    v_exp_f32 v145, v145
    buffer_load_dwordx4 v190, s[20:23], s96 offen lds
    s_add_u32 s96, s96, 14336
    s_add_u32 m0, m0, 896
    v_exp_f32 v146, v146
    v_exp_f32 v147, v147
    v_exp_f32 v148, v148
    s_waitcnt lgkmcnt(2)
    v_mfma_f32_32x32x16_bf16 v[128:143], v[176:179], v[196:199], v[96:111]
    ds_read_b128 v[180:183], v184 offset:4096
    v_exp_f32 v149, v149
    v_exp_f32 v150, v150
    v_exp_f32 v151, v151
    v_exp_f32 v152, v152
    v_cvt_pk_bf16_f32 v168, v144, v145
    v_cvt_pk_bf16_f32 v169, v146, v147
    v_cvt_pk_bf16_f32 v170, v148, v149
    v_cvt_pk_bf16_f32 v171, v150, v151
    s_waitcnt lgkmcnt(1)
    s_nop 0
    v_mfma_f32_32x32x16_bf16 v[64:79], v[40:43], v[168:171], v[64:79]
    s_mov_b64 exec, s[100:101]
    ds_read_b128 v[32:35], v185 offset:8192
    ds_read_b128 v[36:39], v185 offset:9216
    s_mov_b64 exec, -1
    v_exp_f32 v153, v153
    v_exp_f32 v154, v154
    v_exp_f32 v155, v155
    buffer_load_dwordx4 v190, s[20:23], s96 offen lds
    s_add_u32 s96, s96, 14336
    s_add_u32 m0, m0, 896
    v_exp_f32 v156, v156
    v_exp_f32 v157, v157
    v_exp_f32 v158, v158
    v_exp_f32 v159, v159
    v_cvt_pk_bf16_f32 v172, v152, v153
    v_cvt_pk_bf16_f32 v173, v154, v155
    v_cvt_pk_bf16_f32 v174, v156, v157
    v_cvt_pk_bf16_f32 v175, v158, v159
    s_nop 1
    v_mfma_f32_32x32x16_bf16 v[64:79], v[44:47], v[172:175], v[64:79]
Lfb_2:
    v_exp_f32 v128, v128
    v_exp_f32 v129, v129
    buffer_load_dwordx4 v190, s[20:23], s96 offen lds
    s_add_u32 s96, s96, 14336
    s_add_u32 m0, m0, 896
    v_exp_f32 v130, v130
    v_exp_f32 v131, v131
    v_exp_f32 v132, v132
    s_waitcnt lgkmcnt(2)
    v_mfma_f32_32x32x16_bf16 v[144:159], v[180:183], v[196:199], v[96:111]
    ds_read_b128 v[176:179], v184 offset:0
    v_exp_f32 v133, v133
    v_exp_f32 v134, v134
    v_exp_f32 v135, v135
    v_exp_f32 v136, v136
    v_cvt_pk_bf16_f32 v160, v128, v129
    v_cvt_pk_bf16_f32 v161, v130, v131
    v_cvt_pk_bf16_f32 v162, v132, v133
    v_cvt_pk_bf16_f32 v163, v134, v135
    s_waitcnt lgkmcnt(1)
    s_nop 0
    v_mfma_f32_32x32x16_bf16 v[64:79], v[32:35], v[160:163], v[64:79]
    s_mov_b64 exec, s[100:101]
    ds_read_b128 v[40:43], v185 offset:4096
    ds_read_b128 v[44:47], v185 offset:5120
    s_mov_b64 exec, -1
    v_exp_f32 v137, v137
    v_exp_f32 v138, v138
    v_exp_f32 v139, v139
    buffer_load_dwordx4 v190, s[20:23], s96 offen lds
    s_add_u32 s96, s96, 14336
    s_add_u32 m0, m0, 896
    v_exp_f32 v140, v140
    v_exp_f32 v141, v141
    v_exp_f32 v142, v142
    v_exp_f32 v143, v143
    v_cvt_pk_bf16_f32 v164, v136, v137
    v_cvt_pk_bf16_f32 v165, v138, v139
    v_cvt_pk_bf16_f32 v166, v140, v141
    v_cvt_pk_bf16_f32 v167, v142, v143
    s_nop 1
    v_mfma_f32_32x32x16_bf16 v[64:79], v[36:39], v[164:167], v[64:79]
Lfb_1:
    v_exp_f32 v144, v144
    v_exp_f32 v145, v145
    buffer_load_dwordx4 v190, s[20:23], s96 offen lds
    s_add_u32 s96, s96, 14336
    s_add_u32 m0, m0, 896
    v_exp_f32 v146, v146
    v_exp_f32 v147, v147
    v_exp_f32 v148, v148
    v_pk_add_f32 v[128:129], v[96:97], v[16:17]
    v_pk_add_f32 v[130:131], v[98:99], v[18:19]
    v_pk_add_f32 v[132:133], v[100:101], v[20:21]
    v_pk_add_f32 v[134:135], v[102:103], v[22:23]
    v_pk_add_f32 v[136:137], v[104:105], v[24:25]
    v_pk_add_f32 v[138:139], v[106:107], v[26:27]
    v_pk_add_f32 v[140:141], v[108:109], v[28:29]
    v_pk_add_f32 v[142:143], v[110:111], v[30:31]
    s_waitcnt lgkmcnt(2)
    s_nop 0
    v_mfma_f32_32x32x16_bf16 v[128:143], v[176:179], v[196:199], v[128:143]
    v_exp_f32 v149, v149
    v_exp_f32 v150, v150
    v_exp_f32 v151, v151
    v_exp_f32 v152, v152
    v_cvt_pk_bf16_f32 v168, v144, v145
    v_cvt_pk_bf16_f32 v169, v146, v147
    v_cvt_pk_bf16_f32 v170, v148, v149
    v_cvt_pk_bf16_f32 v171, v150, v151
    s_waitcnt lgkmcnt(0)
    s_nop 0
    v_mfma_f32_32x32x16_bf16 v[64:79], v[40:43], v[168:171], v[64:79]
    s_mov_b64 exec, s[100:101]
    ds_read_b128 v[32:35], v185 offset:0
    ds_read_b128 v[36:39], v185 offset:1024
    s_mov_b64 exec, -1
    v_exp_f32 v153, v153
    v_exp_f32 v154, v154
    v_exp_f32 v155, v155
    buffer_load_dwordx4 v190, s[20:23], s96 offen lds
    s_add_u32 s96, s96, 14336
    s_add_u32 m0, m0, 896
    v_exp_f32 v156, v156
    v_exp_f32 v157, v157
    v_exp_f32 v158, v158
    v_exp_f32 v159, v159
    v_cvt_pk_bf16_f32 v172, v152, v153
    v_cvt_pk_bf16_f32 v173, v154, v155
    v_cvt_pk_bf16_f32 v174, v156, v157
    v_cvt_pk_bf16_f32 v175, v158, v159
    s_nop 1
    v_mfma_f32_32x32x16_bf16 v[64:79], v[44:47], v[172:175], v[64:79]
Lfb_0:
    v_exp_f32 v128, v128
    v_exp_f32 v129, v129
    v_exp_f32 v130, v130
    v_exp_f32 v131, v131
    v_exp_f32 v132, v132
    v_exp_f32 v133, v133
    v_exp_f32 v134, v134
    v_exp_f32 v135, v135
    v_exp_f32 v136, v136
    v_cvt_pk_bf16_f32 v160, v128, v129
    v_cvt_pk_bf16_f32 v161, v130, v131
    v_cvt_pk_bf16_f32 v162, v132, v133
    v_cvt_pk_bf16_f32 v163, v134, v135
    s_waitcnt lgkmcnt(0)
    s_nop 0
    v_mfma_f32_32x32x16_bf16 v[64:79], v[32:35], v[160:163], v[64:79]
    v_exp_f32 v137, v137
    v_exp_f32 v138, v138
    v_exp_f32 v139, v139
    v_exp_f32 v140, v140
    v_exp_f32 v141, v141
    v_exp_f32 v142, v142
    v_exp_f32 v143, v143
    v_cvt_pk_bf16_f32 v164, v136, v137
    v_cvt_pk_bf16_f32 v165, v138, v139
    v_cvt_pk_bf16_f32 v166, v140, v141
    v_cvt_pk_bf16_f32 v167, v142, v143
    s_nop 1
    v_mfma_f32_32x32x16_bf16 v[64:79], v[36:39], v[164:167], v[64:79]
L_nofor:
    s_waitcnt vmcnt(20)
    v_lshlrev_b32 v204, 4, v202
    v_subrev_u32 v202, s51, v202
    v_xor_b32 v203, 0x5bd1e990, v203
    v_cmp_gt_u32 vcc, 32, v202
    v_xor_b32 v203, v203, v204
    v_cmp_eq_u32 s[4:5], s52, v203
    s_nop 0
    s_and_b64 vcc, vcc, s[4:5]
    s_and_b32 s3, vcc_lo, 0xffff
    s_cmp_eq_u32 s3, 0xffff
    s_cselect_b32 s32, 1, s32
    s_lshl_b32 s3, s49, 17
    s_lshl_b32 s4, s50, 11
    s_add_u32 s3, s3, s4
    s_lshr_b32 s4, s48, 1
    s_lshl_b32 s4, s4, 10
    s_add_u32 s3, s3, s4
    s_lshl_b32 s4, s33, 21
    s_cmp_gt_u32 s53, s33
    s_cselect_b32 s4, 0xffa00000, s4
    s_add_u32 s3, s3, s4
    s_add_u32 s6, s3, 10485760
    v_mov_b32 v188, 0x5d800000
    s_nop 4
    v_cmp_nlt_f32 vcc, v56, v188
    s_nop 1
    s_cbranch_vccnz L_fb0
L_fbr0:
    v_rcp_f32 v200, v56
    s_lshl_b32 s4, s28, 15
    s_add_u32 s4, s4, s6
    v_pk_mul_f32 v[48:49], v[48:49], v[200:201] op_sel_hi:[1,0]
    v_pk_mul_f32 v[50:51], v[50:51], v[200:201] op_sel_hi:[1,0]
    v_pk_mul_f32 v[52:53], v[52:53], v[200:201] op_sel_hi:[1,0]
    v_pk_mul_f32 v[54:55], v[54:55], v[200:201] op_sel_hi:[1,0]
    v_cvt_pk_bf16_f32 v160, v48, v49
    v_cvt_pk_bf16_f32 v161, v50, v51
    v_cvt_pk_bf16_f32 v162, v52, v53
    v_cvt_pk_bf16_f32 v163, v54, v55
    s_cmp_lg_u32 s47, 0
    s_cbranch_scc1 Ldu_7
    buffer_store_dwordx4 v[160:163], v206, s[8:11], s4 offen sc1
    s_branch Ldv_8
Ldu_7:
    buffer_store_dwordx4 v[160:163], v206, s[8:11], s4 offen
Ldv_8:
    v_cmp_nlt_f32 vcc, v72, v188
    s_nop 1
    s_cbranch_vccnz L_fb1
L_fbr1:
    v_rcp_f32 v200, v72
    s_lshl_b32 s4, s97, 15
    s_add_u32 s4, s4, s6
    v_pk_mul_f32 v[64:65], v[64:65], v[200:201] op_sel_hi:[1,0]
    v_pk_mul_f32 v[66:67], v[66:67], v[200:201] op_sel_hi:[1,0]
    v_pk_mul_f32 v[68:69], v[68:69], v[200:201] op_sel_hi:[1,0]
    v_pk_mul_f32 v[70:71], v[70:71], v[200:201] op_sel_hi:[1,0]
    v_cvt_pk_bf16_f32 v164, v64, v65
    v_cvt_pk_bf16_f32 v165, v66, v67
    v_cvt_pk_bf16_f32 v166, v68, v69
    v_cvt_pk_bf16_f32 v167, v70, v71
    s_cmp_lg_u32 s47, 0
    s_cbranch_scc1 Ldu_9
    buffer_store_dwordx4 v[164:167], v206, s[8:11], s4 offen sc1
    s_branch Ldv_10
Ldu_9:
    buffer_store_dwordx4 v[164:167], v206, s[8:11], s4 offen
Ldv_10:
    buffer_load_dwordx4 v190, s[20:23], s96 offen lds
    s_add_u32 s96, s96, 14336
    s_add_u32 m0, m0, 896
    s_nop 0
    buffer_load_dwordx4 v190, s[20:23], s96 offen lds
    s_add_u32 s96, s96, 14336
    s_add_u32 m0, m0, 896
    s_nop 0
    buffer_load_dwordx4 v190, s[20:23], s96 offen lds
    s_add_u32 s96, s96, 14336
    s_add_u32 m0, m0, 896
    s_nop 0
    buffer_load_dwordx4 v190, s[20:23], s96 offen lds
    s_add_u32 s96, s96, 14336
    s_add_u32 m0, m0, 896
    s_nop 0
    buffer_load_dwordx4 v190, s[20:23], s96 offen lds
    s_add_u32 s96, s96, 14336
    s_add_u32 m0, m0, 896
    s_mov_b32 s4, -1
    s_mov_b32 s5, 0x00ffffff
    s_mov_b64 exec, s[4:5]
    buffer_load_dwordx4 v190, s[20:23], s96 offen lds
    s_mov_b64 exec, -1
    v_lshlrev_b32 v128, 16, v216
    v_and_b32 v129, 0xffff0000, v216
    v_lshlrev_b32 v130, 16, v217
    v_and_b32 v131, 0xffff0000, v217
    v_lshlrev_b32 v132, 16, v218
    v_and_b32 v133, 0xffff0000, v218
    v_lshlrev_b32 v134, 16, v219
    v_and_b32 v135, 0xffff0000, v219
    v_lshlrev_b32 v136, 16, v220
    v_and_b32 v137, 0xffff0000, v220
    v_lshlrev_b32 v138, 16, v221
    v_and_b32 v139, 0xffff0000, v221
    v_lshlrev_b32 v140, 16, v222
    v_and_b32 v141, 0xffff0000, v222
    v_lshlrev_b32 v142, 16, v223
    v_and_b32 v143, 0xffff0000, v223
    s_mul_i32 s3, s48, 12288
    s_add_u32 s3, s3, 114688
    v_add_u32 v192, s3, v206
    s_xor_b32 s3, s48, 1
    s_mul_i32 s3, s3, 12288
    s_add_u32 s3, s3, 114688
    v_add_u32 v193, s3, v206
    s_xor_b32 s3, s48, 2
    s_mul_i32 s3, s3, 12288
    s_add_u32 s3, s3, 118784
    v_add_u32 v194, s3, v206
    s_xor_b32 s3, s48, 3
    s_mul_i32 s3, s3, 12288
    s_add_u32 s3, s3, 122880
    v_add_u32 v195, s3, v206
    s_lshl_b32 s3, s55, 15
    s_lshl_b32 s4, s56, 10
    s_add_u32 s3, s3, s4
    s_cmp_eq_u32 s58, 0x800000
    s_cselect_b32 s4, 0x200000, s58
    s_add_u32 s4, s4, s3
    s_lshr_b32 s4, s4, 3
    s_add_u32 s3, s3, s58
    s_add_u32 s98, s3, 2097152
    s_add_u32 s99, s4, 1048576
    s_lshl_b32 s3, s55, 15
    s_lshl_b32 s4, s48, 13
    s_add_u32 s3, s3, s4
    s_lshl_b32 s4, s33, 21
    s_cmp_gt_u32 s53, s33
    s_cselect_b32 s4, 0xffa00000, s4
    s_add_u32 s3, s3, s4
    s_add_u32 s96, s3, 10485760
    s_xor_b32 s97, s96, 0x8000
    s_waitcnt vmcnt(6) lgkmcnt(0)
    s_barrier
    s_add_u32 s51, s51, 1
    s_cmp_lg_u32 s48, 0
    s_cbranch_scc1 Lpub_11
    v_mov_b32 v200, s51
    s_lshl_b32 s3, s51, 4
    s_xor_b32 s3, s3, 0x5bd1e990
    s_or_b32 s3, s3, s52
    v_mov_b32 v201, s3
    v_mov_b32 v202, 0
    s_mov_b64 exec, 1
    s_cmp_lg_u32 s32, 0
    s_cbranch_scc1 Ldu_12
    buffer_store_dwordx2 v[200:201], v202, s[8:11], s60 offen sc1
    s_branch Ldv_13
Ldu_12:
    buffer_store_dwordx2 v[200:201], v202, s[8:11], s60 offen
Ldv_13:
    s_mov_b64 exec, -1
Lpub_11:
    s_nop 1
    s_waitcnt vmcnt(0)
    s_cmp_lg_u32 s48, 0
    s_cbranch_scc1 Lpw_14
    v_mov_b32 v202, v206
    s_mov_b32 s3, s45
    s_mov_b64 exec, 0xffff
    s_mov_b32 s6, 0
Lpp_15:
    buffer_load_dwordx2 v[200:201], v202, s[8:11], s3 offen sc1
    s_add_u32 s6, s6, 1
    s_cmp_ge_u32 s6, 0x40000
    s_cbranch_scc1 Lpd_16
    s_waitcnt vmcnt(0)
    v_lshlrev_b32 v204, 4, v200
    v_subrev_u32 v200, s51, v200
    v_xor_b32 v201, 0x5bd1e990, v201
    v_cmp_gt_u32 vcc, 32, v200
    v_xor_b32 v201, v201, v204
    v_cmp_gt_u32 s[4:5], 16, v201
    s_nop 0
    s_and_b64 vcc, vcc, s[4:5]
    s_cmp_eq_u64 vcc, exec
    s_cbranch_scc0 Lpp_15
Lpd_16:
    s_waitcnt vmcnt(0)
    s_mov_b64 exec, -1
Lpw_14:
    s_barrier
    s_mov_b64 exec, 0xffff
    buffer_load_dword v196, v206, s[8:11], s45 offen offset:4 sc1
    s_mov_b64 exec, -1
    buffer_load_dwordx4 v[0:3], v206, s[8:11], s97 offen offset:0 sc1
    buffer_load_dwordx4 v[4:7], v206, s[8:11], s97 offen offset:1024 sc1
    buffer_load_dwordx4 v[8:11], v206, s[8:11], s97 offen offset:2048 sc1
    buffer_load_dwordx4 v[12:15], v206, s[8:11], s97 offen offset:3072 sc1
    s_add_u32 s97, s97, 4096
    buffer_load_dwordx4 v[16:19], v206, s[8:11], s97 offen offset:0 sc1
    buffer_load_dwordx4 v[20:23], v206, s[8:11], s97 offen offset:1024 sc1
    buffer_load_dwordx4 v[24:27], v206, s[8:11], s97 offen offset:2048 sc1
    buffer_load_dwordx4 v[28:31], v206, s[8:11], s97 offen offset:3072 sc1
    s_add_u32 s97, s97, 4096
    buffer_load_dwordx4 v[32:35], v206, s[8:11], s96 offen offset:0 sc1
    buffer_load_dwordx4 v[36:39], v206, s[8:11], s96 offen offset:1024 sc1
    s_cmp_lg_u32 s53, 0
    s_cbranch_scc1 Ll0_17
    v_mov_b32 v64, 0x3f803f80
    v_mov_b32 v65, 0x3f803f80
    v_mov_b32 v66, 0x3f803f80
    v_mov_b32 v67, 0x3f803f80
    s_lshl_b32 s3, s48, 6
    v_add_u32 v68, s3, v210
    v_add_u32 v69, 57344, v68
    ds_read_b64_tr_b16 v[80:81], v68 offset:0
    ds_read_b64_tr_b16 v[82:83], v68 offset:1792
    ds_read_b64_tr_b16 v[84:85], v68 offset:32
    ds_read_b64_tr_b16 v[86:87], v68 offset:1824
    ds_read_b64_tr_b16 v[88:89], v68 offset:7168
    ds_read_b64_tr_b16 v[90:91], v68 offset:8960
    ds_read_b64_tr_b16 v[92:93], v68 offset:7200
    ds_read_b64_tr_b16 v[94:95], v68 offset:8992
    ds_read_b64_tr_b16 v[96:97], v68 offset:14336
    ds_read_b64_tr_b16 v[98:99], v68 offset:16128
    ds_read_b64_tr_b16 v[100:101], v68 offset:14368
    ds_read_b64_tr_b16 v[102:103], v68 offset:16160
    s_waitcnt lgkmcnt(10)
    v_mfma_f32_16x16x32_bf16 v[72:75], v[64:67], v[80:83], 0
    ds_read_b64_tr_b16 v[80:81], v68 offset:21504
    ds_read_b64_tr_b16 v[82:83], v68 offset:23296
    s_waitcnt lgkmcnt(10)
    v_mfma_f32_16x16x32_bf16 v[76:79], v[64:67], v[84:87], 0
    ds_read_b64_tr_b16 v[84:85], v68 offset:21536
    ds_read_b64_tr_b16 v[86:87], v68 offset:23328
    s_waitcnt lgkmcnt(10)
    v_mfma_f32_16x16x32_bf16 v[72:75], v[64:67], v[88:91], v[72:75]
    ds_read_b64_tr_b16 v[88:89], v68 offset:28672
    ds_read_b64_tr_b16 v[90:91], v68 offset:30464
    s_waitcnt lgkmcnt(10)
    v_mfma_f32_16x16x32_bf16 v[76:79], v[64:67], v[92:95], v[76:79]
    ds_read_b64_tr_b16 v[92:93], v68 offset:28704
    ds_read_b64_tr_b16 v[94:95], v68 offset:30496
    s_waitcnt lgkmcnt(10)
    v_mfma_f32_16x16x32_bf16 v[72:75], v[64:67], v[96:99], v[72:75]
    ds_read_b64_tr_b16 v[96:97], v68 offset:35840
    ds_read_b64_tr_b16 v[98:99], v68 offset:37632
    s_waitcnt lgkmcnt(10)
    v_mfma_f32_16x16x32_bf16 v[76:79], v[64:67], v[100:103], v[76:79]
    ds_read_b64_tr_b16 v[100:101], v68 offset:35872
    ds_read_b64_tr_b16 v[102:103], v68 offset:37664
    s_waitcnt lgkmcnt(10)
    v_mfma_f32_16x16x32_bf16 v[72:75], v[64:67], v[80:83], v[72:75]
    ds_read_b64_tr_b16 v[80:81], v68 offset:43008
    ds_read_b64_tr_b16 v[82:83], v68 offset:44800
    s_waitcnt lgkmcnt(10)
    v_mfma_f32_16x16x32_bf16 v[76:79], v[64:67], v[84:87], v[76:79]
    ds_read_b64_tr_b16 v[84:85], v68 offset:43040
    ds_read_b64_tr_b16 v[86:87], v68 offset:44832
    s_waitcnt lgkmcnt(10)
    v_mfma_f32_16x16x32_bf16 v[72:75], v[64:67], v[88:91], v[72:75]
    ds_read_b64_tr_b16 v[88:89], v68 offset:50176
    ds_read_b64_tr_b16 v[90:91], v68 offset:51968
    s_waitcnt lgkmcnt(10)
    v_mfma_f32_16x16x32_bf16 v[76:79], v[64:67], v[92:95], v[76:79]
    ds_read_b64_tr_b16 v[92:93], v68 offset:50208
    ds_read_b64_tr_b16 v[94:95], v68 offset:52000
    s_waitcnt lgkmcnt(10)
    v_mfma_f32_16x16x32_bf16 v[72:75], v[64:67], v[96:99], v[72:75]
    ds_read_b64_tr_b16 v[96:97], v69 offset:0
    ds_read_b64_tr_b16 v[98:99], v69 offset:1792
    s_waitcnt lgkmcnt(10)
    v_mfma_f32_16x16x32_bf16 v[76:79], v[64:67], v[100:103], v[76:79]
    ds_read_b64_tr_b16 v[100:101], v69 offset:32
    ds_read_b64_tr_b16 v[102:103], v69 offset:1824
    s_waitcnt lgkmcnt(10)
    v_mfma_f32_16x16x32_bf16 v[72:75], v[64:67], v[80:83], v[72:75]
    ds_read_b64_tr_b16 v[80:81], v69 offset:7168
    ds_read_b64_tr_b16 v[82:83], v69 offset:8960
    s_waitcnt lgkmcnt(10)
    v_mfma_f32_16x16x32_bf16 v[76:79], v[64:67], v[84:87], v[76:79]
    ds_read_b64_tr_b16 v[84:85], v69 offset:7200
    ds_read_b64_tr_b16 v[86:87], v69 offset:8992
    s_waitcnt lgkmcnt(10)
    v_mfma_f32_16x16x32_bf16 v[72:75], v[64:67], v[88:91], v[72:75]
    ds_read_b64_tr_b16 v[88:89], v69 offset:14336
    ds_read_b64_tr_b16 v[90:91], v69 offset:16128
    s_waitcnt lgkmcnt(10)
    v_mfma_f32_16x16x32_bf16 v[76:79], v[64:67], v[92:95], v[76:79]
    ds_read_b64_tr_b16 v[92:93], v69 offset:14368
    ds_read_b64_tr_b16 v[94:95], v69 offset:16160
    s_waitcnt lgkmcnt(10)
    v_mfma_f32_16x16x32_bf16 v[72:75], v[64:67], v[96:99], v[72:75]
    ds_read_b64_tr_b16 v[96:97], v69 offset:21504
    ds_read_b64_tr_b16 v[98:99], v69 offset:23296
    s_waitcnt lgkmcnt(10)
    v_mfma_f32_16x16x32_bf16 v[76:79], v[64:67], v[100:103], v[76:79]
    ds_read_b64_tr_b16 v[100:101], v69 offset:21536
    ds_read_b64_tr_b16 v[102:103], v69 offset:23328
    s_waitcnt lgkmcnt(10)
    v_mfma_f32_16x16x32_bf16 v[72:75], v[64:67], v[80:83], v[72:75]
    ds_read_b64_tr_b16 v[80:81], v69 offset:28672
    ds_read_b64_tr_b16 v[82:83], v69 offset:30464
    s_waitcnt lgkmcnt(10)
    v_mfma_f32_16x16x32_bf16 v[76:79], v[64:67], v[84:87], v[76:79]
    ds_read_b64_tr_b16 v[84:85], v69 offset:28704
    ds_read_b64_tr_b16 v[86:87], v69 offset:30496
    s_waitcnt lgkmcnt(10)
    v_mfma_f32_16x16x32_bf16 v[72:75], v[64:67], v[88:91], v[72:75]
    ds_read_b64_tr_b16 v[88:89], v69 offset:35840
    ds_read_b64_tr_b16 v[90:91], v69 offset:37632
    s_waitcnt lgkmcnt(10)
    v_mfma_f32_16x16x32_bf16 v[76:79], v[64:67], v[92:95], v[76:79]
    ds_read_b64_tr_b16 v[92:93], v69 offset:35872
    ds_read_b64_tr_b16 v[94:95], v69 offset:37664
    s_waitcnt lgkmcnt(10)
    v_mfma_f32_16x16x32_bf16 v[72:75], v[64:67], v[96:99], v[72:75]
    ds_read_b64_tr_b16 v[96:97], v69 offset:43008
    ds_read_b64_tr_b16 v[98:99], v69 offset:44800
    s_waitcnt lgkmcnt(10)
    v_mfma_f32_16x16x32_bf16 v[76:79], v[64:67], v[100:103], v[76:79]
    ds_read_b64_tr_b16 v[100:101], v69 offset:43040
    ds_read_b64_tr_b16 v[102:103], v69 offset:44832
    s_waitcnt lgkmcnt(10)
    v_mfma_f32_16x16x32_bf16 v[72:75], v[64:67], v[80:83], v[72:75]
    ds_read_b64_tr_b16 v[80:81], v69 offset:50176
    ds_read_b64_tr_b16 v[82:83], v69 offset:51968
    s_waitcnt lgkmcnt(10)
    v_mfma_f32_16x16x32_bf16 v[76:79], v[64:67], v[84:87], v[76:79]
    ds_read_b64_tr_b16 v[84:85], v69 offset:50208
    ds_read_b64_tr_b16 v[86:87], v69 offset:52000
    s_waitcnt lgkmcnt(10)
    v_mfma_f32_16x16x32_bf16 v[72:75], v[64:67], v[88:91], v[72:75]
    s_waitcnt lgkmcnt(8)
    v_mfma_f32_16x16x32_bf16 v[76:79], v[64:67], v[92:95], v[76:79]
    s_waitcnt lgkmcnt(6)
    v_mfma_f32_16x16x32_bf16 v[72:75], v[64:67], v[96:99], v[72:75]
    s_waitcnt lgkmcnt(4)
    v_mfma_f32_16x16x32_bf16 v[76:79], v[64:67], v[100:103], v[76:79]
    s_waitcnt lgkmcnt(2)
    v_mfma_f32_16x16x32_bf16 v[72:75], v[64:67], v[80:83], v[72:75]
    s_waitcnt lgkmcnt(0)
    v_mfma_f32_16x16x32_bf16 v[76:79], v[64:67], v[84:87], v[76:79]
Ll0_17:
    buffer_load_dwordx4 v[40:43], v206, s[8:11], s96 offen offset:2048 sc1
    s_waitcnt vmcnt(10)
    v_mfma_f32_32x32x16_bf16 v[144:159], a[224:227], v[0:3], 0
    v_mfma_f32_32x32x16_bf16 v[176:191], a[228:231], v[0:3], 0
    buffer_load_dwordx4 v[44:47], v206, s[8:11], s96 offen offset:3072 sc1
    s_add_u32 s96, s96, 4096
    s_waitcnt vmcnt(10)
    v_mfma_f32_32x32x16_bf16 v[144:159], a[232:235], v[4:7], v[144:159]
    v_mfma_f32_32x32x16_bf16 v[176:191], a[236:239], v[4:7], v[176:191]
    buffer_load_dwordx4 v[48:51], v206, s[8:11], s96 offen offset:0 sc1
    s_waitcnt vmcnt(10)
    v_mfma_f32_32x32x16_bf16 v[144:159], a[240:243], v[8:11], v[144:159]
    v_mfma_f32_32x32x16_bf16 v[176:191], a[244:247], v[8:11], v[176:191]
    buffer_load_dwordx4 v[52:55], v206, s[8:11], s96 offen offset:1024 sc1
    s_waitcnt vmcnt(10)
    v_mfma_f32_32x32x16_bf16 v[144:159], a[248:251], v[12:15], v[144:159]
    v_mfma_f32_32x32x16_bf16 v[176:191], a[252:255], v[12:15], v[176:191]
    buffer_load_dwordx4 v[56:59], v206, s[8:11], s96 offen offset:2048 sc1
    s_waitcnt vmcnt(10)
    v_mfma_f32_32x32x16_bf16 v[144:159], v[224:227], v[16:19], v[144:159]
    v_mfma_f32_32x32x16_bf16 v[176:191], v[228:231], v[16:19], v[176:191]
    buffer_load_dwordx4 v[60:63], v206, s[8:11], s96 offen offset:3072 sc1
    s_add_u32 s96, s96, 4096
    s_waitcnt vmcnt(10)
    v_mfma_f32_32x32x16_bf16 v[144:159], v[232:235], v[20:23], v[144:159]
    v_mfma_f32_32x32x16_bf16 v[176:191], v[236:239], v[20:23], v[176:191]
    s_waitcnt vmcnt(9)
    v_mfma_f32_32x32x16_bf16 v[144:159], v[240:243], v[24:27], v[144:159]
    v_mfma_f32_32x32x16_bf16 v[176:191], v[244:247], v[24:27], v[176:191]
    s_waitcnt vmcnt(8)
    v_mfma_f32_32x32x16_bf16 v[144:159], v[248:251], v[28:31], v[144:159]
    v_mfma_f32_32x32x16_bf16 v[176:191], v[252:255], v[28:31], v[176:191]
    s_waitcnt vmcnt(7)
    v_mfma_f32_32x32x16_bf16 v[128:143], a[224:227], v[32:35], v[128:143]
    v_mfma_f32_32x32x16_bf16 v[160:175], a[228:231], v[32:35], 0
    s_waitcnt vmcnt(6)
    v_mfma_f32_32x32x16_bf16 v[128:143], a[232:235], v[36:39], v[128:143]
    v_mfma_f32_32x32x16_bf16 v[160:175], a[236:239], v[36:39], v[160:175]
    s_waitcnt vmcnt(5)
    v_mfma_f32_32x32x16_bf16 v[128:143], a[240:243], v[40:43], v[128:143]
    s_nop 2
    ds_write_b128 v192, v[144:147] offset:0
    v_mfma_f32_32x32x16_bf16 v[160:175], a[244:247], v[40:43], v[160:175]
    ds_write_b128 v192, v[148:151] offset:1024
    s_waitcnt vmcnt(4)
    v_mfma_f32_32x32x16_bf16 v[128:143], a[248:251], v[44:47], v[128:143]
    ds_write_b128 v192, v[152:155] offset:2048
    v_mfma_f32_32x32x16_bf16 v[160:175], a[252:255], v[44:47], v[160:175]
    ds_write_b128 v192, v[156:159] offset:3072
    s_waitcnt vmcnt(3)
    v_mfma_f32_32x32x16_bf16 v[128:143], v[224:227], v[48:51], v[128:143]
    ds_write_b128 v192, v[176:179] offset:8192
    v_mfma_f32_32x32x16_bf16 v[160:175], v[228:231], v[48:51], v[160:175]
    ds_write_b128 v192, v[180:183] offset:9216
    s_waitcnt vmcnt(2)
    v_mfma_f32_32x32x16_bf16 v[128:143], v[232:235], v[52:55], v[128:143]
    ds_write_b128 v192, v[184:187] offset:10240
    v_mfma_f32_32x32x16_bf16 v[160:175], v[236:239], v[52:55], v[160:175]
    ds_write_b128 v192, v[188:191] offset:11264
    s_waitcnt vmcnt(1)
    v_mfma_f32_32x32x16_bf16 v[128:143], v[240:243], v[56:59], v[128:143]
    v_mfma_f32_32x32x16_bf16 v[160:175], v[244:247], v[56:59], v[160:175]
    s_waitcnt vmcnt(0)
    v_mfma_f32_32x32x16_bf16 v[160:175], v[252:255], v[60:63], v[160:175]
    v_mfma_f32_32x32x16_bf16 v[128:143], v[248:251], v[60:63], v[128:143]
    s_cmp_lg_u32 s53, 0
    s_cbranch_scc1 Ll0_18
    s_lshl_b32 s3, s48, 7
    s_add_u32 s3, s3, s59
    v_permlane16_swap_b32 v72, v76
    s_mov_b32 s4, -1
    s_mov_b32 s5, 0
    s_mov_b64 exec, s[4:5]
    buffer_store_dword v72, v213, s[8:11], s3 offen offset:1024 sc1
    s_mov_b64 exec, -1
Ll0_18:
    v_and_b32 v196, 15, v196
    v_cmp_eq_u32 vcc, s52, v196
    s_nop 1
    s_and_b32 s3, vcc_lo, 0xffff
    s_cmp_eq_u32 s3, 0xffff
    s_cselect_b32 s32, 1, 0
    s_xor_b32 s3, s53, 1
    s_or_b32 s3, s3, s50
    s_cbranch_scc0 L_ep_o
L_ep_a:
    v_lshrrev_b32 v124, 4, v207
    v_lshlrev_b32 v125, 3, v124
    v_lshlrev_b32 v124, 4, v124
    s_xor_b32 s3, s50, 3
    s_mul_i32 s3, s3, 224
    buffer_load_dwordx2 v[94:95], v125, s[36:39], s3 offen offset:0
    buffer_load_dwordx2 v[98:99], v125, s[36:39], s3 offen offset:32
    ds_write_b128 v192, v[160:163] offset:4096
    buffer_load_dwordx2 v[102:103], v125, s[36:39], s3 offen offset:64
    ds_write_b128 v192, v[164:167] offset:5120
    buffer_load_dwordx2 v[106:107], v125, s[36:39], s3 offen offset:96
    ds_write_b128 v192, v[168:171] offset:6144
    buffer_load_dwordx2 v[110:111], v125, s[36:39], s3 offen offset:128
    ds_write_b128 v192, v[172:175] offset:7168
    buffer_load_dwordx2 v[114:115], v125, s[36:39], s3 offen offset:160
    buffer_load_dwordx2 v[118:119], v125, s[36:39], s3 offen offset:192
    s_waitcnt lgkmcnt(0)
    s_barrier
    ds_read_b128 v[144:147], v193 offset:0
    ds_read_b128 v[148:151], v193 offset:1024
    ds_read_b128 v[152:155], v193 offset:2048
    ds_read_b128 v[156:159], v193 offset:3072
    ds_read_b128 v[160:163], v194 offset:0
    ds_read_b128 v[164:167], v194 offset:1024
    ds_read_b128 v[168:171], v194 offset:2048
    ds_read_b128 v[172:175], v194 offset:3072
    ds_read_b128 v[176:179], v195 offset:0
    ds_read_b128 v[180:183], v195 offset:1024
    ds_read_b128 v[184:187], v195 offset:2048
    ds_read_b128 v[188:191], v195 offset:3072
    s_waitcnt lgkmcnt(8)
    v_pk_add_f32 v[128:129], v[128:129], v[144:145]
    v_pk_add_f32 v[130:131], v[130:131], v[146:147]
    v_pk_add_f32 v[132:133], v[132:133], v[148:149]
    v_pk_add_f32 v[134:135], v[134:135], v[150:151]
    v_pk_add_f32 v[136:137], v[136:137], v[152:153]
    v_pk_add_f32 v[138:139], v[138:139], v[154:155]
    v_pk_add_f32 v[140:141], v[140:141], v[156:157]
    v_pk_add_f32 v[142:143], v[142:143], v[158:159]
    s_waitcnt lgkmcnt(4)
    v_pk_add_f32 v[128:129], v[128:129], v[160:161]
    v_pk_add_f32 v[130:131], v[130:131], v[162:163]
    v_pk_add_f32 v[132:133], v[132:133], v[164:165]
    v_pk_add_f32 v[134:135], v[134:135], v[166:167]
    v_pk_add_f32 v[136:137], v[136:137], v[168:169]
    v_pk_add_f32 v[138:139], v[138:139], v[170:171]
    v_pk_add_f32 v[140:141], v[140:141], v[172:173]
    v_pk_add_f32 v[142:143], v[142:143], v[174:175]
    s_waitcnt lgkmcnt(0)
    v_pk_add_f32 v[128:129], v[128:129], v[176:177]
    v_pk_add_f32 v[130:131], v[130:131], v[178:179]
    v_pk_add_f32 v[132:133], v[132:133], v[180:181]
    v_pk_add_f32 v[134:135], v[134:135], v[182:183]
    v_pk_add_f32 v[136:137], v[136:137], v[184:185]
    v_pk_add_f32 v[138:139], v[138:139], v[186:187]
    v_pk_add_f32 v[140:141], v[140:141], v[188:189]
    v_pk_add_f32 v[142:143], v[142:143], v[190:191]
    v_cvt_pk_bf16_f32 v216, v128, v129
    v_cvt_pk_bf16_f32 v217, v130, v131
    v_cvt_pk_bf16_f32 v218, v132, v133
    v_cvt_pk_bf16_f32 v219, v134, v135
    v_cvt_pk_bf16_f32 v220, v136, v137
    v_cvt_pk_bf16_f32 v221, v138, v139
    v_cvt_pk_bf16_f32 v222, v140, v141
    v_cvt_pk_bf16_f32 v223, v142, v143
    s_cmp_lg_u32 s47, 0
    s_cbranch_scc1 Ldu_19
    buffer_store_dwordx4 v[216:219], v206, s[8:11], s98 offen sc1
    buffer_store_dwordx4 v[220:223], v206, s[8:11], s98 offen offset:1024 sc1
    s_branch Ldv_20
Ldu_19:
    buffer_store_dwordx4 v[216:219], v206, s[8:11], s98 offen
    buffer_store_dwordx4 v[220:223], v206, s[8:11], s98 offen offset:1024
Ldv_20:
    v_pk_add_f32 v[144:145], v[128:129], v[130:131]
    v_pk_mul_f32 v[146:147], v[128:129], v[128:129]
    v_pk_fma_f32 v[146:147], v[130:131], v[130:131], v[146:147]
    v_pk_add_f32 v[144:145], v[144:145], v[132:133]
    v_pk_fma_f32 v[146:147], v[132:133], v[132:133], v[146:147]
    v_pk_add_f32 v[144:145], v[144:145], v[134:135]
    v_pk_fma_f32 v[146:147], v[134:135], v[134:135], v[146:147]
    v_pk_add_f32 v[144:145], v[144:145], v[136:137]
    v_pk_fma_f32 v[146:147], v[136:137], v[136:137], v[146:147]
    v_pk_add_f32 v[144:145], v[144:145], v[138:139]
    v_pk_fma_f32 v[146:147], v[138:139], v[138:139], v[146:147]
    v_pk_add_f32 v[144:145], v[144:145], v[140:141]
    v_pk_fma_f32 v[146:147], v[140:141], v[140:141], v[146:147]
    v_pk_add_f32 v[144:145], v[144:145], v[142:143]
    v_pk_fma_f32 v[146:147], v[142:143], v[142:143], v[146:147]
    v_add_f32 v144, v144, v145
    v_add_f32 v146, v146, v147
    s_nop 1
    v_permlane32_swap_b32 v144, v146
    v_add_f32 v144, v144, v146
    s_cmp_lg_u32 s47, 0
    s_cbranch_scc1 Ldu_21
    buffer_store_dword v144, v213, s[8:11], s99 offen sc1
    s_branch Ldv_22
Ldu_21:
    buffer_store_dword v144, v213, s[8:11], s99 offen
Ldv_22:
    s_lshl_b32 s96, s54, 15
    s_cmp_eq_u32 s58, 0x800000
    s_cselect_b32 s97, 0x200000, s58
    s_add_u32 s97, s97, s96
    s_lshr_b32 s97, s97, 3
    s_add_u32 s96, s96, s58
    s_add_u32 s96, s96, 2097152
    s_add_u32 s97, s97, 1048576
    v_add_u32 v126, 57344, v210
    v_add_u32 v122, 7168, v214
    s_mul_i32 s29, s48, 12288
    s_add_u32 s29, s29, 114688
    s_lshl_b32 s4, s33, 3
    s_sub_u32 s4, s4, s33
    s_lshl_b32 s4, s4, 20
    s_mul_i32 s3, s54, 114688
    s_add_u32 s3, s3, s4
    s_xor_b32 s4, s50, 3
    s_mul_i32 s4, s4, 7168
    s_add_u32 s3, s3, s4
    s_add_u32 s98, s3, 23068672
    s_waitcnt vmcnt(0) lgkmcnt(0)
    s_barrier
    s_add_u32 s51, s51, 1
    s_cmp_lg_u32 s48, 0
    s_cbranch_scc1 Lpub_23
    v_mov_b32 v200, s51
    s_lshl_b32 s3, s51, 4
    s_xor_b32 s3, s3, 0x5bd1e990
    s_or_b32 s3, s3, s52
    v_mov_b32 v201, s3
    v_mov_b32 v202, 0
    s_mov_b64 exec, 1
    s_cmp_lg_u32 s32, 0
    s_cbranch_scc1 Ldu_24
    buffer_store_dwordx2 v[200:201], v202, s[8:11], s44 offen sc1
    s_branch Ldv_25
Ldu_24:
    buffer_store_dwordx2 v[200:201], v202, s[8:11], s44 offen
Ldv_25:
    s_mov_b64 exec, -1
Lpub_23:
    s_nop 1
    s_cmp_lg_u32 s48, 0
    s_cbranch_scc1 Lpw_26
    v_mov_b32 v202, v206
    s_mov_b32 s3, s61
    s_mov_b64 exec, 0xffff
    s_mov_b32 s6, 0
Lpp_27:
    buffer_load_dwordx2 v[200:201], v202, s[8:11], s3 offen sc1
    s_add_u32 s6, s6, 1
    s_cmp_ge_u32 s6, 0x40000
    s_cbranch_scc1 Lpd_28
    s_waitcnt vmcnt(0)
    v_lshlrev_b32 v204, 4, v200
    v_subrev_u32 v200, s51, v200
    v_xor_b32 v201, 0x5bd1e990, v201
    v_cmp_gt_u32 vcc, 32, v200
    v_xor_b32 v201, v201, v204
    v_cmp_gt_u32 s[4:5], 16, v201
    s_nop 0
    s_and_b64 vcc, vcc, s[4:5]
    s_cmp_eq_u64 vcc, exec
    s_cbranch_scc0 Lpp_27
Lpd_28:
    s_waitcnt vmcnt(0)
    s_mov_b64 exec, -1
Lpw_26:
    s_barrier
    buffer_load_dwordx4 v[0:3], v212, s[8:11], s96 offen offset:0 sc1
    buffer_load_dwordx4 v[4:7], v212, s[8:11], s96 offen offset:256 sc1
    buffer_load_dwordx4 v[8:11], v212, s[8:11], s96 offen offset:2048 sc1
    buffer_load_dwordx4 v[12:15], v212, s[8:11], s96 offen offset:2304 sc1
    s_add_u32 s96, s96, 4096
    buffer_load_dwordx4 v[16:19], v212, s[8:11], s96 offen offset:0 sc1
    buffer_load_dwordx4 v[20:23], v212, s[8:11], s96 offen offset:256 sc1
    buffer_load_dwordx4 v[24:27], v212, s[8:11], s96 offen offset:2048 sc1
    buffer_load_dwordx4 v[28:31], v212, s[8:11], s96 offen offset:2304 sc1
    s_add_u32 s96, s96, 4096
    buffer_load_dwordx4 v[32:35], v212, s[8:11], s96 offen offset:0 sc1
    buffer_load_dwordx4 v[36:39], v212, s[8:11], s96 offen offset:256 sc1
    ds_read_b64_tr_b16 v[184:185], v210 offset:0
    ds_read_b64_tr_b16 v[186:187], v210 offset:1792
    ds_read_b64_tr_b16 v[188:189], v210 offset:32
    ds_read_b64_tr_b16 v[190:191], v210 offset:1824
    ds_read_b64_tr_b16 v[192:193], v210 offset:64
    ds_read_b64_tr_b16 v[194:195], v210 offset:1856
    v_add_u32 v200, s29, v215
    v_xor_b32 v201, 64, v200
    v_lshlrev_b32 v92, 16, v94
    v_and_b32 v93, 0xffff0000, v94
    v_lshlrev_b32 v94, 16, v95
    v_and_b32 v95, 0xffff0000, v95
    v_lshlrev_b32 v96, 16, v98
    v_and_b32 v97, 0xffff0000, v98
    v_lshlrev_b32 v98, 16, v99
    v_and_b32 v99, 0xffff0000, v99
    v_lshlrev_b32 v100, 16, v102
    v_and_b32 v101, 0xffff0000, v102
    v_lshlrev_b32 v102, 16, v103
    v_and_b32 v103, 0xffff0000, v103
    v_lshlrev_b32 v104, 16, v106
    v_and_b32 v105, 0xffff0000, v106
    v_lshlrev_b32 v106, 16, v107
    v_and_b32 v107, 0xffff0000, v107
    v_lshlrev_b32 v108, 16, v110
    v_and_b32 v109, 0xffff0000, v110
    v_lshlrev_b32 v110, 16, v111
    v_and_b32 v111, 0xffff0000, v111
    v_lshlrev_b32 v112, 16, v114
    v_and_b32 v113, 0xffff0000, v114
    v_lshlrev_b32 v114, 16, v115
    v_and_b32 v115, 0xffff0000, v115
    v_lshlrev_b32 v116, 16, v118
    v_and_b32 v117, 0xffff0000, v118
    v_lshlrev_b32 v118, 16, v119
    v_and_b32 v119, 0xffff0000, v119
    s_cmp_lg_u32 s53, 0
    s_cbranch_scc1 L_p4b
    s_waitcnt vmcnt(8) lgkmcnt(4)
    v_mfma_f32_16x16x32_bf16 v[128:131], v[184:187], v[0:3], 0
    ds_read_b64_tr_b16 v[196:197], v210 offset:96
    v_mfma_f32_16x16x32_bf16 v[132:135], v[184:187], v[4:7], 0
    ds_read_b64_tr_b16 v[198:199], v210 offset:1888
    s_waitcnt lgkmcnt(4)
    v_mfma_f32_16x16x32_bf16 v[136:139], v[188:191], v[0:3], 0
    ds_read_b64_tr_b16 v[184:185], v210 offset:128
    v_mfma_f32_16x16x32_bf16 v[140:143], v[188:191], v[4:7], 0
    ds_read_b64_tr_b16 v[186:187], v210 offset:1920
    buffer_load_dwordx4 v[40:43], v212, s[8:11], s96 offen offset:2048 sc1
    s_waitcnt lgkmcnt(4)
    v_mfma_f32_16x16x32_bf16 v[144:147], v[192:195], v[0:3], 0
    ds_read_b64_tr_b16 v[188:189], v210 offset:160
    v_mfma_f32_16x16x32_bf16 v[148:151], v[192:195], v[4:7], 0
    ds_read_b64_tr_b16 v[190:191], v210 offset:1952
    s_waitcnt lgkmcnt(4)
    v_mfma_f32_16x16x32_bf16 v[152:155], v[196:199], v[0:3], 0
    ds_read_b64_tr_b16 v[192:193], v210 offset:192
    v_mfma_f32_16x16x32_bf16 v[156:159], v[196:199], v[4:7], 0
    ds_read_b64_tr_b16 v[194:195], v210 offset:1984
    buffer_load_dwordx4 v[44:47], v212, s[8:11], s96 offen offset:2304 sc1
    s_add_u32 s96, s96, 4096
    s_waitcnt lgkmcnt(4)
    v_mfma_f32_16x16x32_bf16 v[160:163], v[184:187], v[0:3], 0
    ds_read_b64_tr_b16 v[196:197], v210 offset:7168
    v_mfma_f32_16x16x32_bf16 v[164:167], v[184:187], v[4:7], 0
    ds_read_b64_tr_b16 v[198:199], v210 offset:8960
    s_mov_b32 s31, s29
    s_mov_b32 m0, s31
    s_add_u32 s31, s31, 2048
    buffer_load_dwordx4 v214, s[24:27], s30 offen offset:0 lds
    buffer_load_dwordx4 v122, s[24:27], s30 offen offset:1024 lds
    s_add_u32 s30, s30, 16384
    s_waitcnt lgkmcnt(4)
    v_mfma_f32_16x16x32_bf16 v[168:171], v[188:191], v[0:3], 0
    ds_read_b64_tr_b16 v[184:185], v210 offset:7200
    v_mfma_f32_16x16x32_bf16 v[172:175], v[188:191], v[4:7], 0
    ds_read_b64_tr_b16 v[186:187], v210 offset:8992
    s_waitcnt lgkmcnt(4)
    v_mfma_f32_16x16x32_bf16 v[176:179], v[192:195], v[0:3], 0
    ds_read_b64_tr_b16 v[188:189], v210 offset:7232
    v_mfma_f32_16x16x32_bf16 v[180:183], v[192:195], v[4:7], 0
    ds_read_b64_tr_b16 v[190:191], v210 offset:9024
    s_waitcnt vmcnt(10) lgkmcnt(4)
    v_mfma_f32_16x16x32_bf16 v[128:131], v[196:199], v[8:11], v[128:131]
    ds_read_b64_tr_b16 v[192:193], v210 offset:7264
    v_mfma_f32_16x16x32_bf16 v[132:135], v[196:199], v[12:15], v[132:135]
    ds_read_b64_tr_b16 v[194:195], v210 offset:9056
    s_waitcnt lgkmcnt(4)
    v_mfma_f32_16x16x32_bf16 v[136:139], v[184:187], v[8:11], v[136:139]
    ds_read_b64_tr_b16 v[196:197], v210 offset:7296
    v_mfma_f32_16x16x32_bf16 v[140:143], v[184:187], v[12:15], v[140:143]
    ds_read_b64_tr_b16 v[198:199], v210 offset:9088
    buffer_load_dwordx4 v[0:3], v212, s[8:11], s96 offen offset:0 sc1
    s_waitcnt lgkmcnt(4)
    v_mfma_f32_16x16x32_bf16 v[144:147], v[188:191], v[8:11], v[144:147]
    ds_read_b64_tr_b16 v[184:185], v210 offset:7328
    v_mfma_f32_16x16x32_bf16 v[148:151], v[188:191], v[12:15], v[148:151]
    ds_read_b64_tr_b16 v[186:187], v210 offset:9120
    s_mov_b32 m0, s31
    s_add_u32 s31, s31, 2048
    buffer_load_dwordx4 v214, s[24:27], s30 offen offset:0 lds
    buffer_load_dwordx4 v122, s[24:27], s30 offen offset:1024 lds
    s_add_u32 s30, s30, 16384
    s_waitcnt lgkmcnt(4)
    v_mfma_f32_16x16x32_bf16 v[152:155], v[192:195], v[8:11], v[152:155]
    ds_read_b64_tr_b16 v[188:189], v210 offset:7360
    v_mfma_f32_16x16x32_bf16 v[156:159], v[192:195], v[12:15], v[156:159]
    ds_read_b64_tr_b16 v[190:191], v210 offset:9152
    buffer_load_dwordx4 v[4:7], v212, s[8:11], s96 offen offset:256 sc1
    s_waitcnt lgkmcnt(4)
    v_mfma_f32_16x16x32_bf16 v[160:163], v[196:199], v[8:11], v[160:163]
    ds_read_b64_tr_b16 v[192:193], v210 offset:14336
    v_mfma_f32_16x16x32_bf16 v[164:167], v[196:199], v[12:15], v[164:167]
    ds_read_b64_tr_b16 v[194:195], v210 offset:16128
    s_waitcnt lgkmcnt(4)
    v_mfma_f32_16x16x32_bf16 v[168:171], v[184:187], v[8:11], v[168:171]
    ds_read_b64_tr_b16 v[196:197], v210 offset:14368
    v_mfma_f32_16x16x32_bf16 v[172:175], v[184:187], v[12:15], v[172:175]
    ds_read_b64_tr_b16 v[198:199], v210 offset:16160
    s_waitcnt lgkmcnt(4)
    v_mfma_f32_16x16x32_bf16 v[176:179], v[188:191], v[8:11], v[176:179]
    ds_read_b64_tr_b16 v[184:185], v210 offset:14400
    v_mfma_f32_16x16x32_bf16 v[180:183], v[188:191], v[12:15], v[180:183]
    ds_read_b64_tr_b16 v[186:187], v210 offset:16192
    s_waitcnt vmcnt(12) lgkmcnt(4)
    v_mfma_f32_16x16x32_bf16 v[128:131], v[192:195], v[16:19], v[128:131]
    ds_read_b64_tr_b16 v[188:189], v210 offset:14432
    v_mfma_f32_16x16x32_bf16 v[132:135], v[192:195], v[20:23], v[132:135]
    ds_read_b64_tr_b16 v[190:191], v210 offset:16224
    s_mov_b32 m0, s31
    s_add_u32 s31, s31, 2048
    buffer_load_dwordx4 v214, s[24:27], s30 offen offset:0 lds
    buffer_load_dwordx4 v122, s[24:27], s30 offen offset:1024 lds
    s_add_u32 s30, s30, 16384
    s_waitcnt lgkmcnt(4)
    v_mfma_f32_16x16x32_bf16 v[136:139], v[196:199], v[16:19], v[136:139]
    ds_read_b64_tr_b16 v[192:193], v210 offset:14464
    v_mfma_f32_16x16x32_bf16 v[140:143], v[196:199], v[20:23], v[140:143]
    ds_read_b64_tr_b16 v[194:195], v210 offset:16256
    buffer_load_dwordx4 v[8:11], v212, s[8:11], s96 offen offset:2048 sc1
    s_waitcnt lgkmcnt(4)
    v_mfma_f32_16x16x32_bf16 v[144:147], v[184:187], v[16:19], v[144:147]
    ds_read_b64_tr_b16 v[196:197], v210 offset:14496
    v_mfma_f32_16x16x32_bf16 v[148:151], v[184:187], v[20:23], v[148:151]
    ds_read_b64_tr_b16 v[198:199], v210 offset:16288
    s_waitcnt lgkmcnt(4)
    v_mfma_f32_16x16x32_bf16 v[152:155], v[188:191], v[16:19], v[152:155]
    ds_read_b64_tr_b16 v[184:185], v210 offset:14528
    v_mfma_f32_16x16x32_bf16 v[156:159], v[188:191], v[20:23], v[156:159]
    ds_read_b64_tr_b16 v[186:187], v210 offset:16320
    buffer_load_dwordx4 v[12:15], v212, s[8:11], s96 offen offset:2304 sc1
    s_add_u32 s96, s96, 4096
    s_waitcnt lgkmcnt(4)
    v_mfma_f32_16x16x32_bf16 v[160:163], v[192:195], v[16:19], v[160:163]
    ds_read_b64_tr_b16 v[188:189], v210 offset:21504
    v_mfma_f32_16x16x32_bf16 v[164:167], v[192:195], v[20:23], v[164:167]
    ds_read_b64_tr_b16 v[190:191], v210 offset:23296
    s_waitcnt lgkmcnt(4)
    v_mfma_f32_16x16x32_bf16 v[168:171], v[196:199], v[16:19], v[168:171]
    ds_read_b64_tr_b16 v[192:193], v210 offset:21536
    v_mfma_f32_16x16x32_bf16 v[172:175], v[196:199], v[20:23], v[172:175]
    ds_read_b64_tr_b16 v[194:195], v210 offset:23328
    s_mov_b32 m0, s31
    s_add_u32 s31, s31, 2048
    buffer_load_dwordx4 v214, s[24:27], s30 offen offset:0 lds
    buffer_load_dwordx4 v122, s[24:27], s30 offen offset:1024 lds
    s_add_u32 s30, s30, 16384
    s_waitcnt lgkmcnt(4)
    v_mfma_f32_16x16x32_bf16 v[176:179], v[184:187], v[16:19], v[176:179]
    ds_read_b64_tr_b16 v[196:197], v210 offset:21568
    v_mfma_f32_16x16x32_bf16 v[180:183], v[184:187], v[20:23], v[180:183]
    ds_read_b64_tr_b16 v[198:199], v210 offset:23360
    s_waitcnt vmcnt(16) lgkmcnt(4)
    v_mfma_f32_16x16x32_bf16 v[128:131], v[188:191], v[24:27], v[128:131]
    ds_read_b64_tr_b16 v[184:185], v210 offset:21600
    v_mfma_f32_16x16x32_bf16 v[132:135], v[188:191], v[28:31], v[132:135]
    ds_read_b64_tr_b16 v[186:187], v210 offset:23392
    s_waitcnt lgkmcnt(4)
    v_mfma_f32_16x16x32_bf16 v[136:139], v[192:195], v[24:27], v[136:139]
    ds_read_b64_tr_b16 v[188:189], v210 offset:21632
    v_mfma_f32_16x16x32_bf16 v[140:143], v[192:195], v[28:31], v[140:143]
    ds_read_b64_tr_b16 v[190:191], v210 offset:23424
    buffer_load_dwordx4 v[16:19], v212, s[8:11], s96 offen offset:0 sc1
    s_waitcnt lgkmcnt(4)
    v_mfma_f32_16x16x32_bf16 v[144:147], v[196:199], v[24:27], v[144:147]
    ds_read_b64_tr_b16 v[192:193], v210 offset:21664
    v_mfma_f32_16x16x32_bf16 v[148:151], v[196:199], v[28:31], v[148:151]
    ds_read_b64_tr_b16 v[194:195], v210 offset:23456
    s_waitcnt lgkmcnt(4)
    v_mfma_f32_16x16x32_bf16 v[152:155], v[184:187], v[24:27], v[152:155]
    ds_read_b64_tr_b16 v[196:197], v210 offset:21696
    v_mfma_f32_16x16x32_bf16 v[156:159], v[184:187], v[28:31], v[156:159]
    ds_read_b64_tr_b16 v[198:199], v210 offset:23488
    buffer_load_dwordx4 v[20:23], v212, s[8:11], s96 offen offset:256 sc1
    s_mov_b32 m0, s31
    s_add_u32 s31, s31, 2048
    buffer_load_dwordx4 v214, s[24:27], s30 offen offset:0 lds
    buffer_load_dwordx4 v122, s[24:27], s30 offen offset:1024 lds
    s_add_u32 s30, s30, 16384
    s_waitcnt lgkmcnt(4)
    v_mfma_f32_16x16x32_bf16 v[160:163], v[188:191], v[24:27], v[160:163]
    ds_read_b64_tr_b16 v[184:185], v210 offset:28672
    v_mfma_f32_16x16x32_bf16 v[164:167], v[188:191], v[28:31], v[164:167]
    ds_read_b64_tr_b16 v[186:187], v210 offset:30464
    s_waitcnt lgkmcnt(4)
    v_mfma_f32_16x16x32_bf16 v[168:171], v[192:195], v[24:27], v[168:171]
    ds_read_b64_tr_b16 v[188:189], v210 offset:28704
    v_mfma_f32_16x16x32_bf16 v[172:175], v[192:195], v[28:31], v[172:175]
    ds_read_b64_tr_b16 v[190:191], v210 offset:30496
    s_waitcnt lgkmcnt(4)
    v_mfma_f32_16x16x32_bf16 v[176:179], v[196:199], v[24:27], v[176:179]
    ds_read_b64_tr_b16 v[192:193], v210 offset:28736
    v_mfma_f32_16x16x32_bf16 v[180:183], v[196:199], v[28:31], v[180:183]
    ds_read_b64_tr_b16 v[194:195], v210 offset:30528
    s_waitcnt vmcnt(18) lgkmcnt(4)
    v_mfma_f32_16x16x32_bf16 v[128:131], v[184:187], v[32:35], v[128:131]
    ds_read_b64_tr_b16 v[196:197], v210 offset:28768
    v_mfma_f32_16x16x32_bf16 v[132:135], v[184:187], v[36:39], v[132:135]
    ds_read_b64_tr_b16 v[198:199], v210 offset:30560
    s_waitcnt lgkmcnt(4)
    v_mfma_f32_16x16x32_bf16 v[136:139], v[188:191], v[32:35], v[136:139]
    ds_read_b64_tr_b16 v[184:185], v210 offset:28800
    v_mfma_f32_16x16x32_bf16 v[140:143], v[188:191], v[36:39], v[140:143]
    ds_read_b64_tr_b16 v[186:187], v210 offset:30592
    buffer_load_dwordx4 v[24:27], v212, s[8:11], s96 offen offset:2048 sc1
    s_mov_b32 m0, s31
    s_add_u32 s31, s31, 2048
    buffer_load_dwordx4 v214, s[24:27], s30 offen offset:0 lds
    buffer_load_dwordx4 v122, s[24:27], s30 offen offset:1024 lds
    s_add_u32 s30, s30, 16384
    s_waitcnt lgkmcnt(4)
    v_mfma_f32_16x16x32_bf16 v[144:147], v[192:195], v[32:35], v[144:147]
    ds_read_b64_tr_b16 v[188:189], v210 offset:28832
    v_mfma_f32_16x16x32_bf16 v[148:151], v[192:195], v[36:39], v[148:151]
    ds_read_b64_tr_b16 v[190:191], v210 offset:30624
    s_waitcnt lgkmcnt(4)
    v_mfma_f32_16x16x32_bf16 v[152:155], v[196:199], v[32:35], v[152:155]
    ds_read_b64_tr_b16 v[192:193], v210 offset:28864
    v_mfma_f32_16x16x32_bf16 v[156:159], v[196:199], v[36:39], v[156:159]
    ds_read_b64_tr_b16 v[194:195], v210 offset:30656
    buffer_load_dwordx4 v[28:31], v212, s[8:11], s96 offen offset:2304 sc1
    s_add_u32 s96, s96, 4096
    s_waitcnt lgkmcnt(4)
    v_mfma_f32_16x16x32_bf16 v[160:163], v[184:187], v[32:35], v[160:163]
    ds_read_b64_tr_b16 v[196:197], v210 offset:35840
    v_mfma_f32_16x16x32_bf16 v[164:167], v[184:187], v[36:39], v[164:167]
    ds_read_b64_tr_b16 v[198:199], v210 offset:37632
    s_waitcnt lgkmcnt(4)
    v_mfma_f32_16x16x32_bf16 v[168:171], v[188:191], v[32:35], v[168:171]
    ds_read_b64_tr_b16 v[184:185], v210 offset:35872
    v_mfma_f32_16x16x32_bf16 v[172:175], v[188:191], v[36:39], v[172:175]
    ds_read_b64_tr_b16 v[186:187], v210 offset:37664
    s_waitcnt lgkmcnt(4)
    v_mfma_f32_16x16x32_bf16 v[176:179], v[192:195], v[32:35], v[176:179]
    ds_read_b64_tr_b16 v[188:189], v210 offset:35904
    v_mfma_f32_16x16x32_bf16 v[180:183], v[192:195], v[36:39], v[180:183]
    ds_read_b64_tr_b16 v[190:191], v210 offset:37696
    s_waitcnt vmcnt(20) lgkmcnt(4)
    v_mfma_f32_16x16x32_bf16 v[128:131], v[196:199], v[40:43], v[128:131]
    ds_read_b64_tr_b16 v[192:193], v210 offset:35936
    v_mfma_f32_16x16x32_bf16 v[132:135], v[196:199], v[44:47], v[132:135]
    ds_read_b64_tr_b16 v[194:195], v210 offset:37728
    s_waitcnt lgkmcnt(4)
    v_mfma_f32_16x16x32_bf16 v[136:139], v[184:187], v[40:43], v[136:139]
    ds_read_b64_tr_b16 v[196:197], v210 offset:35968
    v_mfma_f32_16x16x32_bf16 v[140:143], v[184:187], v[44:47], v[140:143]
    ds_read_b64_tr_b16 v[198:199], v210 offset:37760
    buffer_load_dwordx4 v[32:35], v212, s[8:11], s96 offen offset:0 sc1
    s_waitcnt lgkmcnt(4)
    v_mfma_f32_16x16x32_bf16 v[144:147], v[188:191], v[40:43], v[144:147]
    ds_read_b64_tr_b16 v[184:185], v210 offset:36000
    v_mfma_f32_16x16x32_bf16 v[148:151], v[188:191], v[44:47], v[148:151]
    ds_read_b64_tr_b16 v[186:187], v210 offset:37792
    s_waitcnt lgkmcnt(4)
    v_mfma_f32_16x16x32_bf16 v[152:155], v[192:195], v[40:43], v[152:155]
    ds_read_b64_tr_b16 v[188:189], v210 offset:36032
    v_mfma_f32_16x16x32_bf16 v[156:159], v[192:195], v[44:47], v[156:159]
    ds_read_b64_tr_b16 v[190:191], v210 offset:37824
    buffer_load_dwordx4 v[36:39], v212, s[8:11], s96 offen offset:256 sc1
    s_waitcnt lgkmcnt(4)
    v_mfma_f32_16x16x32_bf16 v[160:163], v[196:199], v[40:43], v[160:163]
    ds_read_b64_tr_b16 v[192:193], v210 offset:43008
    v_mfma_f32_16x16x32_bf16 v[164:167], v[196:199], v[44:47], v[164:167]
    ds_read_b64_tr_b16 v[194:195], v210 offset:44800
    s_waitcnt lgkmcnt(4)
    v_mfma_f32_16x16x32_bf16 v[168:171], v[184:187], v[40:43], v[168:171]
    ds_read_b64_tr_b16 v[196:197], v210 offset:43040
    v_mfma_f32_16x16x32_bf16 v[172:175], v[184:187], v[44:47], v[172:175]
    ds_read_b64_tr_b16 v[198:199], v210 offset:44832
    s_waitcnt lgkmcnt(4)
    v_mfma_f32_16x16x32_bf16 v[176:179], v[188:191], v[40:43], v[176:179]
    ds_read_b64_tr_b16 v[184:185], v210 offset:43072
    v_mfma_f32_16x16x32_bf16 v[180:183], v[188:191], v[44:47], v[180:183]
    ds_read_b64_tr_b16 v[186:187], v210 offset:44864
    s_waitcnt vmcnt(16) lgkmcnt(4)
    v_mfma_f32_16x16x32_bf16 v[128:131], v[192:195], v[0:3], v[128:131]
    ds_read_b64_tr_b16 v[188:189], v210 offset:43104
    v_mfma_f32_16x16x32_bf16 v[132:135], v[192:195], v[4:7], v[132:135]
    ds_read_b64_tr_b16 v[190:191], v210 offset:44896
    s_waitcnt lgkmcnt(4)
    v_mfma_f32_16x16x32_bf16 v[136:139], v[196:199], v[0:3], v[136:139]
    ds_read_b64_tr_b16 v[192:193], v210 offset:43136
    v_mfma_f32_16x16x32_bf16 v[140:143], v[196:199], v[4:7], v[140:143]
    ds_read_b64_tr_b16 v[194:195], v210 offset:44928
    buffer_load_dwordx4 v[40:43], v212, s[8:11], s96 offen offset:2048 sc1
    s_waitcnt lgkmcnt(4)
    v_mfma_f32_16x16x32_bf16 v[144:147], v[184:187], v[0:3], v[144:147]
    ds_read_b64_tr_b16 v[196:197], v210 offset:43168
    v_mfma_f32_16x16x32_bf16 v[148:151], v[184:187], v[4:7], v[148:151]
    ds_read_b64_tr_b16 v[198:199], v210 offset:44960
    s_waitcnt lgkmcnt(4)
    v_mfma_f32_16x16x32_bf16 v[152:155], v[188:191], v[0:3], v[152:155]
    ds_read_b64_tr_b16 v[184:185], v210 offset:43200
    v_mfma_f32_16x16x32_bf16 v[156:159], v[188:191], v[4:7], v[156:159]
    ds_read_b64_tr_b16 v[186:187], v210 offset:44992
    buffer_load_dwordx4 v[44:47], v212, s[8:11], s96 offen offset:2304 sc1
    s_add_u32 s96, s96, 4096
    s_waitcnt lgkmcnt(4)
    v_mfma_f32_16x16x32_bf16 v[160:163], v[192:195], v[0:3], v[160:163]
    ds_read_b64_tr_b16 v[188:189], v210 offset:50176
    v_mfma_f32_16x16x32_bf16 v[164:167], v[192:195], v[4:7], v[164:167]
    ds_read_b64_tr_b16 v[190:191], v210 offset:51968
    s_waitcnt lgkmcnt(4)
    v_mfma_f32_16x16x32_bf16 v[168:171], v[196:199], v[0:3], v[168:171]
    ds_read_b64_tr_b16 v[192:193], v210 offset:50208
    v_mfma_f32_16x16x32_bf16 v[172:175], v[196:199], v[4:7], v[172:175]
    ds_read_b64_tr_b16 v[194:195], v210 offset:52000
    s_waitcnt lgkmcnt(4)
    v_mfma_f32_16x16x32_bf16 v[176:179], v[184:187], v[0:3], v[176:179]
    ds_read_b64_tr_b16 v[196:197], v210 offset:50240
    v_mfma_f32_16x16x32_bf16 v[180:183], v[184:187], v[4:7], v[180:183]
    ds_read_b64_tr_b16 v[198:199], v210 offset:52032
    s_waitcnt vmcnt(14) lgkmcnt(4)
    v_mfma_f32_16x16x32_bf16 v[128:131], v[188:191], v[8:11], v[128:131]
    ds_read_b64_tr_b16 v[184:185], v210 offset:50272
    v_mfma_f32_16x16x32_bf16 v[132:135], v[188:191], v[12:15], v[132:135]
    ds_read_b64_tr_b16 v[186:187], v210 offset:52064
    s_waitcnt lgkmcnt(4)
    v_mfma_f32_16x16x32_bf16 v[136:139], v[192:195], v[8:11], v[136:139]
    ds_read_b64_tr_b16 v[188:189], v210 offset:50304
    v_mfma_f32_16x16x32_bf16 v[140:143], v[192:195], v[12:15], v[140:143]
    ds_read_b64_tr_b16 v[190:191], v210 offset:52096
    buffer_load_dwordx4 v[0:3], v212, s[8:11], s96 offen offset:0 sc1
    s_waitcnt lgkmcnt(4)
    v_mfma_f32_16x16x32_bf16 v[144:147], v[196:199], v[8:11], v[144:147]
    ds_read_b64_tr_b16 v[192:193], v210 offset:50336
    v_mfma_f32_16x16x32_bf16 v[148:151], v[196:199], v[12:15], v[148:151]
    ds_read_b64_tr_b16 v[194:195], v210 offset:52128
    s_waitcnt lgkmcnt(4)
    v_mfma_f32_16x16x32_bf16 v[152:155], v[184:187], v[8:11], v[152:155]
    ds_read_b64_tr_b16 v[196:197], v210 offset:50368
    v_mfma_f32_16x16x32_bf16 v[156:159], v[184:187], v[12:15], v[156:159]
    ds_read_b64_tr_b16 v[198:199], v210 offset:52160
    buffer_load_dwordx4 v[4:7], v212, s[8:11], s96 offen offset:256 sc1
    s_waitcnt lgkmcnt(4)
    v_mfma_f32_16x16x32_bf16 v[160:163], v[188:191], v[8:11], v[160:163]
    ds_read_b64_tr_b16 v[184:185], v126 offset:0
    v_mfma_f32_16x16x32_bf16 v[164:167], v[188:191], v[12:15], v[164:167]
    ds_read_b64_tr_b16 v[186:187], v126 offset:1792
    s_waitcnt lgkmcnt(4)
    v_mfma_f32_16x16x32_bf16 v[168:171], v[192:195], v[8:11], v[168:171]
    ds_read_b64_tr_b16 v[188:189], v126 offset:32
    v_mfma_f32_16x16x32_bf16 v[172:175], v[192:195], v[12:15], v[172:175]
    ds_read_b64_tr_b16 v[190:191], v126 offset:1824
    s_waitcnt lgkmcnt(4)
    v_mfma_f32_16x16x32_bf16 v[176:179], v[196:199], v[8:11], v[176:179]
    ds_read_b64_tr_b16 v[192:193], v126 offset:64
    v_mfma_f32_16x16x32_bf16 v[180:183], v[196:199], v[12:15], v[180:183]
    ds_read_b64_tr_b16 v[194:195], v126 offset:1856
    s_waitcnt vmcnt(12) lgkmcnt(4)
    v_mfma_f32_16x16x32_bf16 v[128:131], v[184:187], v[16:19], v[128:131]
    ds_read_b64_tr_b16 v[196:197], v126 offset:96
    v_mfma_f32_16x16x32_bf16 v[132:135], v[184:187], v[20:23], v[132:135]
    ds_read_b64_tr_b16 v[198:199], v126 offset:1888
    s_waitcnt vmcnt(7)
    ds_read_b64_tr_b16 a[48:49], v200 offset:0
    ds_read_b64_tr_b16 a[50:51], v200 offset:512
    s_waitcnt lgkmcnt(6)
    v_mfma_f32_16x16x32_bf16 v[136:139], v[188:191], v[16:19], v[136:139]
    ds_read_b64_tr_b16 v[184:185], v126 offset:128
    v_mfma_f32_16x16x32_bf16 v[140:143], v[188:191], v[20:23], v[140:143]
    ds_read_b64_tr_b16 v[186:187], v126 offset:1920
    buffer_load_dwordx4 v[8:11], v212, s[8:11], s96 offen offset:2048 sc1
    ds_read_b64_tr_b16 a[52:53], v201 offset:0
    ds_read_b64_tr_b16 a[54:55], v201 offset:512
    s_waitcnt lgkmcnt(8)
    v_mfma_f32_16x16x32_bf16 v[144:147], v[192:195], v[16:19], v[144:147]
    ds_read_b64_tr_b16 v[188:189], v126 offset:160
    v_mfma_f32_16x16x32_bf16 v[148:151], v[192:195], v[20:23], v[148:151]
    ds_read_b64_tr_b16 v[190:191], v126 offset:1952
    ds_read_b64_tr_b16 a[56:57], v200 offset:2048
    ds_read_b64_tr_b16 a[58:59], v200 offset:2560
    s_waitcnt lgkmcnt(10)
    v_mfma_f32_16x16x32_bf16 v[152:155], v[196:199], v[16:19], v[152:155]
    ds_read_b64_tr_b16 v[192:193], v126 offset:192
    v_mfma_f32_16x16x32_bf16 v[156:159], v[196:199], v[20:23], v[156:159]
    ds_read_b64_tr_b16 v[194:195], v126 offset:1984
    buffer_load_dwordx4 v[12:15], v212, s[8:11], s96 offen offset:2304 sc1
    s_add_u32 s96, s96, 4096
    ds_read_b64_tr_b16 a[60:61], v201 offset:2048
    ds_read_b64_tr_b16 a[62:63], v201 offset:2560
    s_waitcnt lgkmcnt(10)
    v_mfma_f32_16x16x32_bf16 v[160:163], v[184:187], v[16:19], v[160:163]
    ds_read_b64_tr_b16 v[196:197], v126 offset:7168
    v_mfma_f32_16x16x32_bf16 v[164:167], v[184:187], v[20:23], v[164:167]
    ds_read_b64_tr_b16 v[198:199], v126 offset:8960
    ds_read_b64_tr_b16 a[64:65], v200 offset:4096
    ds_read_b64_tr_b16 a[66:67], v200 offset:4608
    s_waitcnt lgkmcnt(10)
    v_mfma_f32_16x16x32_bf16 v[168:171], v[188:191], v[16:19], v[168:171]
    ds_read_b64_tr_b16 v[184:185], v126 offset:7200
    v_mfma_f32_16x16x32_bf16 v[172:175], v[188:191], v[20:23], v[172:175]
    ds_read_b64_tr_b16 v[186:187], v126 offset:8992
    ds_read_b64_tr_b16 a[68:69], v201 offset:4096
    ds_read_b64_tr_b16 a[70:71], v201 offset:4608
    s_waitcnt lgkmcnt(10)
    v_mfma_f32_16x16x32_bf16 v[176:179], v[192:195], v[16:19], v[176:179]
    ds_read_b64_tr_b16 v[188:189], v126 offset:7232
    v_mfma_f32_16x16x32_bf16 v[180:183], v[192:195], v[20:23], v[180:183]
    ds_read_b64_tr_b16 v[190:191], v126 offset:9024
    ds_read_b64_tr_b16 a[72:73], v200 offset:6144
    ds_read_b64_tr_b16 a[74:75], v200 offset:6656
    s_waitcnt vmcnt(8) lgkmcnt(10)
    v_mfma_f32_16x16x32_bf16 v[128:131], v[196:199], v[24:27], v[128:131]
    ds_read_b64_tr_b16 v[192:193], v126 offset:7264
    v_mfma_f32_16x16x32_bf16 v[132:135], v[196:199], v[28:31], v[132:135]
    ds_read_b64_tr_b16 v[194:195], v126 offset:9056
    ds_read_b64_tr_b16 a[76:77], v201 offset:6144
    ds_read_b64_tr_b16 a[78:79], v201 offset:6656
    s_waitcnt lgkmcnt(10)
    v_mfma_f32_16x16x32_bf16 v[136:139], v[184:187], v[24:27], v[136:139]
    ds_read_b64_tr_b16 v[196:197], v126 offset:7296
    v_mfma_f32_16x16x32_bf16 v[140:143], v[184:187], v[28:31], v[140:143]
    ds_read_b64_tr_b16 v[198:199], v126 offset:9088
    buffer_load_dwordx4 v[16:19], v212, s[8:11], s96 offen offset:0 sc1
    ds_read_b64_tr_b16 a[80:81], v200 offset:8192
    ds_read_b64_tr_b16 a[82:83], v200 offset:8704
    s_waitcnt lgkmcnt(10)
    v_mfma_f32_16x16x32_bf16 v[144:147], v[188:191], v[24:27], v[144:147]
    ds_read_b64_tr_b16 v[184:185], v126 offset:7328
    v_mfma_f32_16x16x32_bf16 v[148:151], v[188:191], v[28:31], v[148:151]
    ds_read_b64_tr_b16 v[186:187], v126 offset:9120
    ds_read_b64_tr_b16 a[84:85], v201 offset:8192
    ds_read_b64_tr_b16 a[86:87], v201 offset:8704
    s_waitcnt lgkmcnt(10)
    v_mfma_f32_16x16x32_bf16 v[152:155], v[192:195], v[24:27], v[152:155]
    ds_read_b64_tr_b16 v[188:189], v126 offset:7360
    v_mfma_f32_16x16x32_bf16 v[156:159], v[192:195], v[28:31], v[156:159]
    ds_read_b64_tr_b16 v[190:191], v126 offset:9152
    buffer_load_dwordx4 v[20:23], v212, s[8:11], s96 offen offset:256 sc1
    ds_read_b64_tr_b16 a[88:89], v200 offset:10240
    ds_read_b64_tr_b16 a[90:91], v200 offset:10752
    s_waitcnt lgkmcnt(10)
    v_mfma_f32_16x16x32_bf16 v[160:163], v[196:199], v[24:27], v[160:163]
    ds_read_b64_tr_b16 v[192:193], v126 offset:14336
    v_mfma_f32_16x16x32_bf16 v[164:167], v[196:199], v[28:31], v[164:167]
    ds_read_b64_tr_b16 v[194:195], v126 offset:16128
    ds_read_b64_tr_b16 a[92:93], v201 offset:10240
    ds_read_b64_tr_b16 a[94:95], v201 offset:10752
    s_waitcnt lgkmcnt(10)
    v_mfma_f32_16x16x32_bf16 v[168:171], v[184:187], v[24:27], v[168:171]
    ds_read_b64_tr_b16 v[196:197], v126 offset:14368
    v_mfma_f32_16x16x32_bf16 v[172:175], v[184:187], v[28:31], v[172:175]
    ds_read_b64_tr_b16 v[198:199], v126 offset:16160
    s_waitcnt lgkmcnt(8)
    v_mfma_f32_16x16x32_bf16 v[176:179], v[188:191], v[24:27], v[176:179]
    ds_read_b64_tr_b16 v[184:185], v126 offset:14400
    v_mfma_f32_16x16x32_bf16 v[180:183], v[188:191], v[28:31], v[180:183]
    ds_read_b64_tr_b16 v[186:187], v126 offset:16192
    s_waitcnt vmcnt(8) lgkmcnt(6)
    v_mfma_f32_16x16x32_bf16 v[128:131], v[192:195], v[32:35], v[128:131]
    ds_read_b64_tr_b16 v[188:189], v126 offset:14432
    v_mfma_f32_16x16x32_bf16 v[132:135], v[192:195], v[36:39], v[132:135]
    ds_read_b64_tr_b16 v[190:191], v126 offset:16224
    s_mov_b32 s31, s29
    s_waitcnt lgkmcnt(6)
    s_mov_b32 m0, s31
    s_add_u32 s31, s31, 2048
    buffer_load_dwordx4 v214, s[24:27], s30 offen offset:0 lds
    buffer_load_dwordx4 v122, s[24:27], s30 offen offset:1024 lds
    s_add_u32 s30, s30, 16384
    s_waitcnt lgkmcnt(4)
    v_mfma_f32_16x16x32_bf16 v[136:139], v[196:199], v[32:35], v[136:139]
    ds_read_b64_tr_b16 v[192:193], v126 offset:14464
    v_mfma_f32_16x16x32_bf16 v[140:143], v[196:199], v[36:39], v[140:143]
    ds_read_b64_tr_b16 v[194:195], v126 offset:16256
    buffer_load_dwordx4 v[24:27], v212, s[8:11], s96 offen offset:2048 sc1
    s_waitcnt lgkmcnt(4)
    v_mfma_f32_16x16x32_bf16 v[144:147], v[184:187], v[32:35], v[144:147]
    ds_read_b64_tr_b16 v[196:197], v126 offset:14496
    v_mfma_f32_16x16x32_bf16 v[148:151], v[184:187], v[36:39], v[148:151]
    ds_read_b64_tr_b16 v[198:199], v126 offset:16288
    s_waitcnt lgkmcnt(4)
    v_mfma_f32_16x16x32_bf16 v[152:155], v[188:191], v[32:35], v[152:155]
    ds_read_b64_tr_b16 v[184:185], v126 offset:14528
    v_mfma_f32_16x16x32_bf16 v[156:159], v[188:191], v[36:39], v[156:159]
    ds_read_b64_tr_b16 v[186:187], v126 offset:16320
    buffer_load_dwordx4 v[28:31], v212, s[8:11], s96 offen offset:2304 sc1
    s_waitcnt lgkmcnt(4)
    v_mfma_f32_16x16x32_bf16 v[160:163], v[192:195], v[32:35], v[160:163]
    ds_read_b64_tr_b16 v[188:189], v126 offset:21504
    v_mfma_f32_16x16x32_bf16 v[164:167], v[192:195], v[36:39], v[164:167]
    ds_read_b64_tr_b16 v[190:191], v126 offset:23296
    s_waitcnt lgkmcnt(4)
    v_mfma_f32_16x16x32_bf16 v[168:171], v[196:199], v[32:35], v[168:171]
    ds_read_b64_tr_b16 v[192:193], v126 offset:21536
    v_mfma_f32_16x16x32_bf16 v[172:175], v[196:199], v[36:39], v[172:175]
    ds_read_b64_tr_b16 v[194:195], v126 offset:23328
    s_waitcnt lgkmcnt(15)
    s_mov_b32 m0, s31
    s_add_u32 s31, s31, 2048
    buffer_load_dwordx4 v214, s[24:27], s30 offen offset:0 lds
    buffer_load_dwordx4 v122, s[24:27], s30 offen offset:1024 lds
    s_add_u32 s30, s30, 16384
    s_waitcnt lgkmcnt(4)
    v_mfma_f32_16x16x32_bf16 v[176:179], v[184:187], v[32:35], v[176:179]
    ds_read_b64_tr_b16 v[196:197], v126 offset:21568
    v_mfma_f32_16x16x32_bf16 v[180:183], v[184:187], v[36:39], v[180:183]
    ds_read_b64_tr_b16 v[198:199], v126 offset:23360
    s_waitcnt vmcnt(12) lgkmcnt(4)
    v_mfma_f32_16x16x32_bf16 v[128:131], v[188:191], v[40:43], v[128:131]
    ds_read_b64_tr_b16 v[184:185], v126 offset:21600
    v_mfma_f32_16x16x32_bf16 v[132:135], v[188:191], v[44:47], v[132:135]
    ds_read_b64_tr_b16 v[186:187], v126 offset:23392
    buffer_load_dwordx4 v[64:67], v124, s[8:11], s59 offen offset:1024 sc1
    s_waitcnt lgkmcnt(4)
    v_mfma_f32_16x16x32_bf16 v[136:139], v[192:195], v[40:43], v[136:139]
    ds_read_b64_tr_b16 v[188:189], v126 offset:21632
    v_mfma_f32_16x16x32_bf16 v[140:143], v[192:195], v[44:47], v[140:143]
    ds_read_b64_tr_b16 v[190:191], v126 offset:23424
    buffer_load_dwordx4 v[68:71], v124, s[8:11], s59 offen offset:1088 sc1
    s_waitcnt lgkmcnt(4)
    v_mfma_f32_16x16x32_bf16 v[144:147], v[196:199], v[40:43], v[144:147]
    ds_read_b64_tr_b16 v[192:193], v126 offset:21664
    v_mfma_f32_16x16x32_bf16 v[148:151], v[196:199], v[44:47], v[148:151]
    ds_read_b64_tr_b16 v[194:195], v126 offset:23456
    buffer_load_dwordx4 v[72:75], v124, s[8:11], s59 offen offset:1152 sc1
    s_waitcnt lgkmcnt(4)
    v_mfma_f32_16x16x32_bf16 v[152:155], v[184:187], v[40:43], v[152:155]
    ds_read_b64_tr_b16 v[196:197], v126 offset:21696
    v_mfma_f32_16x16x32_bf16 v[156:159], v[184:187], v[44:47], v[156:159]
    ds_read_b64_tr_b16 v[198:199], v126 offset:23488
    buffer_load_dwordx4 v[76:79], v124, s[8:11], s59 offen offset:1216 sc1
    s_waitcnt lgkmcnt(15)
    s_mov_b32 m0, s31
    s_add_u32 s31, s31, 2048
    buffer_load_dwordx4 v214, s[24:27], s30 offen offset:0 lds
    buffer_load_dwordx4 v122, s[24:27], s30 offen offset:1024 lds
    s_add_u32 s30, s30, 16384
    s_waitcnt lgkmcnt(4)
    v_mfma_f32_16x16x32_bf16 v[160:163], v[188:191], v[40:43], v[160:163]
    ds_read_b64_tr_b16 v[184:185], v126 offset:28672
    v_mfma_f32_16x16x32_bf16 v[164:167], v[188:191], v[44:47], v[164:167]
    ds_read_b64_tr_b16 v[186:187], v126 offset:30464
    buffer_load_dwordx4 v[80:83], v124, s[8:11], s59 offen offset:1280 sc1
    s_waitcnt lgkmcnt(4)
    v_mfma_f32_16x16x32_bf16 v[168:171], v[192:195], v[40:43], v[168:171]
    ds_read_b64_tr_b16 v[188:189], v126 offset:28704
    v_mfma_f32_16x16x32_bf16 v[172:175], v[192:195], v[44:47], v[172:175]
    ds_read_b64_tr_b16 v[190:191], v126 offset:30496
    buffer_load_dwordx4 v[84:87], v124, s[8:11], s59 offen offset:1344 sc1
    s_waitcnt lgkmcnt(4)
    v_mfma_f32_16x16x32_bf16 v[176:179], v[196:199], v[40:43], v[176:179]
    ds_read_b64_tr_b16 v[192:193], v126 offset:28736
    v_mfma_f32_16x16x32_bf16 v[180:183], v[196:199], v[44:47], v[180:183]
    ds_read_b64_tr_b16 v[194:195], v126 offset:30528
    s_waitcnt vmcnt(18) lgkmcnt(4)
    v_mfma_f32_16x16x32_bf16 v[128:131], v[184:187], v[0:3], v[128:131]
    ds_read_b64_tr_b16 v[196:197], v126 offset:28768
    v_mfma_f32_16x16x32_bf16 v[132:135], v[184:187], v[4:7], v[132:135]
    ds_read_b64_tr_b16 v[198:199], v126 offset:30560
    buffer_load_dwordx4 v[88:91], v124, s[8:11], s59 offen offset:1408 sc1
    s_waitcnt lgkmcnt(4)
    v_mfma_f32_16x16x32_bf16 v[136:139], v[188:191], v[0:3], v[136:139]
    ds_read_b64_tr_b16 v[184:185], v126 offset:28800
    v_mfma_f32_16x16x32_bf16 v[140:143], v[188:191], v[4:7], v[140:143]
    ds_read_b64_tr_b16 v[186:187], v126 offset:30592
    buffer_load_dword v48, v213, s[8:11], s97 offen offset:0 sc1
    s_waitcnt lgkmcnt(15)
    s_mov_b32 m0, s31
    s_add_u32 s31, s31, 2048
    buffer_load_dwordx4 v214, s[24:27], s30 offen offset:0 lds
    buffer_load_dwordx4 v122, s[24:27], s30 offen offset:1024 lds
    s_add_u32 s30, s30, 16384
    s_waitcnt lgkmcnt(4)
    v_mfma_f32_16x16x32_bf16 v[144:147], v[192:195], v[0:3], v[144:147]
    ds_read_b64_tr_b16 v[188:189], v126 offset:28832
    v_mfma_f32_16x16x32_bf16 v[148:151], v[192:195], v[4:7], v[148:151]
    ds_read_b64_tr_b16 v[190:191], v126 offset:30624
    buffer_load_dword v49, v213, s[8:11], s97 offen offset:256 sc1
    s_waitcnt lgkmcnt(4)
    v_mfma_f32_16x16x32_bf16 v[152:155], v[196:199], v[0:3], v[152:155]
    ds_read_b64_tr_b16 v[192:193], v126 offset:28864
    v_mfma_f32_16x16x32_bf16 v[156:159], v[196:199], v[4:7], v[156:159]
    ds_read_b64_tr_b16 v[194:195], v126 offset:30656
    buffer_load_dword v50, v213, s[8:11], s97 offen offset:512 sc1
    s_waitcnt lgkmcnt(4)
    v_mfma_f32_16x16x32_bf16 v[160:163], v[184:187], v[0:3], v[160:163]
    ds_read_b64_tr_b16 v[196:197], v126 offset:35840
    v_mfma_f32_16x16x32_bf16 v[164:167], v[184:187], v[4:7], v[164:167]
    ds_read_b64_tr_b16 v[198:199], v126 offset:37632
    buffer_load_dword v51, v213, s[8:11], s97 offen offset:768 sc1
    s_waitcnt lgkmcnt(4)
    v_mfma_f32_16x16x32_bf16 v[168:171], v[188:191], v[0:3], v[168:171]
    ds_read_b64_tr_b16 v[184:185], v126 offset:35872
    v_mfma_f32_16x16x32_bf16 v[172:175], v[188:191], v[4:7], v[172:175]
    ds_read_b64_tr_b16 v[186:187], v126 offset:37664
    buffer_load_dword v52, v213, s[8:11], s97 offen offset:1024 sc1
    s_waitcnt lgkmcnt(4)
    v_mfma_f32_16x16x32_bf16 v[176:179], v[192:195], v[0:3], v[176:179]
    ds_read_b64_tr_b16 v[188:189], v126 offset:35904
    v_mfma_f32_16x16x32_bf16 v[180:183], v[192:195], v[4:7], v[180:183]
    ds_read_b64_tr_b16 v[190:191], v126 offset:37696
    s_waitcnt vmcnt(24) lgkmcnt(4)
    v_mfma_f32_16x16x32_bf16 v[128:131], v[196:199], v[8:11], v[128:131]
    ds_read_b64_tr_b16 v[192:193], v126 offset:35936
    v_mfma_f32_16x16x32_bf16 v[132:135], v[196:199], v[12:15], v[132:135]
    ds_read_b64_tr_b16 v[194:195], v126 offset:37728
    buffer_load_dword v53, v213, s[8:11], s97 offen offset:1280 sc1
    s_waitcnt lgkmcnt(4)
    v_mfma_f32_16x16x32_bf16 v[136:139], v[184:187], v[8:11], v[136:139]
    ds_read_b64_tr_b16 v[196:197], v126 offset:35968
    v_mfma_f32_16x16x32_bf16 v[140:143], v[184:187], v[12:15], v[140:143]
    ds_read_b64_tr_b16 v[198:199], v126 offset:37760
    buffer_load_dword v54, v213, s[8:11], s97 offen offset:1536 sc1
    s_waitcnt lgkmcnt(4)
    v_mfma_f32_16x16x32_bf16 v[144:147], v[188:191], v[8:11], v[144:147]
    ds_read_b64_tr_b16 v[184:185], v126 offset:36000
    v_mfma_f32_16x16x32_bf16 v[148:151], v[188:191], v[12:15], v[148:151]
    ds_read_b64_tr_b16 v[186:187], v126 offset:37792
    buffer_load_dword v55, v213, s[8:11], s97 offen offset:1792 sc1
    s_waitcnt lgkmcnt(4)
    v_mfma_f32_16x16x32_bf16 v[152:155], v[192:195], v[8:11], v[152:155]
    ds_read_b64_tr_b16 v[188:189], v126 offset:36032
    v_mfma_f32_16x16x32_bf16 v[156:159], v[192:195], v[12:15], v[156:159]
    ds_read_b64_tr_b16 v[190:191], v126 offset:37824
    buffer_load_dword v56, v213, s[8:11], s97 offen offset:2048 sc1
    s_waitcnt lgkmcnt(4)
    v_mfma_f32_16x16x32_bf16 v[160:163], v[196:199], v[8:11], v[160:163]
    ds_read_b64_tr_b16 v[192:193], v126 offset:43008
    v_mfma_f32_16x16x32_bf16 v[164:167], v[196:199], v[12:15], v[164:167]
    ds_read_b64_tr_b16 v[194:195], v126 offset:44800
    buffer_load_dword v57, v213, s[8:11], s97 offen offset:2304 sc1
    s_waitcnt lgkmcnt(4)
    v_mfma_f32_16x16x32_bf16 v[168:171], v[184:187], v[8:11], v[168:171]
    ds_read_b64_tr_b16 v[196:197], v126 offset:43040
    v_mfma_f32_16x16x32_bf16 v[172:175], v[184:187], v[12:15], v[172:175]
    ds_read_b64_tr_b16 v[198:199], v126 offset:44832
    buffer_load_dword v58, v213, s[8:11], s97 offen offset:2560 sc1
    s_waitcnt lgkmcnt(4)
    v_mfma_f32_16x16x32_bf16 v[176:179], v[188:191], v[8:11], v[176:179]
    ds_read_b64_tr_b16 v[184:185], v126 offset:43072
    v_mfma_f32_16x16x32_bf16 v[180:183], v[188:191], v[12:15], v[180:183]
    ds_read_b64_tr_b16 v[186:187], v126 offset:44864
    s_waitcnt vmcnt(28) lgkmcnt(4)
    v_mfma_f32_16x16x32_bf16 v[128:131], v[192:195], v[16:19], v[128:131]
    ds_read_b64_tr_b16 v[188:189], v126 offset:43104
    v_mfma_f32_16x16x32_bf16 v[132:135], v[192:195], v[20:23], v[132:135]
    ds_read_b64_tr_b16 v[190:191], v126 offset:44896
    buffer_load_dword v59, v213, s[8:11], s97 offen offset:2816 sc1
    s_waitcnt lgkmcnt(4)
    v_mfma_f32_16x16x32_bf16 v[136:139], v[196:199], v[16:19], v[136:139]
    ds_read_b64_tr_b16 v[192:193], v126 offset:43136
    v_mfma_f32_16x16x32_bf16 v[140:143], v[196:199], v[20:23], v[140:143]
    ds_read_b64_tr_b16 v[194:195], v126 offset:44928
    buffer_load_dword v60, v213, s[8:11], s97 offen offset:3072 sc1
    s_waitcnt lgkmcnt(4)
    v_mfma_f32_16x16x32_bf16 v[144:147], v[184:187], v[16:19], v[144:147]
    ds_read_b64_tr_b16 v[196:197], v126 offset:43168
    v_mfma_f32_16x16x32_bf16 v[148:151], v[184:187], v[20:23], v[148:151]
    ds_read_b64_tr_b16 v[198:199], v126 offset:44960
    buffer_load_dword v61, v213, s[8:11], s97 offen offset:3328 sc1
    s_waitcnt lgkmcnt(4)
    v_mfma_f32_16x16x32_bf16 v[152:155], v[188:191], v[16:19], v[152:155]
    ds_read_b64_tr_b16 v[184:185], v126 offset:43200
    v_mfma_f32_16x16x32_bf16 v[156:159], v[188:191], v[20:23], v[156:159]
    ds_read_b64_tr_b16 v[186:187], v126 offset:44992
    buffer_load_dword v62, v213, s[8:11], s97 offen offset:3584 sc1
    s_waitcnt lgkmcnt(4)
    v_mfma_f32_16x16x32_bf16 v[160:163], v[192:195], v[16:19], v[160:163]
    ds_read_b64_tr_b16 v[188:189], v126 offset:50176
    v_mfma_f32_16x16x32_bf16 v[164:167], v[192:195], v[20:23], v[164:167]
    ds_read_b64_tr_b16 v[190:191], v126 offset:51968
    buffer_load_dword v63, v213, s[8:11], s97 offen offset:3840 sc1
    s_waitcnt lgkmcnt(4)
    v_mfma_f32_16x16x32_bf16 v[168:171], v[196:199], v[16:19], v[168:171]
    ds_read_b64_tr_b16 v[192:193], v126 offset:50208
    v_mfma_f32_16x16x32_bf16 v[172:175], v[196:199], v[20:23], v[172:175]
    ds_read_b64_tr_b16 v[194:195], v126 offset:52000
    s_waitcnt vmcnt(15)
    ds_read_b64_tr_b16 a[96:97], v200 offset:0
    ds_read_b64_tr_b16 a[98:99], v200 offset:512
    s_waitcnt lgkmcnt(6)
    v_mfma_f32_16x16x32_bf16 v[176:179], v[184:187], v[16:19], v[176:179]
    ds_read_b64_tr_b16 v[196:197], v126 offset:50240
    v_mfma_f32_16x16x32_bf16 v[180:183], v[184:187], v[20:23], v[180:183]
    ds_read_b64_tr_b16 v[198:199], v126 offset:52032
    ds_read_b64_tr_b16 a[100:101], v201 offset:0
    ds_read_b64_tr_b16 a[102:103], v201 offset:512
    s_waitcnt vmcnt(29) lgkmcnt(8)
    v_mfma_f32_16x16x32_bf16 v[128:131], v[188:191], v[24:27], v[128:131]
    ds_read_b64_tr_b16 v[184:185], v126 offset:50272
    v_mfma_f32_16x16x32_bf16 v[132:135], v[188:191], v[28:31], v[132:135]
    ds_read_b64_tr_b16 v[186:187], v126 offset:52064
    ds_read_b64_tr_b16 a[104:105], v200 offset:2048
    ds_read_b64_tr_b16 a[106:107], v200 offset:2560
    s_waitcnt lgkmcnt(10)
    v_mfma_f32_16x16x32_bf16 v[136:139], v[192:195], v[24:27], v[136:139]
    ds_read_b64_tr_b16 v[188:189], v126 offset:50304
    v_mfma_f32_16x16x32_bf16 v[140:143], v[192:195], v[28:31], v[140:143]
    ds_read_b64_tr_b16 v[190:191], v126 offset:52096
    ds_read_b64_tr_b16 a[108:109], v201 offset:2048
    ds_read_b64_tr_b16 a[110:111], v201 offset:2560
    s_waitcnt lgkmcnt(10)
    v_mfma_f32_16x16x32_bf16 v[144:147], v[196:199], v[24:27], v[144:147]
    ds_read_b64_tr_b16 v[192:193], v126 offset:50336
    v_mfma_f32_16x16x32_bf16 v[148:151], v[196:199], v[28:31], v[148:151]
    ds_read_b64_tr_b16 v[194:195], v126 offset:52128
    ds_read_b64_tr_b16 a[112:113], v200 offset:4096
    ds_read_b64_tr_b16 a[114:115], v200 offset:4608
    s_waitcnt lgkmcnt(10)
    v_mfma_f32_16x16x32_bf16 v[152:155], v[184:187], v[24:27], v[152:155]
    ds_read_b64_tr_b16 v[196:197], v126 offset:50368
    v_mfma_f32_16x16x32_bf16 v[156:159], v[184:187], v[28:31], v[156:159]
    ds_read_b64_tr_b16 v[198:199], v126 offset:52160
    ds_read_b64_tr_b16 a[116:117], v201 offset:4096
    ds_read_b64_tr_b16 a[118:119], v201 offset:4608
    s_waitcnt lgkmcnt(10)
    v_mfma_f32_16x16x32_bf16 v[160:163], v[188:191], v[24:27], v[160:163]
    v_mfma_f32_16x16x32_bf16 v[164:167], v[188:191], v[28:31], v[164:167]
    ds_read_b64_tr_b16 a[120:121], v200 offset:6144
    ds_read_b64_tr_b16 a[122:123], v200 offset:6656
    s_waitcnt lgkmcnt(8)
    v_mfma_f32_16x16x32_bf16 v[168:171], v[192:195], v[24:27], v[168:171]
    v_mfma_f32_16x16x32_bf16 v[172:175], v[192:195], v[28:31], v[172:175]
    ds_read_b64_tr_b16 a[124:125], v201 offset:6144
    ds_read_b64_tr_b16 a[126:127], v201 offset:6656
    s_waitcnt lgkmcnt(6)
    v_mfma_f32_16x16x32_bf16 v[176:179], v[196:199], v[24:27], v[176:179]
    v_mfma_f32_16x16x32_bf16 v[180:183], v[196:199], v[28:31], v[180:183]
    s_waitcnt lgkmcnt(0)
    s_branch L_p4c
L_p4b:
    s_waitcnt vmcnt(8) lgkmcnt(4)
    v_mfma_f32_16x16x32_bf16 v[128:131], v[184:187], v[0:3], 0
    ds_read_b64_tr_b16 v[196:197], v210 offset:96
    v_mfma_f32_16x16x32_bf16 v[132:135], v[184:187], v[4:7], 0
    ds_read_b64_tr_b16 v[198:199], v210 offset:1888
    s_waitcnt lgkmcnt(4)
    v_mfma_f32_16x16x32_bf16 v[136:139], v[188:191], v[0:3], 0
    ds_read_b64_tr_b16 v[184:185], v210 offset:128
    v_mfma_f32_16x16x32_bf16 v[140:143], v[188:191], v[4:7], 0
    ds_read_b64_tr_b16 v[186:187], v210 offset:1920
    buffer_load_dwordx4 v[40:43], v212, s[8:11], s96 offen offset:2048 sc1
    s_waitcnt lgkmcnt(4)
    v_mfma_f32_16x16x32_bf16 v[144:147], v[192:195], v[0:3], 0
    ds_read_b64_tr_b16 v[188:189], v210 offset:160
    v_mfma_f32_16x16x32_bf16 v[148:151], v[192:195], v[4:7], 0
    ds_read_b64_tr_b16 v[190:191], v210 offset:1952
    s_waitcnt lgkmcnt(4)
    v_mfma_f32_16x16x32_bf16 v[152:155], v[196:199], v[0:3], 0
    ds_read_b64_tr_b16 v[192:193], v210 offset:192
    v_mfma_f32_16x16x32_bf16 v[156:159], v[196:199], v[4:7], 0
    ds_read_b64_tr_b16 v[194:195], v210 offset:1984
    buffer_load_dwordx4 v[44:47], v212, s[8:11], s96 offen offset:2304 sc1
    s_add_u32 s96, s96, 4096
    s_waitcnt lgkmcnt(4)
    v_mfma_f32_16x16x32_bf16 v[160:163], v[184:187], v[0:3], 0
    ds_read_b64_tr_b16 v[196:197], v210 offset:7168
    v_mfma_f32_16x16x32_bf16 v[164:167], v[184:187], v[4:7], 0
    ds_read_b64_tr_b16 v[198:199], v210 offset:8960
    s_waitcnt lgkmcnt(4)
    v_mfma_f32_16x16x32_bf16 v[168:171], v[188:191], v[0:3], 0
    ds_read_b64_tr_b16 v[184:185], v210 offset:7200
    v_mfma_f32_16x16x32_bf16 v[172:175], v[188:191], v[4:7], 0
    ds_read_b64_tr_b16 v[186:187], v210 offset:8992
    s_waitcnt lgkmcnt(4)
    v_mfma_f32_16x16x32_bf16 v[176:179], v[192:195], v[0:3], 0
    ds_read_b64_tr_b16 v[188:189], v210 offset:7232
    v_mfma_f32_16x16x32_bf16 v[180:183], v[192:195], v[4:7], 0
    ds_read_b64_tr_b16 v[190:191], v210 offset:9024
    s_waitcnt vmcnt(8) lgkmcnt(4)
    v_mfma_f32_16x16x32_bf16 v[128:131], v[196:199], v[8:11], v[128:131]
    ds_read_b64_tr_b16 v[192:193], v210 offset:7264
    v_mfma_f32_16x16x32_bf16 v[132:135], v[196:199], v[12:15], v[132:135]
    ds_read_b64_tr_b16 v[194:195], v210 offset:9056
    s_waitcnt lgkmcnt(4)
    v_mfma_f32_16x16x32_bf16 v[136:139], v[184:187], v[8:11], v[136:139]
    ds_read_b64_tr_b16 v[196:197], v210 offset:7296
    v_mfma_f32_16x16x32_bf16 v[140:143], v[184:187], v[12:15], v[140:143]
    ds_read_b64_tr_b16 v[198:199], v210 offset:9088
    buffer_load_dwordx4 v[0:3], v212, s[8:11], s96 offen offset:0 sc1
    s_waitcnt lgkmcnt(4)
    v_mfma_f32_16x16x32_bf16 v[144:147], v[188:191], v[8:11], v[144:147]
    ds_read_b64_tr_b16 v[184:185], v210 offset:7328
    v_mfma_f32_16x16x32_bf16 v[148:151], v[188:191], v[12:15], v[148:151]
    ds_read_b64_tr_b16 v[186:187], v210 offset:9120
    s_waitcnt lgkmcnt(4)
    v_mfma_f32_16x16x32_bf16 v[152:155], v[192:195], v[8:11], v[152:155]
    ds_read_b64_tr_b16 v[188:189], v210 offset:7360
    v_mfma_f32_16x16x32_bf16 v[156:159], v[192:195], v[12:15], v[156:159]
    ds_read_b64_tr_b16 v[190:191], v210 offset:9152
    buffer_load_dwordx4 v[4:7], v212, s[8:11], s96 offen offset:256 sc1
    s_waitcnt lgkmcnt(4)
    v_mfma_f32_16x16x32_bf16 v[160:163], v[196:199], v[8:11], v[160:163]
    ds_read_b64_tr_b16 v[192:193], v210 offset:14336
    v_mfma_f32_16x16x32_bf16 v[164:167], v[196:199], v[12:15], v[164:167]
    ds_read_b64_tr_b16 v[194:195], v210 offset:16128
    s_waitcnt lgkmcnt(4)
    v_mfma_f32_16x16x32_bf16 v[168:171], v[184:187], v[8:11], v[168:171]
    ds_read_b64_tr_b16 v[196:197], v210 offset:14368
    v_mfma_f32_16x16x32_bf16 v[172:175], v[184:187], v[12:15], v[172:175]
    ds_read_b64_tr_b16 v[198:199], v210 offset:16160
    s_waitcnt lgkmcnt(4)
    v_mfma_f32_16x16x32_bf16 v[176:179], v[188:191], v[8:11], v[176:179]
    ds_read_b64_tr_b16 v[184:185], v210 offset:14400
    v_mfma_f32_16x16x32_bf16 v[180:183], v[188:191], v[12:15], v[180:183]
    ds_read_b64_tr_b16 v[186:187], v210 offset:16192
    s_waitcnt vmcnt(8) lgkmcnt(4)
    v_mfma_f32_16x16x32_bf16 v[128:131], v[192:195], v[16:19], v[128:131]
    ds_read_b64_tr_b16 v[188:189], v210 offset:14432
    v_mfma_f32_16x16x32_bf16 v[132:135], v[192:195], v[20:23], v[132:135]
    ds_read_b64_tr_b16 v[190:191], v210 offset:16224
    s_waitcnt lgkmcnt(4)
    v_mfma_f32_16x16x32_bf16 v[136:139], v[196:199], v[16:19], v[136:139]
    ds_read_b64_tr_b16 v[192:193], v210 offset:14464
    v_mfma_f32_16x16x32_bf16 v[140:143], v[196:199], v[20:23], v[140:143]
    ds_read_b64_tr_b16 v[194:195], v210 offset:16256
    buffer_load_dwordx4 v[8:11], v212, s[8:11], s96 offen offset:2048 sc1
    s_waitcnt lgkmcnt(4)
    v_mfma_f32_16x16x32_bf16 v[144:147], v[184:187], v[16:19], v[144:147]
    ds_read_b64_tr_b16 v[196:197], v210 offset:14496
    v_mfma_f32_16x16x32_bf16 v[148:151], v[184:187], v[20:23], v[148:151]
    ds_read_b64_tr_b16 v[198:199], v210 offset:16288
    s_waitcnt lgkmcnt(4)
    v_mfma_f32_16x16x32_bf16 v[152:155], v[188:191], v[16:19], v[152:155]
    ds_read_b64_tr_b16 v[184:185], v210 offset:14528
    v_mfma_f32_16x16x32_bf16 v[156:159], v[188:191], v[20:23], v[156:159]
    ds_read_b64_tr_b16 v[186:187], v210 offset:16320
    buffer_load_dwordx4 v[12:15], v212, s[8:11], s96 offen offset:2304 sc1
    s_add_u32 s96, s96, 4096
    s_waitcnt lgkmcnt(4)
    v_mfma_f32_16x16x32_bf16 v[160:163], v[192:195], v[16:19], v[160:163]
    ds_read_b64_tr_b16 v[188:189], v210 offset:21504
    v_mfma_f32_16x16x32_bf16 v[164:167], v[192:195], v[20:23], v[164:167]
    ds_read_b64_tr_b16 v[190:191], v210 offset:23296
    s_waitcnt lgkmcnt(4)
    v_mfma_f32_16x16x32_bf16 v[168:171], v[196:199], v[16:19], v[168:171]
    ds_read_b64_tr_b16 v[192:193], v210 offset:21536
    v_mfma_f32_16x16x32_bf16 v[172:175], v[196:199], v[20:23], v[172:175]
    ds_read_b64_tr_b16 v[194:195], v210 offset:23328
    s_waitcnt lgkmcnt(4)
    v_mfma_f32_16x16x32_bf16 v[176:179], v[184:187], v[16:19], v[176:179]
    ds_read_b64_tr_b16 v[196:197], v210 offset:21568
    v_mfma_f32_16x16x32_bf16 v[180:183], v[184:187], v[20:23], v[180:183]
    ds_read_b64_tr_b16 v[198:199], v210 offset:23360
    s_waitcnt vmcnt(8) lgkmcnt(4)
    v_mfma_f32_16x16x32_bf16 v[128:131], v[188:191], v[24:27], v[128:131]
    ds_read_b64_tr_b16 v[184:185], v210 offset:21600
    v_mfma_f32_16x16x32_bf16 v[132:135], v[188:191], v[28:31], v[132:135]
    ds_read_b64_tr_b16 v[186:187], v210 offset:23392
    s_waitcnt lgkmcnt(4)
    v_mfma_f32_16x16x32_bf16 v[136:139], v[192:195], v[24:27], v[136:139]
    ds_read_b64_tr_b16 v[188:189], v210 offset:21632
    v_mfma_f32_16x16x32_bf16 v[140:143], v[192:195], v[28:31], v[140:143]
    ds_read_b64_tr_b16 v[190:191], v210 offset:23424
    buffer_load_dwordx4 v[16:19], v212, s[8:11], s96 offen offset:0 sc1
    s_waitcnt lgkmcnt(4)
    v_mfma_f32_16x16x32_bf16 v[144:147], v[196:199], v[24:27], v[144:147]
    ds_read_b64_tr_b16 v[192:193], v210 offset:21664
    v_mfma_f32_16x16x32_bf16 v[148:151], v[196:199], v[28:31], v[148:151]
    ds_read_b64_tr_b16 v[194:195], v210 offset:23456
    s_waitcnt lgkmcnt(4)
    v_mfma_f32_16x16x32_bf16 v[152:155], v[184:187], v[24:27], v[152:155]
    ds_read_b64_tr_b16 v[196:197], v210 offset:21696
    v_mfma_f32_16x16x32_bf16 v[156:159], v[184:187], v[28:31], v[156:159]
    ds_read_b64_tr_b16 v[198:199], v210 offset:23488
    buffer_load_dwordx4 v[20:23], v212, s[8:11], s96 offen offset:256 sc1
    s_waitcnt lgkmcnt(4)
    v_mfma_f32_16x16x32_bf16 v[160:163], v[188:191], v[24:27], v[160:163]
    ds_read_b64_tr_b16 v[184:185], v210 offset:28672
    v_mfma_f32_16x16x32_bf16 v[164:167], v[188:191], v[28:31], v[164:167]
    ds_read_b64_tr_b16 v[186:187], v210 offset:30464
    s_waitcnt lgkmcnt(4)
    v_mfma_f32_16x16x32_bf16 v[168:171], v[192:195], v[24:27], v[168:171]
    ds_read_b64_tr_b16 v[188:189], v210 offset:28704
    v_mfma_f32_16x16x32_bf16 v[172:175], v[192:195], v[28:31], v[172:175]
    ds_read_b64_tr_b16 v[190:191], v210 offset:30496
    s_waitcnt lgkmcnt(4)
    v_mfma_f32_16x16x32_bf16 v[176:179], v[196:199], v[24:27], v[176:179]
    ds_read_b64_tr_b16 v[192:193], v210 offset:28736
    v_mfma_f32_16x16x32_bf16 v[180:183], v[196:199], v[28:31], v[180:183]
    ds_read_b64_tr_b16 v[194:195], v210 offset:30528
    s_waitcnt vmcnt(8) lgkmcnt(4)
    v_mfma_f32_16x16x32_bf16 v[128:131], v[184:187], v[32:35], v[128:131]
    ds_read_b64_tr_b16 v[196:197], v210 offset:28768
    v_mfma_f32_16x16x32_bf16 v[132:135], v[184:187], v[36:39], v[132:135]
    ds_read_b64_tr_b16 v[198:199], v210 offset:30560
    s_waitcnt lgkmcnt(4)
    v_mfma_f32_16x16x32_bf16 v[136:139], v[188:191], v[32:35], v[136:139]
    ds_read_b64_tr_b16 v[184:185], v210 offset:28800
    v_mfma_f32_16x16x32_bf16 v[140:143], v[188:191], v[36:39], v[140:143]
    ds_read_b64_tr_b16 v[186:187], v210 offset:30592
    buffer_load_dwordx4 v[24:27], v212, s[8:11], s96 offen offset:2048 sc1
    s_waitcnt lgkmcnt(4)
    v_mfma_f32_16x16x32_bf16 v[144:147], v[192:195], v[32:35], v[144:147]
    ds_read_b64_tr_b16 v[188:189], v210 offset:28832
    v_mfma_f32_16x16x32_bf16 v[148:151], v[192:195], v[36:39], v[148:151]
    ds_read_b64_tr_b16 v[190:191], v210 offset:30624
    s_waitcnt lgkmcnt(4)
    v_mfma_f32_16x16x32_bf16 v[152:155], v[196:199], v[32:35], v[152:155]
    ds_read_b64_tr_b16 v[192:193], v210 offset:28864
    v_mfma_f32_16x16x32_bf16 v[156:159], v[196:199], v[36:39], v[156:159]
    ds_read_b64_tr_b16 v[194:195], v210 offset:30656
    buffer_load_dwordx4 v[28:31], v212, s[8:11], s96 offen offset:2304 sc1
    s_add_u32 s96, s96, 4096
    s_waitcnt lgkmcnt(4)
    v_mfma_f32_16x16x32_bf16 v[160:163], v[184:187], v[32:35], v[160:163]
    ds_read_b64_tr_b16 v[196:197], v210 offset:35840
    v_mfma_f32_16x16x32_bf16 v[164:167], v[184:187], v[36:39], v[164:167]
    ds_read_b64_tr_b16 v[198:199], v210 offset:37632
    s_waitcnt lgkmcnt(4)
    v_mfma_f32_16x16x32_bf16 v[168:171], v[188:191], v[32:35], v[168:171]
    ds_read_b64_tr_b16 v[184:185], v210 offset:35872
    v_mfma_f32_16x16x32_bf16 v[172:175], v[188:191], v[36:39], v[172:175]
    ds_read_b64_tr_b16 v[186:187], v210 offset:37664
    s_waitcnt lgkmcnt(4)
    v_mfma_f32_16x16x32_bf16 v[176:179], v[192:195], v[32:35], v[176:179]
    ds_read_b64_tr_b16 v[188:189], v210 offset:35904
    v_mfma_f32_16x16x32_bf16 v[180:183], v[192:195], v[36:39], v[180:183]
    ds_read_b64_tr_b16 v[190:191], v210 offset:37696
    s_waitcnt vmcnt(8) lgkmcnt(4)
    v_mfma_f32_16x16x32_bf16 v[128:131], v[196:199], v[40:43], v[128:131]
    ds_read_b64_tr_b16 v[192:193], v210 offset:35936
    v_mfma_f32_16x16x32_bf16 v[132:135], v[196:199], v[44:47], v[132:135]
    ds_read_b64_tr_b16 v[194:195], v210 offset:37728
    s_waitcnt lgkmcnt(4)
    v_mfma_f32_16x16x32_bf16 v[136:139], v[184:187], v[40:43], v[136:139]
    ds_read_b64_tr_b16 v[196:197], v210 offset:35968
    v_mfma_f32_16x16x32_bf16 v[140:143], v[184:187], v[44:47], v[140:143]
    ds_read_b64_tr_b16 v[198:199], v210 offset:37760
    buffer_load_dwordx4 v[32:35], v212, s[8:11], s96 offen offset:0 sc1
    s_waitcnt lgkmcnt(4)
    v_mfma_f32_16x16x32_bf16 v[144:147], v[188:191], v[40:43], v[144:147]
    ds_read_b64_tr_b16 v[184:185], v210 offset:36000
    v_mfma_f32_16x16x32_bf16 v[148:151], v[188:191], v[44:47], v[148:151]
    ds_read_b64_tr_b16 v[186:187], v210 offset:37792
    s_waitcnt lgkmcnt(4)
    v_mfma_f32_16x16x32_bf16 v[152:155], v[192:195], v[40:43], v[152:155]
    ds_read_b64_tr_b16 v[188:189], v210 offset:36032
    v_mfma_f32_16x16x32_bf16 v[156:159], v[192:195], v[44:47], v[156:159]
    ds_read_b64_tr_b16 v[190:191], v210 offset:37824
    buffer_load_dwordx4 v[36:39], v212, s[8:11], s96 offen offset:256 sc1
    s_waitcnt lgkmcnt(4)
    v_mfma_f32_16x16x32_bf16 v[160:163], v[196:199], v[40:43], v[160:163]
    ds_read_b64_tr_b16 v[192:193], v210 offset:43008
    v_mfma_f32_16x16x32_bf16 v[164:167], v[196:199], v[44:47], v[164:167]
    ds_read_b64_tr_b16 v[194:195], v210 offset:44800
    s_waitcnt lgkmcnt(4)
    v_mfma_f32_16x16x32_bf16 v[168:171], v[184:187], v[40:43], v[168:171]
    ds_read_b64_tr_b16 v[196:197], v210 offset:43040
    v_mfma_f32_16x16x32_bf16 v[172:175], v[184:187], v[44:47], v[172:175]
    ds_read_b64_tr_b16 v[198:199], v210 offset:44832
    s_waitcnt lgkmcnt(4)
    v_mfma_f32_16x16x32_bf16 v[176:179], v[188:191], v[40:43], v[176:179]
    ds_read_b64_tr_b16 v[184:185], v210 offset:43072
    v_mfma_f32_16x16x32_bf16 v[180:183], v[188:191], v[44:47], v[180:183]
    ds_read_b64_tr_b16 v[186:187], v210 offset:44864
    s_waitcnt vmcnt(8) lgkmcnt(4)
    v_mfma_f32_16x16x32_bf16 v[128:131], v[192:195], v[0:3], v[128:131]
    ds_read_b64_tr_b16 v[188:189], v210 offset:43104
    v_mfma_f32_16x16x32_bf16 v[132:135], v[192:195], v[4:7], v[132:135]
    ds_read_b64_tr_b16 v[190:191], v210 offset:44896
    s_waitcnt lgkmcnt(4)
    v_mfma_f32_16x16x32_bf16 v[136:139], v[196:199], v[0:3], v[136:139]
    ds_read_b64_tr_b16 v[192:193], v210 offset:43136
    v_mfma_f32_16x16x32_bf16 v[140:143], v[196:199], v[4:7], v[140:143]
    ds_read_b64_tr_b16 v[194:195], v210 offset:44928
    buffer_load_dwordx4 v[40:43], v212, s[8:11], s96 offen offset:2048 sc1
    s_waitcnt lgkmcnt(4)
    v_mfma_f32_16x16x32_bf16 v[144:147], v[184:187], v[0:3], v[144:147]
    ds_read_b64_tr_b16 v[196:197], v210 offset:43168
    v_mfma_f32_16x16x32_bf16 v[148:151], v[184:187], v[4:7], v[148:151]
    ds_read_b64_tr_b16 v[198:199], v210 offset:44960
    s_waitcnt lgkmcnt(4)
    v_mfma_f32_16x16x32_bf16 v[152:155], v[188:191], v[0:3], v[152:155]
    ds_read_b64_tr_b16 v[184:185], v210 offset:43200
    v_mfma_f32_16x16x32_bf16 v[156:159], v[188:191], v[4:7], v[156:159]
    ds_read_b64_tr_b16 v[186:187], v210 offset:44992
    buffer_load_dwordx4 v[44:47], v212, s[8:11], s96 offen offset:2304 sc1
    s_add_u32 s96, s96, 4096
    s_waitcnt lgkmcnt(4)
    v_mfma_f32_16x16x32_bf16 v[160:163], v[192:195], v[0:3], v[160:163]
    ds_read_b64_tr_b16 v[188:189], v210 offset:50176
    v_mfma_f32_16x16x32_bf16 v[164:167], v[192:195], v[4:7], v[164:167]
    ds_read_b64_tr_b16 v[190:191], v210 offset:51968
    s_waitcnt lgkmcnt(4)
    v_mfma_f32_16x16x32_bf16 v[168:171], v[196:199], v[0:3], v[168:171]
    ds_read_b64_tr_b16 v[192:193], v210 offset:50208
    v_mfma_f32_16x16x32_bf16 v[172:175], v[196:199], v[4:7], v[172:175]
    ds_read_b64_tr_b16 v[194:195], v210 offset:52000
    s_waitcnt lgkmcnt(4)
    v_mfma_f32_16x16x32_bf16 v[176:179], v[184:187], v[0:3], v[176:179]
    ds_read_b64_tr_b16 v[196:197], v210 offset:50240
    v_mfma_f32_16x16x32_bf16 v[180:183], v[184:187], v[4:7], v[180:183]
    ds_read_b64_tr_b16 v[198:199], v210 offset:52032
    s_waitcnt vmcnt(8) lgkmcnt(4)
    v_mfma_f32_16x16x32_bf16 v[128:131], v[188:191], v[8:11], v[128:131]
    ds_read_b64_tr_b16 v[184:185], v210 offset:50272
    v_mfma_f32_16x16x32_bf16 v[132:135], v[188:191], v[12:15], v[132:135]
    ds_read_b64_tr_b16 v[186:187], v210 offset:52064
    s_waitcnt lgkmcnt(4)
    v_mfma_f32_16x16x32_bf16 v[136:139], v[192:195], v[8:11], v[136:139]
    ds_read_b64_tr_b16 v[188:189], v210 offset:50304
    v_mfma_f32_16x16x32_bf16 v[140:143], v[192:195], v[12:15], v[140:143]
    ds_read_b64_tr_b16 v[190:191], v210 offset:52096
    buffer_load_dwordx4 v[0:3], v212, s[8:11], s96 offen offset:0 sc1
    s_waitcnt lgkmcnt(4)
    v_mfma_f32_16x16x32_bf16 v[144:147], v[196:199], v[8:11], v[144:147]
    ds_read_b64_tr_b16 v[192:193], v210 offset:50336
    v_mfma_f32_16x16x32_bf16 v[148:151], v[196:199], v[12:15], v[148:151]
    ds_read_b64_tr_b16 v[194:195], v210 offset:52128
    s_waitcnt lgkmcnt(4)
    v_mfma_f32_16x16x32_bf16 v[152:155], v[184:187], v[8:11], v[152:155]
    ds_read_b64_tr_b16 v[196:197], v210 offset:50368
    v_mfma_f32_16x16x32_bf16 v[156:159], v[184:187], v[12:15], v[156:159]
    ds_read_b64_tr_b16 v[198:199], v210 offset:52160
    buffer_load_dwordx4 v[4:7], v212, s[8:11], s96 offen offset:256 sc1
    s_waitcnt lgkmcnt(4)
    v_mfma_f32_16x16x32_bf16 v[160:163], v[188:191], v[8:11], v[160:163]
    ds_read_b64_tr_b16 v[184:185], v126 offset:0
    v_mfma_f32_16x16x32_bf16 v[164:167], v[188:191], v[12:15], v[164:167]
    ds_read_b64_tr_b16 v[186:187], v126 offset:1792
    s_waitcnt lgkmcnt(4)
    v_mfma_f32_16x16x32_bf16 v[168:171], v[192:195], v[8:11], v[168:171]
    ds_read_b64_tr_b16 v[188:189], v126 offset:32
    v_mfma_f32_16x16x32_bf16 v[172:175], v[192:195], v[12:15], v[172:175]
    ds_read_b64_tr_b16 v[190:191], v126 offset:1824
    s_waitcnt lgkmcnt(4)
    v_mfma_f32_16x16x32_bf16 v[176:179], v[196:199], v[8:11], v[176:179]
    ds_read_b64_tr_b16 v[192:193], v126 offset:64
    v_mfma_f32_16x16x32_bf16 v[180:183], v[196:199], v[12:15], v[180:183]
    ds_read_b64_tr_b16 v[194:195], v126 offset:1856
    s_waitcnt vmcnt(8) lgkmcnt(4)
    v_mfma_f32_16x16x32_bf16 v[128:131], v[184:187], v[16:19], v[128:131]
    ds_read_b64_tr_b16 v[196:197], v126 offset:96
    v_mfma_f32_16x16x32_bf16 v[132:135], v[184:187], v[20:23], v[132:135]
    ds_read_b64_tr_b16 v[198:199], v126 offset:1888
    s_waitcnt lgkmcnt(4)
    v_mfma_f32_16x16x32_bf16 v[136:139], v[188:191], v[16:19], v[136:139]
    ds_read_b64_tr_b16 v[184:185], v126 offset:128
    v_mfma_f32_16x16x32_bf16 v[140:143], v[188:191], v[20:23], v[140:143]
    ds_read_b64_tr_b16 v[186:187], v126 offset:1920
    buffer_load_dwordx4 v[8:11], v212, s[8:11], s96 offen offset:2048 sc1
    s_waitcnt lgkmcnt(4)
    v_mfma_f32_16x16x32_bf16 v[144:147], v[192:195], v[16:19], v[144:147]
    ds_read_b64_tr_b16 v[188:189], v126 offset:160
    v_mfma_f32_16x16x32_bf16 v[148:151], v[192:195], v[20:23], v[148:151]
    ds_read_b64_tr_b16 v[190:191], v126 offset:1952
    s_waitcnt lgkmcnt(4)
    v_mfma_f32_16x16x32_bf16 v[152:155], v[196:199], v[16:19], v[152:155]
    ds_read_b64_tr_b16 v[192:193], v126 offset:192
    v_mfma_f32_16x16x32_bf16 v[156:159], v[196:199], v[20:23], v[156:159]
    ds_read_b64_tr_b16 v[194:195], v126 offset:1984
    buffer_load_dwordx4 v[12:15], v212, s[8:11], s96 offen offset:2304 sc1
    s_add_u32 s96, s96, 4096
    s_waitcnt lgkmcnt(4)
    v_mfma_f32_16x16x32_bf16 v[160:163], v[184:187], v[16:19], v[160:163]
    ds_read_b64_tr_b16 v[196:197], v126 offset:7168
    v_mfma_f32_16x16x32_bf16 v[164:167], v[184:187], v[20:23], v[164:167]
    ds_read_b64_tr_b16 v[198:199], v126 offset:8960
    s_waitcnt lgkmcnt(4)
    v_mfma_f32_16x16x32_bf16 v[168:171], v[188:191], v[16:19], v[168:171]
    ds_read_b64_tr_b16 v[184:185], v126 offset:7200
    v_mfma_f32_16x16x32_bf16 v[172:175], v[188:191], v[20:23], v[172:175]
    ds_read_b64_tr_b16 v[186:187], v126 offset:8992
    s_waitcnt lgkmcnt(4)
    v_mfma_f32_16x16x32_bf16 v[176:179], v[192:195], v[16:19], v[176:179]
    ds_read_b64_tr_b16 v[188:189], v126 offset:7232
    v_mfma_f32_16x16x32_bf16 v[180:183], v[192:195], v[20:23], v[180:183]
    ds_read_b64_tr_b16 v[190:191], v126 offset:9024
    s_waitcnt vmcnt(8) lgkmcnt(4)
    v_mfma_f32_16x16x32_bf16 v[128:131], v[196:199], v[24:27], v[128:131]
    ds_read_b64_tr_b16 v[192:193], v126 offset:7264
    v_mfma_f32_16x16x32_bf16 v[132:135], v[196:199], v[28:31], v[132:135]
    ds_read_b64_tr_b16 v[194:195], v126 offset:9056
    s_waitcnt lgkmcnt(4)
    v_mfma_f32_16x16x32_bf16 v[136:139], v[184:187], v[24:27], v[136:139]
    ds_read_b64_tr_b16 v[196:197], v126 offset:7296
    v_mfma_f32_16x16x32_bf16 v[140:143], v[184:187], v[28:31], v[140:143]
    ds_read_b64_tr_b16 v[198:199], v126 offset:9088
    buffer_load_dwordx4 v[16:19], v212, s[8:11], s96 offen offset:0 sc1
    s_waitcnt lgkmcnt(4)
    v_mfma_f32_16x16x32_bf16 v[144:147], v[188:191], v[24:27], v[144:147]
    ds_read_b64_tr_b16 v[184:185], v126 offset:7328
    v_mfma_f32_16x16x32_bf16 v[148:151], v[188:191], v[28:31], v[148:151]
    ds_read_b64_tr_b16 v[186:187], v126 offset:9120
    s_waitcnt lgkmcnt(4)
    v_mfma_f32_16x16x32_bf16 v[152:155], v[192:195], v[24:27], v[152:155]
    ds_read_b64_tr_b16 v[188:189], v126 offset:7360
    v_mfma_f32_16x16x32_bf16 v[156:159], v[192:195], v[28:31], v[156:159]
    ds_read_b64_tr_b16 v[190:191], v126 offset:9152
    buffer_load_dwordx4 v[20:23], v212, s[8:11], s96 offen offset:256 sc1
    s_waitcnt lgkmcnt(4)
    v_mfma_f32_16x16x32_bf16 v[160:163], v[196:199], v[24:27], v[160:163]
    ds_read_b64_tr_b16 v[192:193], v126 offset:14336
    v_mfma_f32_16x16x32_bf16 v[164:167], v[196:199], v[28:31], v[164:167]
    ds_read_b64_tr_b16 v[194:195], v126 offset:16128
    s_waitcnt lgkmcnt(4)
    v_mfma_f32_16x16x32_bf16 v[168:171], v[184:187], v[24:27], v[168:171]
    ds_read_b64_tr_b16 v[196:197], v126 offset:14368
    v_mfma_f32_16x16x32_bf16 v[172:175], v[184:187], v[28:31], v[172:175]
    ds_read_b64_tr_b16 v[198:199], v126 offset:16160
    s_waitcnt lgkmcnt(4)
    v_mfma_f32_16x16x32_bf16 v[176:179], v[188:191], v[24:27], v[176:179]
    ds_read_b64_tr_b16 v[184:185], v126 offset:14400
    v_mfma_f32_16x16x32_bf16 v[180:183], v[188:191], v[28:31], v[180:183]
    ds_read_b64_tr_b16 v[186:187], v126 offset:16192
    s_waitcnt vmcnt(8) lgkmcnt(4)
    v_mfma_f32_16x16x32_bf16 v[128:131], v[192:195], v[32:35], v[128:131]
    ds_read_b64_tr_b16 v[188:189], v126 offset:14432
    v_mfma_f32_16x16x32_bf16 v[132:135], v[192:195], v[36:39], v[132:135]
    ds_read_b64_tr_b16 v[190:191], v126 offset:16224
    s_waitcnt lgkmcnt(4)
    v_mfma_f32_16x16x32_bf16 v[136:139], v[196:199], v[32:35], v[136:139]
    ds_read_b64_tr_b16 v[192:193], v126 offset:14464
    v_mfma_f32_16x16x32_bf16 v[140:143], v[196:199], v[36:39], v[140:143]
    ds_read_b64_tr_b16 v[194:195], v126 offset:16256
    buffer_load_dwordx4 v[24:27], v212, s[8:11], s96 offen offset:2048 sc1
    s_waitcnt lgkmcnt(4)
    v_mfma_f32_16x16x32_bf16 v[144:147], v[184:187], v[32:35], v[144:147]
    ds_read_b64_tr_b16 v[196:197], v126 offset:14496
    v_mfma_f32_16x16x32_bf16 v[148:151], v[184:187], v[36:39], v[148:151]
    ds_read_b64_tr_b16 v[198:199], v126 offset:16288
    s_waitcnt lgkmcnt(4)
    v_mfma_f32_16x16x32_bf16 v[152:155], v[188:191], v[32:35], v[152:155]
    ds_read_b64_tr_b16 v[184:185], v126 offset:14528
    v_mfma_f32_16x16x32_bf16 v[156:159], v[188:191], v[36:39], v[156:159]
    ds_read_b64_tr_b16 v[186:187], v126 offset:16320
    buffer_load_dwordx4 v[28:31], v212, s[8:11], s96 offen offset:2304 sc1
    s_waitcnt lgkmcnt(4)
    v_mfma_f32_16x16x32_bf16 v[160:163], v[192:195], v[32:35], v[160:163]
    ds_read_b64_tr_b16 v[188:189], v126 offset:21504
    v_mfma_f32_16x16x32_bf16 v[164:167], v[192:195], v[36:39], v[164:167]
    ds_read_b64_tr_b16 v[190:191], v126 offset:23296
    s_waitcnt lgkmcnt(4)
    v_mfma_f32_16x16x32_bf16 v[168:171], v[196:199], v[32:35], v[168:171]
    ds_read_b64_tr_b16 v[192:193], v126 offset:21536
    v_mfma_f32_16x16x32_bf16 v[172:175], v[196:199], v[36:39], v[172:175]
    ds_read_b64_tr_b16 v[194:195], v126 offset:23328
    s_waitcnt lgkmcnt(4)
    v_mfma_f32_16x16x32_bf16 v[176:179], v[184:187], v[32:35], v[176:179]
    ds_read_b64_tr_b16 v[196:197], v126 offset:21568
    v_mfma_f32_16x16x32_bf16 v[180:183], v[184:187], v[36:39], v[180:183]
    ds_read_b64_tr_b16 v[198:199], v126 offset:23360
    s_waitcnt vmcnt(8) lgkmcnt(4)
    v_mfma_f32_16x16x32_bf16 v[128:131], v[188:191], v[40:43], v[128:131]
    ds_read_b64_tr_b16 v[184:185], v126 offset:21600
    v_mfma_f32_16x16x32_bf16 v[132:135], v[188:191], v[44:47], v[132:135]
    ds_read_b64_tr_b16 v[186:187], v126 offset:23392
    buffer_load_dwordx4 v[64:67], v124, s[8:11], s59 offen offset:1024 sc1
    s_waitcnt lgkmcnt(4)
    v_mfma_f32_16x16x32_bf16 v[136:139], v[192:195], v[40:43], v[136:139]
    ds_read_b64_tr_b16 v[188:189], v126 offset:21632
    v_mfma_f32_16x16x32_bf16 v[140:143], v[192:195], v[44:47], v[140:143]
    ds_read_b64_tr_b16 v[190:191], v126 offset:23424
    buffer_load_dwordx4 v[68:71], v124, s[8:11], s59 offen offset:1088 sc1
    s_waitcnt lgkmcnt(4)
    v_mfma_f32_16x16x32_bf16 v[144:147], v[196:199], v[40:43], v[144:147]
    ds_read_b64_tr_b16 v[192:193], v126 offset:21664
    v_mfma_f32_16x16x32_bf16 v[148:151], v[196:199], v[44:47], v[148:151]
    ds_read_b64_tr_b16 v[194:195], v126 offset:23456
    buffer_load_dwordx4 v[72:75], v124, s[8:11], s59 offen offset:1152 sc1
    s_waitcnt lgkmcnt(4)
    v_mfma_f32_16x16x32_bf16 v[152:155], v[184:187], v[40:43], v[152:155]
    ds_read_b64_tr_b16 v[196:197], v126 offset:21696
    v_mfma_f32_16x16x32_bf16 v[156:159], v[184:187], v[44:47], v[156:159]
    ds_read_b64_tr_b16 v[198:199], v126 offset:23488
    buffer_load_dwordx4 v[76:79], v124, s[8:11], s59 offen offset:1216 sc1
    s_waitcnt lgkmcnt(4)
    v_mfma_f32_16x16x32_bf16 v[160:163], v[188:191], v[40:43], v[160:163]
    ds_read_b64_tr_b16 v[184:185], v126 offset:28672
    v_mfma_f32_16x16x32_bf16 v[164:167], v[188:191], v[44:47], v[164:167]
    ds_read_b64_tr_b16 v[186:187], v126 offset:30464
    buffer_load_dwordx4 v[80:83], v124, s[8:11], s59 offen offset:1280 sc1
    s_waitcnt lgkmcnt(4)
    v_mfma_f32_16x16x32_bf16 v[168:171], v[192:195], v[40:43], v[168:171]
    ds_read_b64_tr_b16 v[188:189], v126 offset:28704
    v_mfma_f32_16x16x32_bf16 v[172:175], v[192:195], v[44:47], v[172:175]
    ds_read_b64_tr_b16 v[190:191], v126 offset:30496
    buffer_load_dwordx4 v[84:87], v124, s[8:11], s59 offen offset:1344 sc1
    s_waitcnt lgkmcnt(4)
    v_mfma_f32_16x16x32_bf16 v[176:179], v[196:199], v[40:43], v[176:179]
    ds_read_b64_tr_b16 v[192:193], v126 offset:28736
    v_mfma_f32_16x16x32_bf16 v[180:183], v[196:199], v[44:47], v[180:183]
    ds_read_b64_tr_b16 v[194:195], v126 offset:30528
    s_waitcnt vmcnt(12) lgkmcnt(4)
    v_mfma_f32_16x16x32_bf16 v[128:131], v[184:187], v[0:3], v[128:131]
    ds_read_b64_tr_b16 v[196:197], v126 offset:28768
    v_mfma_f32_16x16x32_bf16 v[132:135], v[184:187], v[4:7], v[132:135]
    ds_read_b64_tr_b16 v[198:199], v126 offset:30560
    buffer_load_dwordx4 v[88:91], v124, s[8:11], s59 offen offset:1408 sc1
    s_waitcnt lgkmcnt(4)
    v_mfma_f32_16x16x32_bf16 v[136:139], v[188:191], v[0:3], v[136:139]
    ds_read_b64_tr_b16 v[184:185], v126 offset:28800
    v_mfma_f32_16x16x32_bf16 v[140:143], v[188:191], v[4:7], v[140:143]
    ds_read_b64_tr_b16 v[186:187], v126 offset:30592
    buffer_load_dword v48, v213, s[8:11], s97 offen offset:0 sc1
    s_waitcnt lgkmcnt(4)
    v_mfma_f32_16x16x32_bf16 v[144:147], v[192:195], v[0:3], v[144:147]
    ds_read_b64_tr_b16 v[188:189], v126 offset:28832
    v_mfma_f32_16x16x32_bf16 v[148:151], v[192:195], v[4:7], v[148:151]
    ds_read_b64_tr_b16 v[190:191], v126 offset:30624
    buffer_load_dword v49, v213, s[8:11], s97 offen offset:256 sc1
    s_waitcnt lgkmcnt(4)
    v_mfma_f32_16x16x32_bf16 v[152:155], v[196:199], v[0:3], v[152:155]
    ds_read_b64_tr_b16 v[192:193], v126 offset:28864
    v_mfma_f32_16x16x32_bf16 v[156:159], v[196:199], v[4:7], v[156:159]
    ds_read_b64_tr_b16 v[194:195], v126 offset:30656
    buffer_load_dword v50, v213, s[8:11], s97 offen offset:512 sc1
    s_waitcnt lgkmcnt(4)
    v_mfma_f32_16x16x32_bf16 v[160:163], v[184:187], v[0:3], v[160:163]
    ds_read_b64_tr_b16 v[196:197], v126 offset:35840
    v_mfma_f32_16x16x32_bf16 v[164:167], v[184:187], v[4:7], v[164:167]
    ds_read_b64_tr_b16 v[198:199], v126 offset:37632
    buffer_load_dword v51, v213, s[8:11], s97 offen offset:768 sc1
    s_waitcnt lgkmcnt(4)
    v_mfma_f32_16x16x32_bf16 v[168:171], v[188:191], v[0:3], v[168:171]
    ds_read_b64_tr_b16 v[184:185], v126 offset:35872
    v_mfma_f32_16x16x32_bf16 v[172:175], v[188:191], v[4:7], v[172:175]
    ds_read_b64_tr_b16 v[186:187], v126 offset:37664
    buffer_load_dword v52, v213, s[8:11], s97 offen offset:1024 sc1
    s_waitcnt lgkmcnt(4)
    v_mfma_f32_16x16x32_bf16 v[176:179], v[192:195], v[0:3], v[176:179]
    ds_read_b64_tr_b16 v[188:189], v126 offset:35904
    v_mfma_f32_16x16x32_bf16 v[180:183], v[192:195], v[4:7], v[180:183]
    ds_read_b64_tr_b16 v[190:191], v126 offset:37696
    s_waitcnt vmcnt(16) lgkmcnt(4)
    v_mfma_f32_16x16x32_bf16 v[128:131], v[196:199], v[8:11], v[128:131]
    ds_read_b64_tr_b16 v[192:193], v126 offset:35936
    v_mfma_f32_16x16x32_bf16 v[132:135], v[196:199], v[12:15], v[132:135]
    ds_read_b64_tr_b16 v[194:195], v126 offset:37728
    buffer_load_dword v53, v213, s[8:11], s97 offen offset:1280 sc1
    s_waitcnt lgkmcnt(4)
    v_mfma_f32_16x16x32_bf16 v[136:139], v[184:187], v[8:11], v[136:139]
    ds_read_b64_tr_b16 v[196:197], v126 offset:35968
    v_mfma_f32_16x16x32_bf16 v[140:143], v[184:187], v[12:15], v[140:143]
    ds_read_b64_tr_b16 v[198:199], v126 offset:37760
    buffer_load_dword v54, v213, s[8:11], s97 offen offset:1536 sc1
    s_waitcnt lgkmcnt(4)
    v_mfma_f32_16x16x32_bf16 v[144:147], v[188:191], v[8:11], v[144:147]
    ds_read_b64_tr_b16 v[184:185], v126 offset:36000
    v_mfma_f32_16x16x32_bf16 v[148:151], v[188:191], v[12:15], v[148:151]
    ds_read_b64_tr_b16 v[186:187], v126 offset:37792
    buffer_load_dword v55, v213, s[8:11], s97 offen offset:1792 sc1
    s_waitcnt lgkmcnt(4)
    v_mfma_f32_16x16x32_bf16 v[152:155], v[192:195], v[8:11], v[152:155]
    ds_read_b64_tr_b16 v[188:189], v126 offset:36032
    v_mfma_f32_16x16x32_bf16 v[156:159], v[192:195], v[12:15], v[156:159]
    ds_read_b64_tr_b16 v[190:191], v126 offset:37824
    buffer_load_dword v56, v213, s[8:11], s97 offen offset:2048 sc1
    s_waitcnt lgkmcnt(4)
    v_mfma_f32_16x16x32_bf16 v[160:163], v[196:199], v[8:11], v[160:163]
    ds_read_b64_tr_b16 v[192:193], v126 offset:43008
    v_mfma_f32_16x16x32_bf16 v[164:167], v[196:199], v[12:15], v[164:167]
    ds_read_b64_tr_b16 v[194:195], v126 offset:44800
    buffer_load_dword v57, v213, s[8:11], s97 offen offset:2304 sc1
    s_waitcnt lgkmcnt(4)
    v_mfma_f32_16x16x32_bf16 v[168:171], v[184:187], v[8:11], v[168:171]
    ds_read_b64_tr_b16 v[196:197], v126 offset:43040
    v_mfma_f32_16x16x32_bf16 v[172:175], v[184:187], v[12:15], v[172:175]
    ds_read_b64_tr_b16 v[198:199], v126 offset:44832
    buffer_load_dword v58, v213, s[8:11], s97 offen offset:2560 sc1
    s_waitcnt lgkmcnt(4)
    v_mfma_f32_16x16x32_bf16 v[176:179], v[188:191], v[8:11], v[176:179]
    ds_read_b64_tr_b16 v[184:185], v126 offset:43072
    v_mfma_f32_16x16x32_bf16 v[180:183], v[188:191], v[12:15], v[180:183]
    ds_read_b64_tr_b16 v[186:187], v126 offset:44864
    s_waitcnt vmcnt(20) lgkmcnt(4)
    v_mfma_f32_16x16x32_bf16 v[128:131], v[192:195], v[16:19], v[128:131]
    ds_read_b64_tr_b16 v[188:189], v126 offset:43104
    v_mfma_f32_16x16x32_bf16 v[132:135], v[192:195], v[20:23], v[132:135]
    ds_read_b64_tr_b16 v[190:191], v126 offset:44896
    buffer_load_dword v59, v213, s[8:11], s97 offen offset:2816 sc1
    s_waitcnt lgkmcnt(4)
    v_mfma_f32_16x16x32_bf16 v[136:139], v[196:199], v[16:19], v[136:139]
    ds_read_b64_tr_b16 v[192:193], v126 offset:43136
    v_mfma_f32_16x16x32_bf16 v[140:143], v[196:199], v[20:23], v[140:143]
    ds_read_b64_tr_b16 v[194:195], v126 offset:44928
    buffer_load_dword v60, v213, s[8:11], s97 offen offset:3072 sc1
    s_waitcnt lgkmcnt(4)
    v_mfma_f32_16x16x32_bf16 v[144:147], v[184:187], v[16:19], v[144:147]
    ds_read_b64_tr_b16 v[196:197], v126 offset:43168
    v_mfma_f32_16x16x32_bf16 v[148:151], v[184:187], v[20:23], v[148:151]
    ds_read_b64_tr_b16 v[198:199], v126 offset:44960
    buffer_load_dword v61, v213, s[8:11], s97 offen offset:3328 sc1
    s_waitcnt lgkmcnt(4)
    v_mfma_f32_16x16x32_bf16 v[152:155], v[188:191], v[16:19], v[152:155]
    ds_read_b64_tr_b16 v[184:185], v126 offset:43200
    v_mfma_f32_16x16x32_bf16 v[156:159], v[188:191], v[20:23], v[156:159]
    ds_read_b64_tr_b16 v[186:187], v126 offset:44992
    buffer_load_dword v62, v213, s[8:11], s97 offen offset:3584 sc1
    s_waitcnt lgkmcnt(4)
    v_mfma_f32_16x16x32_bf16 v[160:163], v[192:195], v[16:19], v[160:163]
    ds_read_b64_tr_b16 v[188:189], v126 offset:50176
    v_mfma_f32_16x16x32_bf16 v[164:167], v[192:195], v[20:23], v[164:167]
    ds_read_b64_tr_b16 v[190:191], v126 offset:51968
    buffer_load_dword v63, v213, s[8:11], s97 offen offset:3840 sc1
    s_waitcnt lgkmcnt(4)
    v_mfma_f32_16x16x32_bf16 v[168:171], v[196:199], v[16:19], v[168:171]
    ds_read_b64_tr_b16 v[192:193], v126 offset:50208
    v_mfma_f32_16x16x32_bf16 v[172:175], v[196:199], v[20:23], v[172:175]
    ds_read_b64_tr_b16 v[194:195], v126 offset:52000
    s_waitcnt lgkmcnt(4)
    v_mfma_f32_16x16x32_bf16 v[176:179], v[184:187], v[16:19], v[176:179]
    ds_read_b64_tr_b16 v[196:197], v126 offset:50240
    v_mfma_f32_16x16x32_bf16 v[180:183], v[184:187], v[20:23], v[180:183]
    ds_read_b64_tr_b16 v[198:199], v126 offset:52032
    s_waitcnt vmcnt(23) lgkmcnt(4)
    v_mfma_f32_16x16x32_bf16 v[128:131], v[188:191], v[24:27], v[128:131]
    ds_read_b64_tr_b16 v[184:185], v126 offset:50272
    v_mfma_f32_16x16x32_bf16 v[132:135], v[188:191], v[28:31], v[132:135]
    ds_read_b64_tr_b16 v[186:187], v126 offset:52064
    s_waitcnt lgkmcnt(4)
    v_mfma_f32_16x16x32_bf16 v[136:139], v[192:195], v[24:27], v[136:139]
    ds_read_b64_tr_b16 v[188:189], v126 offset:50304
    v_mfma_f32_16x16x32_bf16 v[140:143], v[192:195], v[28:31], v[140:143]
    ds_read_b64_tr_b16 v[190:191], v126 offset:52096
    s_waitcnt lgkmcnt(4)
    v_mfma_f32_16x16x32_bf16 v[144:147], v[196:199], v[24:27], v[144:147]
    ds_read_b64_tr_b16 v[192:193], v126 offset:50336
    v_mfma_f32_16x16x32_bf16 v[148:151], v[196:199], v[28:31], v[148:151]
    ds_read_b64_tr_b16 v[194:195], v126 offset:52128
    s_waitcnt lgkmcnt(4)
    v_mfma_f32_16x16x32_bf16 v[152:155], v[184:187], v[24:27], v[152:155]
    ds_read_b64_tr_b16 v[196:197], v126 offset:50368
    v_mfma_f32_16x16x32_bf16 v[156:159], v[184:187], v[28:31], v[156:159]
    ds_read_b64_tr_b16 v[198:199], v126 offset:52160
    s_waitcnt lgkmcnt(4)
    v_mfma_f32_16x16x32_bf16 v[160:163], v[188:191], v[24:27], v[160:163]
    v_mfma_f32_16x16x32_bf16 v[164:167], v[188:191], v[28:31], v[164:167]
    s_waitcnt lgkmcnt(2)
    v_mfma_f32_16x16x32_bf16 v[168:171], v[192:195], v[24:27], v[168:171]
    v_mfma_f32_16x16x32_bf16 v[172:175], v[192:195], v[28:31], v[172:175]
    s_waitcnt lgkmcnt(0)
    v_mfma_f32_16x16x32_bf16 v[176:179], v[196:199], v[24:27], v[176:179]
    v_mfma_f32_16x16x32_bf16 v[180:183], v[196:199], v[28:31], v[180:183]
L_p4c:
    s_waitcnt vmcnt(0)
    v_pk_add_f32 v[48:49], v[48:49], v[56:57]
    v_pk_add_f32 v[50:51], v[50:51], v[58:59]
    v_pk_add_f32 v[52:53], v[52:53], v[60:61]
    v_pk_add_f32 v[54:55], v[54:55], v[62:63]
    v_pk_add_f32 v[48:49], v[48:49], v[52:53]
    v_pk_add_f32 v[50:51], v[50:51], v[54:55]
    v_pk_add_f32 v[48:49], v[48:49], v[50:51]
    v_add_f32 v48, v48, v49
    v_mov_b32 v49, v48
    s_nop 1
    v_permlane32_swap_b32 v48, v49
    v_mul_f32 v48, 0x3b000000, v48
    v_mul_f32 v49, 0x3b000000, v49
    v_fma_f32 v49, -v48, v48, v49
    v_max_f32 v49, 0, v49
    v_cvt_pk_bf16_f32 v48, v48, v48
    v_lshlrev_b32 v48, 16, v48
    v_cvt_pk_bf16_f32 v49, v49, v49
    v_lshlrev_b32 v49, 16, v49
    v_add_f32 v49, 0x3727c5ac, v49
    v_cvt_pk_bf16_f32 v49, v49, v49
    v_lshlrev_b32 v49, 16, v49
    v_sqrt_f32 v49, v49
    v_sub_f32 v0, 0, v48
    v_cvt_pk_bf16_f32 v49, v49, v49
    v_lshlrev_b32 v49, 16, v49
    v_rcp_f32 v122, v49
    v_mov_b32 v4, v49
    v_mov_b32 v2, v0
    v_mov_b32 v6, v4
    v_mul_f32 v8, 0xc0135761, v122
    v_mul_f32 v12, v122, v122
    v_mov_b32 v10, v8
    v_mul_f32 v12, v12, v8
    v_mul_f32 v12, 0x3d372713, v12
    v_permlane16_swap_b32 v0, v2
    v_mov_b32 v14, v12
    v_permlane16_swap_b32 v4, v6
    v_permlane16_swap_b32 v8, v10
    v_permlane16_swap_b32 v12, v14
    s_mov_b32 s31, s29
    s_lshl_b32 s62, s48, 12
    s_add_u32 s62, s62, 98304
    v_add_u32 v199, 7168, v214
    s_and_b32 s4, s2, 7
    s_lshl_b32 s3, s48, 1
    s_add_u32 s4, s4, s3
    s_and_b32 s3, s4, 7
    s_mul_i32 s3, s3, 12288
    v_add_u32 v198, s3, v206
    s_add_u32 s4, s4, 1
    s_and_b32 s3, s4, 7
    s_mul_i32 s3, s3, 12288
    v_add_u32 v195, s3, v206
    v_add_u32 v196, s62, v215
    v_xor_b32 v197, 64, v196
    s_waitcnt vmcnt(0)
    s_barrier
    s_cmp_lg_u32 s53, 0
    s_cbranch_scc1 L_gelu1
    v_pk_fma_f32 v[128:129], v[64:65], v[0:1], v[128:129] op_sel_hi:[1,0,1]
    v_pk_fma_f32 v[130:131], v[66:67], v[0:1], v[130:131] op_sel_hi:[1,0,1]
    v_pk_fma_f32 v[132:133], v[64:65], v[2:3], v[132:133] op_sel_hi:[1,0,1]
    v_pk_fma_f32 v[134:135], v[66:67], v[2:3], v[134:135] op_sel_hi:[1,0,1]
    v_pk_fma_f32 v[128:129], v[92:93], v[4:5], v[128:129] op_sel_hi:[1,0,1]
    v_pk_fma_f32 v[130:131], v[94:95], v[4:5], v[130:131] op_sel_hi:[1,0,1]
    v_pk_fma_f32 v[132:133], v[92:93], v[6:7], v[132:133] op_sel_hi:[1,0,1]
    v_pk_fma_f32 v[134:135], v[94:95], v[6:7], v[134:135] op_sel_hi:[1,0,1]
    s_mov_b32 m0, s31
    s_add_u32 s31, s31, 2048
    buffer_load_dwordx4 v214, s[24:27], s30 offen offset:0 lds
    buffer_load_dwordx4 v199, s[24:27], s30 offen offset:1024 lds
    s_add_u32 s30, s30, 16384
    ds_write_b128 v198, a[128:131] offset:0
    ds_write_b128 v198, a[132:135] offset:1024
    ds_write_b128 v198, a[136:139] offset:2048
    v_pk_mul_f32 v[16:17], v[128:129], v[128:129]
    v_pk_mul_f32 v[18:19], v[130:131], v[130:131]
    v_pk_mul_f32 v[20:21], v[132:133], v[132:133]
    v_pk_mul_f32 v[22:23], v[134:135], v[134:135]
    v_pk_fma_f32 v[16:17], v[16:17], v[12:13], v[8:9] op_sel_hi:[1,0,0]
    v_pk_fma_f32 v[18:19], v[18:19], v[12:13], v[8:9] op_sel_hi:[1,0,0]
    v_pk_fma_f32 v[20:21], v[20:21], v[14:15], v[10:11] op_sel_hi:[1,0,0]
    v_pk_fma_f32 v[22:23], v[22:23], v[14:15], v[10:11] op_sel_hi:[1,0,0]
    v_pk_mul_f32 v[16:17], v[16:17], v[128:129]
    v_pk_mul_f32 v[18:19], v[18:19], v[130:131]
    v_pk_mul_f32 v[20:21], v[20:21], v[132:133]
    v_pk_mul_f32 v[22:23], v[22:23], v[134:135]
    s_mov_b32 m0, s31
    s_add_u32 s31, s31, 2048
    buffer_load_dwordx4 v214, s[24:27], s30 offen offset:0 lds
    buffer_load_dwordx4 v199, s[24:27], s30 offen offset:1024 lds
    s_add_u32 s30, s30, 16384
    ds_write_b128 v198, a[140:143] offset:3072
    ds_write_b128 v198, a[144:147] offset:4096
    ds_write_b128 v198, a[148:151] offset:5120
    v_exp_f32 v16, v16
    v_exp_f32 v17, v17
    v_exp_f32 v18, v18
    v_exp_f32 v19, v19
    v_exp_f32 v20, v20
    v_exp_f32 v21, v21
    v_exp_f32 v22, v22
    v_exp_f32 v23, v23
    s_mov_b32 m0, s31
    s_add_u32 s31, s31, 2048
    buffer_load_dwordx4 v214, s[24:27], s30 offen offset:0 lds
    buffer_load_dwordx4 v199, s[24:27], s30 offen offset:1024 lds
    s_add_u32 s30, s30, 16384
    ds_write_b128 v198, a[152:155] offset:6144
    ds_write_b128 v198, a[156:159] offset:7168
    ds_write_b128 v198, a[160:163] offset:8192
    v_pk_fma_f32 v[16:17], v[16:17], v[4:5], v[4:5] op_sel_hi:[1,0,0]
    v_pk_fma_f32 v[18:19], v[18:19], v[4:5], v[4:5] op_sel_hi:[1,0,0]
    v_pk_fma_f32 v[20:21], v[20:21], v[6:7], v[6:7] op_sel_hi:[1,0,0]
    v_pk_fma_f32 v[22:23], v[22:23], v[6:7], v[6:7] op_sel_hi:[1,0,0]
    v_rcp_f32 v16, v16
    v_rcp_f32 v17, v17
    v_rcp_f32 v18, v18
    v_rcp_f32 v19, v19
    v_rcp_f32 v20, v20
    v_rcp_f32 v21, v21
    v_rcp_f32 v22, v22
    v_rcp_f32 v23, v23
    s_mov_b32 m0, s31
    s_add_u32 s31, s31, 2048
    buffer_load_dwordx4 v214, s[24:27], s30 offen offset:0 lds
    buffer_load_dwordx4 v199, s[24:27], s30 offen offset:1024 lds
    s_add_u32 s30, s30, 16384
    ds_write_b128 v198, a[164:167] offset:9216
    ds_write_b128 v198, a[168:171] offset:10240
    ds_write_b128 v198, a[172:175] offset:11264
    v_pk_mul_f32 v[128:129], v[128:129], v[16:17]
    v_pk_mul_f32 v[130:131], v[130:131], v[18:19]
    v_pk_mul_f32 v[132:133], v[132:133], v[20:21]
    v_pk_mul_f32 v[134:135], v[134:135], v[22:23]
    v_cvt_pk_bf16_f32 v32, v128, v129
    v_cvt_pk_bf16_f32 v33, v130, v131
    v_cvt_pk_bf16_f32 v34, v132, v133
    v_cvt_pk_bf16_f32 v35, v134, v135
    s_nop 0
    v_permlane16_swap_b32 v32, v34
    v_permlane16_swap_b32 v33, v35
    buffer_store_dwordx4 v[32:35], v206, s[8:11], s98 offen offset:0 sc1
    v_pk_fma_f32 v[136:137], v[68:69], v[0:1], v[136:137] op_sel_hi:[1,0,1]
    v_pk_fma_f32 v[138:139], v[70:71], v[0:1], v[138:139] op_sel_hi:[1,0,1]
    v_pk_fma_f32 v[140:141], v[68:69], v[2:3], v[140:141] op_sel_hi:[1,0,1]
    v_pk_fma_f32 v[142:143], v[70:71], v[2:3], v[142:143] op_sel_hi:[1,0,1]
    v_pk_fma_f32 v[136:137], v[96:97], v[4:5], v[136:137] op_sel_hi:[1,0,1]
    v_pk_fma_f32 v[138:139], v[98:99], v[4:5], v[138:139] op_sel_hi:[1,0,1]
    v_pk_fma_f32 v[140:141], v[96:97], v[6:7], v[140:141] op_sel_hi:[1,0,1]
    v_pk_fma_f32 v[142:143], v[98:99], v[6:7], v[142:143] op_sel_hi:[1,0,1]
    s_mov_b32 m0, s31
    s_add_u32 s31, s31, 2048
    buffer_load_dwordx4 v214, s[24:27], s30 offen offset:0 lds
    buffer_load_dwordx4 v199, s[24:27], s30 offen offset:1024 lds
    s_add_u32 s30, s30, 16384
    ds_write_b128 v195, a[176:179] offset:0
    ds_write_b128 v195, a[180:183] offset:1024
    ds_write_b128 v195, a[184:187] offset:2048
    v_pk_mul_f32 v[24:25], v[136:137], v[136:137]
    v_pk_mul_f32 v[26:27], v[138:139], v[138:139]
    v_pk_mul_f32 v[28:29], v[140:141], v[140:141]
    v_pk_mul_f32 v[30:31], v[142:143], v[142:143]
    v_pk_fma_f32 v[24:25], v[24:25], v[12:13], v[8:9] op_sel_hi:[1,0,0]
    v_pk_fma_f32 v[26:27], v[26:27], v[12:13], v[8:9] op_sel_hi:[1,0,0]
    v_pk_fma_f32 v[28:29], v[28:29], v[14:15], v[10:11] op_sel_hi:[1,0,0]
    v_pk_fma_f32 v[30:31], v[30:31], v[14:15], v[10:11] op_sel_hi:[1,0,0]
    v_pk_mul_f32 v[24:25], v[24:25], v[136:137]
    v_pk_mul_f32 v[26:27], v[26:27], v[138:139]
    v_pk_mul_f32 v[28:29], v[28:29], v[140:141]
    v_pk_mul_f32 v[30:31], v[30:31], v[142:143]
    s_mov_b32 m0, s31
    s_add_u32 s31, s31, 2048
    buffer_load_dwordx4 v214, s[24:27], s30 offen offset:0 lds
    buffer_load_dwordx4 v199, s[24:27], s30 offen offset:1024 lds
    s_add_u32 s30, s30, 16384
    ds_write_b128 v195, a[188:191] offset:3072
    ds_write_b128 v195, a[192:195] offset:4096
    ds_write_b128 v195, a[196:199] offset:5120
    v_exp_f32 v24, v24
    v_exp_f32 v25, v25
    v_exp_f32 v26, v26
    v_exp_f32 v27, v27
    v_exp_f32 v28, v28
    v_exp_f32 v29, v29
    v_exp_f32 v30, v30
    v_exp_f32 v31, v31
    s_mov_b32 m0, s62
    s_add_u32 s62, s62, 2048
    buffer_load_dwordx4 v214, s[24:27], s30 offen offset:0 lds
    buffer_load_dwordx4 v199, s[24:27], s30 offen offset:1024 lds
    s_add_u32 s30, s30, 16384
    ds_write_b128 v195, a[200:203] offset:6144
    ds_write_b128 v195, a[204:207] offset:7168
    ds_write_b128 v195, a[208:211] offset:8192
    v_pk_fma_f32 v[24:25], v[24:25], v[4:5], v[4:5] op_sel_hi:[1,0,0]
    v_pk_fma_f32 v[26:27], v[26:27], v[4:5], v[4:5] op_sel_hi:[1,0,0]
    v_pk_fma_f32 v[28:29], v[28:29], v[6:7], v[6:7] op_sel_hi:[1,0,0]
    v_pk_fma_f32 v[30:31], v[30:31], v[6:7], v[6:7] op_sel_hi:[1,0,0]
    v_rcp_f32 v24, v24
    v_rcp_f32 v25, v25
    v_rcp_f32 v26, v26
    v_rcp_f32 v27, v27
    v_rcp_f32 v28, v28
    v_rcp_f32 v29, v29
    v_rcp_f32 v30, v30
    v_rcp_f32 v31, v31
    s_mov_b32 m0, s62
    s_add_u32 s62, s62, 2048
    buffer_load_dwordx4 v214, s[24:27], s30 offen offset:0 lds
    buffer_load_dwordx4 v199, s[24:27], s30 offen offset:1024 lds
    s_add_u32 s30, s30, 16384
    ds_write_b128 v195, a[212:215] offset:9216
    ds_write_b128 v195, a[216:219] offset:10240
    ds_write_b128 v195, a[220:223] offset:11264
    v_pk_mul_f32 v[136:137], v[136:137], v[24:25]
    v_pk_mul_f32 v[138:139], v[138:139], v[26:27]
    v_pk_mul_f32 v[140:141], v[140:141], v[28:29]
    v_pk_mul_f32 v[142:143], v[142:143], v[30:31]
    v_cvt_pk_bf16_f32 v36, v136, v137
    v_cvt_pk_bf16_f32 v37, v138, v139
    v_cvt_pk_bf16_f32 v38, v140, v141
    v_cvt_pk_bf16_f32 v39, v142, v143
    s_nop 0
    v_permlane16_swap_b32 v36, v38
    v_permlane16_swap_b32 v37, v39
    buffer_store_dwordx4 v[36:39], v206, s[8:11], s98 offen offset:1024 sc1
    v_lshrrev_b32 v202, 5, v207
    v_lshlrev_b32 v202, 3, v202
    s_lshl_b32 s3, s56, 5
    buffer_load_dwordx2 v[64:65], v202, s[40:43], s3 offen offset:0
    buffer_load_dwordx2 v[66:67], v202, s[40:43], s3 offen offset:16
    buffer_load_dwordx2 v[68:69], v202, s[40:43], s3 offen offset:32
    buffer_load_dwordx2 v[70:71], v202, s[40:43], s3 offen offset:48
    v_pk_fma_f32 v[144:145], v[72:73], v[0:1], v[144:145] op_sel_hi:[1,0,1]
    v_pk_fma_f32 v[146:147], v[74:75], v[0:1], v[146:147] op_sel_hi:[1,0,1]
    v_pk_fma_f32 v[148:149], v[72:73], v[2:3], v[148:149] op_sel_hi:[1,0,1]
    v_pk_fma_f32 v[150:151], v[74:75], v[2:3], v[150:151] op_sel_hi:[1,0,1]
    v_pk_fma_f32 v[144:145], v[100:101], v[4:5], v[144:145] op_sel_hi:[1,0,1]
    v_pk_fma_f32 v[146:147], v[102:103], v[4:5], v[146:147] op_sel_hi:[1,0,1]
    v_pk_fma_f32 v[148:149], v[100:101], v[6:7], v[148:149] op_sel_hi:[1,0,1]
    v_pk_fma_f32 v[150:151], v[102:103], v[6:7], v[150:151] op_sel_hi:[1,0,1]
    v_pk_mul_f32 v[16:17], v[144:145], v[144:145]
    v_pk_mul_f32 v[18:19], v[146:147], v[146:147]
    v_pk_mul_f32 v[20:21], v[148:149], v[148:149]
    v_pk_mul_f32 v[22:23], v[150:151], v[150:151]
    v_pk_fma_f32 v[16:17], v[16:17], v[12:13], v[8:9] op_sel_hi:[1,0,0]
    v_pk_fma_f32 v[18:19], v[18:19], v[12:13], v[8:9] op_sel_hi:[1,0,0]
    v_pk_fma_f32 v[20:21], v[20:21], v[14:15], v[10:11] op_sel_hi:[1,0,0]
    v_pk_fma_f32 v[22:23], v[22:23], v[14:15], v[10:11] op_sel_hi:[1,0,0]
    v_pk_mul_f32 v[16:17], v[16:17], v[144:145]
    v_pk_mul_f32 v[18:19], v[18:19], v[146:147]
    v_pk_mul_f32 v[20:21], v[20:21], v[148:149]
    v_pk_mul_f32 v[22:23], v[22:23], v[150:151]
    v_exp_f32 v16, v16
    v_exp_f32 v17, v17
    v_exp_f32 v18, v18
    v_exp_f32 v19, v19
    v_exp_f32 v20, v20
    v_exp_f32 v21, v21
    v_exp_f32 v22, v22
    v_exp_f32 v23, v23
    v_pk_fma_f32 v[16:17], v[16:17], v[4:5], v[4:5] op_sel_hi:[1,0,0]
    v_pk_fma_f32 v[18:19], v[18:19], v[4:5], v[4:5] op_sel_hi:[1,0,0]
    v_pk_fma_f32 v[20:21], v[20:21], v[6:7], v[6:7] op_sel_hi:[1,0,0]
    v_pk_fma_f32 v[22:23], v[22:23], v[6:7], v[6:7] op_sel_hi:[1,0,0]
    v_rcp_f32 v16, v16
    v_rcp_f32 v17, v17
    v_rcp_f32 v18, v18
    v_rcp_f32 v19, v19
    v_rcp_f32 v20, v20
    v_rcp_f32 v21, v21
    v_rcp_f32 v22, v22
    v_rcp_f32 v23, v23
    v_pk_mul_f32 v[144:145], v[144:145], v[16:17]
    v_pk_mul_f32 v[146:147], v[146:147], v[18:19]
    v_pk_mul_f32 v[148:149], v[148:149], v[20:21]
    v_pk_mul_f32 v[150:151], v[150:151], v[22:23]
    v_cvt_pk_bf16_f32 v32, v144, v145
    v_cvt_pk_bf16_f32 v33, v146, v147
    v_cvt_pk_bf16_f32 v34, v148, v149
    v_cvt_pk_bf16_f32 v35, v150, v151
    s_nop 0
    v_permlane16_swap_b32 v32, v34
    v_permlane16_swap_b32 v33, v35
    buffer_store_dwordx4 v[32:35], v206, s[8:11], s98 offen offset:2048 sc1
    v_pk_fma_f32 v[152:153], v[76:77], v[0:1], v[152:153] op_sel_hi:[1,0,1]
    v_pk_fma_f32 v[154:155], v[78:79], v[0:1], v[154:155] op_sel_hi:[1,0,1]
    v_pk_fma_f32 v[156:157], v[76:77], v[2:3], v[156:157] op_sel_hi:[1,0,1]
    v_pk_fma_f32 v[158:159], v[78:79], v[2:3], v[158:159] op_sel_hi:[1,0,1]
    v_pk_fma_f32 v[152:153], v[104:105], v[4:5], v[152:153] op_sel_hi:[1,0,1]
    v_pk_fma_f32 v[154:155], v[106:107], v[4:5], v[154:155] op_sel_hi:[1,0,1]
    v_pk_fma_f32 v[156:157], v[104:105], v[6:7], v[156:157] op_sel_hi:[1,0,1]
    v_pk_fma_f32 v[158:159], v[106:107], v[6:7], v[158:159] op_sel_hi:[1,0,1]
    v_pk_mul_f32 v[24:25], v[152:153], v[152:153]
    v_pk_mul_f32 v[26:27], v[154:155], v[154:155]
    v_pk_mul_f32 v[28:29], v[156:157], v[156:157]
    v_pk_mul_f32 v[30:31], v[158:159], v[158:159]
    v_pk_fma_f32 v[24:25], v[24:25], v[12:13], v[8:9] op_sel_hi:[1,0,0]
    v_pk_fma_f32 v[26:27], v[26:27], v[12:13], v[8:9] op_sel_hi:[1,0,0]
    v_pk_fma_f32 v[28:29], v[28:29], v[14:15], v[10:11] op_sel_hi:[1,0,0]
    v_pk_fma_f32 v[30:31], v[30:31], v[14:15], v[10:11] op_sel_hi:[1,0,0]
    v_pk_mul_f32 v[24:25], v[24:25], v[152:153]
    v_pk_mul_f32 v[26:27], v[26:27], v[154:155]
    v_pk_mul_f32 v[28:29], v[28:29], v[156:157]
    v_pk_mul_f32 v[30:31], v[30:31], v[158:159]
    v_exp_f32 v24, v24
    v_exp_f32 v25, v25
    v_exp_f32 v26, v26
    v_exp_f32 v27, v27
    v_exp_f32 v28, v28
    v_exp_f32 v29, v29
    v_exp_f32 v30, v30
    v_exp_f32 v31, v31
    v_pk_fma_f32 v[24:25], v[24:25], v[4:5], v[4:5] op_sel_hi:[1,0,0]
    v_pk_fma_f32 v[26:27], v[26:27], v[4:5], v[4:5] op_sel_hi:[1,0,0]
    v_pk_fma_f32 v[28:29], v[28:29], v[6:7], v[6:7] op_sel_hi:[1,0,0]
    v_pk_fma_f32 v[30:31], v[30:31], v[6:7], v[6:7] op_sel_hi:[1,0,0]
    v_rcp_f32 v24, v24
    v_rcp_f32 v25, v25
    v_rcp_f32 v26, v26
    v_rcp_f32 v27, v27
    v_rcp_f32 v28, v28
    v_rcp_f32 v29, v29
    v_rcp_f32 v30, v30
    v_rcp_f32 v31, v31
    v_pk_mul_f32 v[152:153], v[152:153], v[24:25]
    v_pk_mul_f32 v[154:155], v[154:155], v[26:27]
    v_pk_mul_f32 v[156:157], v[156:157], v[28:29]
    v_pk_mul_f32 v[158:159], v[158:159], v[30:31]
    v_cvt_pk_bf16_f32 v36, v152, v153
    v_cvt_pk_bf16_f32 v37, v154, v155
    v_cvt_pk_bf16_f32 v38, v156, v157
    v_cvt_pk_bf16_f32 v39, v158, v159
    s_nop 0
    v_permlane16_swap_b32 v36, v38
    v_permlane16_swap_b32 v37, v39
    buffer_store_dwordx4 v[36:39], v206, s[8:11], s98 offen offset:3072 sc1
    s_add_u32 s98, s98, 4096
    v_pk_fma_f32 v[160:161], v[80:81], v[0:1], v[160:161] op_sel_hi:[1,0,1]
    v_pk_fma_f32 v[162:163], v[82:83], v[0:1], v[162:163] op_sel_hi:[1,0,1]
    v_pk_fma_f32 v[164:165], v[80:81], v[2:3], v[164:165] op_sel_hi:[1,0,1]
    v_pk_fma_f32 v[166:167], v[82:83], v[2:3], v[166:167] op_sel_hi:[1,0,1]
    v_pk_fma_f32 v[160:161], v[108:109], v[4:5], v[160:161] op_sel_hi:[1,0,1]
    v_pk_fma_f32 v[162:163], v[110:111], v[4:5], v[162:163] op_sel_hi:[1,0,1]
    v_pk_fma_f32 v[164:165], v[108:109], v[6:7], v[164:165] op_sel_hi:[1,0,1]
    v_pk_fma_f32 v[166:167], v[110:111], v[6:7], v[166:167] op_sel_hi:[1,0,1]
    v_pk_mul_f32 v[16:17], v[160:161], v[160:161]
    v_pk_mul_f32 v[18:19], v[162:163], v[162:163]
    v_pk_mul_f32 v[20:21], v[164:165], v[164:165]
    v_pk_mul_f32 v[22:23], v[166:167], v[166:167]
    v_pk_fma_f32 v[16:17], v[16:17], v[12:13], v[8:9] op_sel_hi:[1,0,0]
    v_pk_fma_f32 v[18:19], v[18:19], v[12:13], v[8:9] op_sel_hi:[1,0,0]
    v_pk_fma_f32 v[20:21], v[20:21], v[14:15], v[10:11] op_sel_hi:[1,0,0]
    v_pk_fma_f32 v[22:23], v[22:23], v[14:15], v[10:11] op_sel_hi:[1,0,0]
    v_pk_mul_f32 v[16:17], v[16:17], v[160:161]
    v_pk_mul_f32 v[18:19], v[18:19], v[162:163]
    v_pk_mul_f32 v[20:21], v[20:21], v[164:165]
    v_pk_mul_f32 v[22:23], v[22:23], v[166:167]
    v_exp_f32 v16, v16
    v_exp_f32 v17, v17
    v_exp_f32 v18, v18
    v_exp_f32 v19, v19
    v_exp_f32 v20, v20
    v_exp_f32 v21, v21
    v_exp_f32 v22, v22
    v_exp_f32 v23, v23
    v_pk_fma_f32 v[16:17], v[16:17], v[4:5], v[4:5] op_sel_hi:[1,0,0]
    v_pk_fma_f32 v[18:19], v[18:19], v[4:5], v[4:5] op_sel_hi:[1,0,0]
    v_pk_fma_f32 v[20:21], v[20:21], v[6:7], v[6:7] op_sel_hi:[1,0,0]
    v_pk_fma_f32 v[22:23], v[22:23], v[6:7], v[6:7] op_sel_hi:[1,0,0]
    v_rcp_f32 v16, v16
    v_rcp_f32 v17, v17
    v_rcp_f32 v18, v18
    v_rcp_f32 v19, v19
    v_rcp_f32 v20, v20
    v_rcp_f32 v21, v21
    v_rcp_f32 v22, v22
    v_rcp_f32 v23, v23
    v_pk_mul_f32 v[160:161], v[160:161], v[16:17]
    v_pk_mul_f32 v[162:163], v[162:163], v[18:19]
    v_pk_mul_f32 v[164:165], v[164:165], v[20:21]
    v_pk_mul_f32 v[166:167], v[166:167], v[22:23]
    v_cvt_pk_bf16_f32 v32, v160, v161
    v_cvt_pk_bf16_f32 v33, v162, v163
    v_cvt_pk_bf16_f32 v34, v164, v165
    v_cvt_pk_bf16_f32 v35, v166, v167
    s_nop 0
    v_permlane16_swap_b32 v32, v34
    v_permlane16_swap_b32 v33, v35
    buffer_store_dwordx4 v[32:35], v206, s[8:11], s98 offen offset:0 sc1
    v_pk_fma_f32 v[168:169], v[84:85], v[0:1], v[168:169] op_sel_hi:[1,0,1]
    v_pk_fma_f32 v[170:171], v[86:87], v[0:1], v[170:171] op_sel_hi:[1,0,1]
    v_pk_fma_f32 v[172:173], v[84:85], v[2:3], v[172:173] op_sel_hi:[1,0,1]
    v_pk_fma_f32 v[174:175], v[86:87], v[2:3], v[174:175] op_sel_hi:[1,0,1]
    v_pk_fma_f32 v[168:169], v[112:113], v[4:5], v[168:169] op_sel_hi:[1,0,1]
    v_pk_fma_f32 v[170:171], v[114:115], v[4:5], v[170:171] op_sel_hi:[1,0,1]
    v_pk_fma_f32 v[172:173], v[112:113], v[6:7], v[172:173] op_sel_hi:[1,0,1]
    v_pk_fma_f32 v[174:175], v[114:115], v[6:7], v[174:175] op_sel_hi:[1,0,1]
    v_pk_mul_f32 v[24:25], v[168:169], v[168:169]
    v_pk_mul_f32 v[26:27], v[170:171], v[170:171]
    v_pk_mul_f32 v[28:29], v[172:173], v[172:173]
    v_pk_mul_f32 v[30:31], v[174:175], v[174:175]
    v_pk_fma_f32 v[24:25], v[24:25], v[12:13], v[8:9] op_sel_hi:[1,0,0]
    v_pk_fma_f32 v[26:27], v[26:27], v[12:13], v[8:9] op_sel_hi:[1,0,0]
    v_pk_fma_f32 v[28:29], v[28:29], v[14:15], v[10:11] op_sel_hi:[1,0,0]
    v_pk_fma_f32 v[30:31], v[30:31], v[14:15], v[10:11] op_sel_hi:[1,0,0]
    v_pk_mul_f32 v[24:25], v[24:25], v[168:169]
    v_pk_mul_f32 v[26:27], v[26:27], v[170:171]
    v_pk_mul_f32 v[28:29], v[28:29], v[172:173]
    v_pk_mul_f32 v[30:31], v[30:31], v[174:175]
    s_waitcnt vmcnt(8) lgkmcnt(0)
    ds_read_b64_tr_b16 a[128:129], v200 offset:0
    ds_read_b64_tr_b16 a[130:131], v200 offset:512
    ds_read_b64_tr_b16 a[132:133], v201 offset:0
    ds_read_b64_tr_b16 a[134:135], v201 offset:512
    ds_read_b64_tr_b16 a[136:137], v200 offset:2048
    ds_read_b64_tr_b16 a[138:139], v200 offset:2560
    ds_read_b64_tr_b16 a[140:141], v201 offset:2048
    ds_read_b64_tr_b16 a[142:143], v201 offset:2560
    s_waitcnt lgkmcnt(7)
    ds_read_b64_tr_b16 a[144:145], v200 offset:4096
    ds_read_b64_tr_b16 a[146:147], v200 offset:4608
    ds_read_b64_tr_b16 a[148:149], v201 offset:4096
    ds_read_b64_tr_b16 a[150:151], v201 offset:4608
    ds_read_b64_tr_b16 a[152:153], v200 offset:6144
    ds_read_b64_tr_b16 a[154:155], v200 offset:6656
    ds_read_b64_tr_b16 a[156:157], v201 offset:6144
    ds_read_b64_tr_b16 a[158:159], v201 offset:6656
    s_waitcnt lgkmcnt(7)
    ds_read_b64_tr_b16 a[160:161], v200 offset:8192
    ds_read_b64_tr_b16 a[162:163], v200 offset:8704
    ds_read_b64_tr_b16 a[164:165], v201 offset:8192
    ds_read_b64_tr_b16 a[166:167], v201 offset:8704
    ds_read_b64_tr_b16 a[168:169], v200 offset:10240
    ds_read_b64_tr_b16 a[170:171], v200 offset:10752
    ds_read_b64_tr_b16 a[172:173], v201 offset:10240
    ds_read_b64_tr_b16 a[174:175], v201 offset:10752
    s_waitcnt lgkmcnt(7)
    s_waitcnt lgkmcnt(0)
    s_mov_b32 s31, s29
    s_mov_b32 m0, s31
    s_add_u32 s31, s31, 2048
    buffer_load_dwordx4 v214, s[24:27], s30 offen offset:0 lds
    buffer_load_dwordx4 v199, s[24:27], s30 offen offset:1024 lds
    s_add_u32 s30, s30, 16384
    s_mov_b32 m0, s31
    s_add_u32 s31, s31, 2048
    buffer_load_dwordx4 v214, s[24:27], s30 offen offset:0 lds
    buffer_load_dwordx4 v199, s[24:27], s30 offen offset:1024 lds
    s_add_u32 s30, s30, 16384
    s_mov_b32 m0, s31
    s_add_u32 s31, s31, 2048
    buffer_load_dwordx4 v214, s[24:27], s30 offen offset:0 lds
    buffer_load_dwordx4 v199, s[24:27], s30 offen offset:1024 lds
    s_add_u32 s30, s30, 16384
    s_mov_b32 m0, s31
    s_add_u32 s31, s31, 2048
    buffer_load_dwordx4 v214, s[24:27], s30 offen offset:0 lds
    buffer_load_dwordx4 v199, s[24:27], s30 offen offset:1024 lds
    s_add_u32 s30, s30, 16384
    ds_read_b64_tr_b16 a[176:177], v196 offset:0
    ds_read_b64_tr_b16 a[178:179], v196 offset:512
    ds_read_b64_tr_b16 a[180:181], v197 offset:0
    ds_read_b64_tr_b16 a[182:183], v197 offset:512
    ds_read_b64_tr_b16 a[184:185], v196 offset:2048
    ds_read_b64_tr_b16 a[186:187], v196 offset:2560
    ds_read_b64_tr_b16 a[188:189], v197 offset:2048
    ds_read_b64_tr_b16 a[190:191], v197 offset:2560
    s_waitcnt lgkmcnt(7)
    s_waitcnt lgkmcnt(0)
    v_exp_f32 v24, v24
    v_exp_f32 v25, v25
    v_exp_f32 v26, v26
    v_exp_f32 v27, v27
    v_exp_f32 v28, v28
    v_exp_f32 v29, v29
    v_exp_f32 v30, v30
    v_exp_f32 v31, v31
    v_pk_fma_f32 v[24:25], v[24:25], v[4:5], v[4:5] op_sel_hi:[1,0,0]
    v_pk_fma_f32 v[26:27], v[26:27], v[4:5], v[4:5] op_sel_hi:[1,0,0]
    v_pk_fma_f32 v[28:29], v[28:29], v[6:7], v[6:7] op_sel_hi:[1,0,0]
    v_pk_fma_f32 v[30:31], v[30:31], v[6:7], v[6:7] op_sel_hi:[1,0,0]
    v_rcp_f32 v24, v24
    v_rcp_f32 v25, v25
    v_rcp_f32 v26, v26
    v_rcp_f32 v27, v27
    v_rcp_f32 v28, v28
    v_rcp_f32 v29, v29
    v_rcp_f32 v30, v30
    v_rcp_f32 v31, v31
    v_pk_mul_f32 v[168:169], v[168:169], v[24:25]
    v_pk_mul_f32 v[170:171], v[170:171], v[26:27]
    v_pk_mul_f32 v[172:173], v[172:173], v[28:29]
    v_pk_mul_f32 v[174:175], v[174:175], v[30:31]
    v_cvt_pk_bf16_f32 v36, v168, v169
    v_cvt_pk_bf16_f32 v37, v170, v171
    v_cvt_pk_bf16_f32 v38, v172, v173
    v_cvt_pk_bf16_f32 v39, v174, v175
    s_nop 0
    v_permlane16_swap_b32 v36, v38
    v_permlane16_swap_b32 v37, v39
    buffer_store_dwordx4 v[36:39], v206, s[8:11], s98 offen offset:1024 sc1
    v_pk_fma_f32 v[176:177], v[88:89], v[0:1], v[176:177] op_sel_hi:[1,0,1]
    v_pk_fma_f32 v[178:179], v[90:91], v[0:1], v[178:179] op_sel_hi:[1,0,1]
    v_pk_fma_f32 v[180:181], v[88:89], v[2:3], v[180:181] op_sel_hi:[1,0,1]
    v_pk_fma_f32 v[182:183], v[90:91], v[2:3], v[182:183] op_sel_hi:[1,0,1]
    v_pk_fma_f32 v[176:177], v[116:117], v[4:5], v[176:177] op_sel_hi:[1,0,1]
    v_pk_fma_f32 v[178:179], v[118:119], v[4:5], v[178:179] op_sel_hi:[1,0,1]
    v_pk_fma_f32 v[180:181], v[116:117], v[6:7], v[180:181] op_sel_hi:[1,0,1]
    v_pk_fma_f32 v[182:183], v[118:119], v[6:7], v[182:183] op_sel_hi:[1,0,1]
    v_pk_mul_f32 v[16:17], v[176:177], v[176:177]
    v_pk_mul_f32 v[18:19], v[178:179], v[178:179]
    v_pk_mul_f32 v[20:21], v[180:181], v[180:181]
    v_pk_mul_f32 v[22:23], v[182:183], v[182:183]
    v_pk_fma_f32 v[16:17], v[16:17], v[12:13], v[8:9] op_sel_hi:[1,0,0]
    v_pk_fma_f32 v[18:19], v[18:19], v[12:13], v[8:9] op_sel_hi:[1,0,0]
    v_pk_fma_f32 v[20:21], v[20:21], v[14:15], v[10:11] op_sel_hi:[1,0,0]
    v_pk_fma_f32 v[22:23], v[22:23], v[14:15], v[10:11] op_sel_hi:[1,0,0]
    v_pk_mul_f32 v[16:17], v[16:17], v[176:177]
    v_pk_mul_f32 v[18:19], v[18:19], v[178:179]
    v_pk_mul_f32 v[20:21], v[20:21], v[180:181]
    v_pk_mul_f32 v[22:23], v[22:23], v[182:183]
    v_exp_f32 v16, v16
    v_exp_f32 v17, v17
    v_exp_f32 v18, v18
    v_exp_f32 v19, v19
    v_exp_f32 v20, v20
    v_exp_f32 v21, v21
    v_exp_f32 v22, v22
    v_exp_f32 v23, v23
    v_pk_fma_f32 v[16:17], v[16:17], v[4:5], v[4:5] op_sel_hi:[1,0,0]
    v_pk_fma_f32 v[18:19], v[18:19], v[4:5], v[4:5] op_sel_hi:[1,0,0]
    v_pk_fma_f32 v[20:21], v[20:21], v[6:7], v[6:7] op_sel_hi:[1,0,0]
    v_pk_fma_f32 v[22:23], v[22:23], v[6:7], v[6:7] op_sel_hi:[1,0,0]
    v_rcp_f32 v16, v16
    v_rcp_f32 v17, v17
    v_rcp_f32 v18, v18
    v_rcp_f32 v19, v19
    v_rcp_f32 v20, v20
    v_rcp_f32 v21, v21
    v_rcp_f32 v22, v22
    v_rcp_f32 v23, v23
    v_pk_mul_f32 v[176:177], v[176:177], v[16:17]
    v_pk_mul_f32 v[178:179], v[178:179], v[18:19]
    v_pk_mul_f32 v[180:181], v[180:181], v[20:21]
    v_pk_mul_f32 v[182:183], v[182:183], v[22:23]
    v_cvt_pk_bf16_f32 v32, v176, v177
    v_cvt_pk_bf16_f32 v33, v178, v179
    v_cvt_pk_bf16_f32 v34, v180, v181
    v_cvt_pk_bf16_f32 v35, v182, v183
    s_nop 0
    v_permlane16_swap_b32 v32, v34
    v_permlane16_swap_b32 v33, v35
    buffer_store_dwordx4 v[32:35], v206, s[8:11], s98 offen offset:2048 sc1
    s_branch L_gelu2
L_gelu1:
    s_cmp_eq_u32 s47, 0
    s_cbranch_scc1 L_gelu0
    v_pk_fma_f32 v[128:129], v[64:65], v[0:1], v[128:129] op_sel_hi:[1,0,1]
    v_pk_fma_f32 v[130:131], v[66:67], v[0:1], v[130:131] op_sel_hi:[1,0,1]
    v_pk_fma_f32 v[132:133], v[64:65], v[2:3], v[132:133] op_sel_hi:[1,0,1]
    v_pk_fma_f32 v[134:135], v[66:67], v[2:3], v[134:135] op_sel_hi:[1,0,1]
    v_pk_fma_f32 v[128:129], v[92:93], v[4:5], v[128:129] op_sel_hi:[1,0,1]
    v_pk_fma_f32 v[130:131], v[94:95], v[4:5], v[130:131] op_sel_hi:[1,0,1]
    v_pk_fma_f32 v[132:133], v[92:93], v[6:7], v[132:133] op_sel_hi:[1,0,1]
    v_pk_fma_f32 v[134:135], v[94:95], v[6:7], v[134:135] op_sel_hi:[1,0,1]
    v_pk_mul_f32 v[16:17], v[128:129], v[128:129]
    v_pk_mul_f32 v[18:19], v[130:131], v[130:131]
    v_pk_mul_f32 v[20:21], v[132:133], v[132:133]
    v_pk_mul_f32 v[22:23], v[134:135], v[134:135]
    v_pk_fma_f32 v[16:17], v[16:17], v[12:13], v[8:9] op_sel_hi:[1,0,0]
    v_pk_fma_f32 v[18:19], v[18:19], v[12:13], v[8:9] op_sel_hi:[1,0,0]
    v_pk_fma_f32 v[20:21], v[20:21], v[14:15], v[10:11] op_sel_hi:[1,0,0]
    v_pk_fma_f32 v[22:23], v[22:23], v[14:15], v[10:11] op_sel_hi:[1,0,0]
    v_pk_mul_f32 v[16:17], v[16:17], v[128:129]
    v_pk_mul_f32 v[18:19], v[18:19], v[130:131]
    v_pk_mul_f32 v[20:21], v[20:21], v[132:133]
    v_pk_mul_f32 v[22:23], v[22:23], v[134:135]
    v_exp_f32 v16, v16
    v_exp_f32 v17, v17
    v_exp_f32 v18, v18
    v_exp_f32 v19, v19
    v_exp_f32 v20, v20
    v_exp_f32 v21, v21
    v_exp_f32 v22, v22
    v_exp_f32 v23, v23
    v_pk_fma_f32 v[16:17], v[16:17], v[4:5], v[4:5] op_sel_hi:[1,0,0]
    v_pk_fma_f32 v[18:19], v[18:19], v[4:5], v[4:5] op_sel_hi:[1,0,0]
    v_pk_fma_f32 v[20:21], v[20:21], v[6:7], v[6:7] op_sel_hi:[1,0,0]
    v_pk_fma_f32 v[22:23], v[22:23], v[6:7], v[6:7] op_sel_hi:[1,0,0]
    v_rcp_f32 v16, v16
    v_rcp_f32 v17, v17
    v_rcp_f32 v18, v18
    v_rcp_f32 v19, v19
    v_rcp_f32 v20, v20
    v_rcp_f32 v21, v21
    v_rcp_f32 v22, v22
    v_rcp_f32 v23, v23
    v_pk_mul_f32 v[128:129], v[128:129], v[16:17]
    v_pk_mul_f32 v[130:131], v[130:131], v[18:19]
    v_pk_mul_f32 v[132:133], v[132:133], v[20:21]
    v_pk_mul_f32 v[134:135], v[134:135], v[22:23]
    v_cvt_pk_bf16_f32 v32, v128, v129
    v_cvt_pk_bf16_f32 v33, v130, v131
    v_cvt_pk_bf16_f32 v34, v132, v133
    v_cvt_pk_bf16_f32 v35, v134, v135
    s_nop 0
    v_permlane16_swap_b32 v32, v34
    v_permlane16_swap_b32 v33, v35
    buffer_store_dwordx4 v[32:35], v206, s[8:11], s98 offen offset:0
    v_pk_fma_f32 v[136:137], v[68:69], v[0:1], v[136:137] op_sel_hi:[1,0,1]
    v_pk_fma_f32 v[138:139], v[70:71], v[0:1], v[138:139] op_sel_hi:[1,0,1]
    v_pk_fma_f32 v[140:141], v[68:69], v[2:3], v[140:141] op_sel_hi:[1,0,1]
    v_pk_fma_f32 v[142:143], v[70:71], v[2:3], v[142:143] op_sel_hi:[1,0,1]
    v_pk_fma_f32 v[136:137], v[96:97], v[4:5], v[136:137] op_sel_hi:[1,0,1]
    v_pk_fma_f32 v[138:139], v[98:99], v[4:5], v[138:139] op_sel_hi:[1,0,1]
    v_pk_fma_f32 v[140:141], v[96:97], v[6:7], v[140:141] op_sel_hi:[1,0,1]
    v_pk_fma_f32 v[142:143], v[98:99], v[6:7], v[142:143] op_sel_hi:[1,0,1]
    v_pk_mul_f32 v[24:25], v[136:137], v[136:137]
    v_pk_mul_f32 v[26:27], v[138:139], v[138:139]
    v_pk_mul_f32 v[28:29], v[140:141], v[140:141]
    v_pk_mul_f32 v[30:31], v[142:143], v[142:143]
    v_pk_fma_f32 v[24:25], v[24:25], v[12:13], v[8:9] op_sel_hi:[1,0,0]
    v_pk_fma_f32 v[26:27], v[26:27], v[12:13], v[8:9] op_sel_hi:[1,0,0]
    v_pk_fma_f32 v[28:29], v[28:29], v[14:15], v[10:11] op_sel_hi:[1,0,0]
    v_pk_fma_f32 v[30:31], v[30:31], v[14:15], v[10:11] op_sel_hi:[1,0,0]
    v_pk_mul_f32 v[24:25], v[24:25], v[136:137]
    v_pk_mul_f32 v[26:27], v[26:27], v[138:139]
    v_pk_mul_f32 v[28:29], v[28:29], v[140:141]
    v_pk_mul_f32 v[30:31], v[30:31], v[142:143]
    v_exp_f32 v24, v24
    v_exp_f32 v25, v25
    v_exp_f32 v26, v26
    v_exp_f32 v27, v27
    v_exp_f32 v28, v28
    v_exp_f32 v29, v29
    v_exp_f32 v30, v30
    v_exp_f32 v31, v31
    v_pk_fma_f32 v[24:25], v[24:25], v[4:5], v[4:5] op_sel_hi:[1,0,0]
    v_pk_fma_f32 v[26:27], v[26:27], v[4:5], v[4:5] op_sel_hi:[1,0,0]
    v_pk_fma_f32 v[28:29], v[28:29], v[6:7], v[6:7] op_sel_hi:[1,0,0]
    v_pk_fma_f32 v[30:31], v[30:31], v[6:7], v[6:7] op_sel_hi:[1,0,0]
    v_rcp_f32 v24, v24
    v_rcp_f32 v25, v25
    v_rcp_f32 v26, v26
    v_rcp_f32 v27, v27
    v_rcp_f32 v28, v28
    v_rcp_f32 v29, v29
    v_rcp_f32 v30, v30
    v_rcp_f32 v31, v31
    v_pk_mul_f32 v[136:137], v[136:137], v[24:25]
    v_pk_mul_f32 v[138:139], v[138:139], v[26:27]
    v_pk_mul_f32 v[140:141], v[140:141], v[28:29]
    v_pk_mul_f32 v[142:143], v[142:143], v[30:31]
    v_cvt_pk_bf16_f32 v36, v136, v137
    v_cvt_pk_bf16_f32 v37, v138, v139
    v_cvt_pk_bf16_f32 v38, v140, v141
    v_cvt_pk_bf16_f32 v39, v142, v143
    s_nop 0
    v_permlane16_swap_b32 v36, v38
    v_permlane16_swap_b32 v37, v39
    buffer_store_dwordx4 v[36:39], v206, s[8:11], s98 offen offset:1024
    v_lshrrev_b32 v202, 5, v207
    v_lshlrev_b32 v202, 3, v202
    s_lshl_b32 s3, s56, 5
    buffer_load_dwordx2 v[64:65], v202, s[40:43], s3 offen offset:0
    buffer_load_dwordx2 v[66:67], v202, s[40:43], s3 offen offset:16
    buffer_load_dwordx2 v[68:69], v202, s[40:43], s3 offen offset:32
    buffer_load_dwordx2 v[70:71], v202, s[40:43], s3 offen offset:48
    v_pk_fma_f32 v[144:145], v[72:73], v[0:1], v[144:145] op_sel_hi:[1,0,1]
    v_pk_fma_f32 v[146:147], v[74:75], v[0:1], v[146:147] op_sel_hi:[1,0,1]
    v_pk_fma_f32 v[148:149], v[72:73], v[2:3], v[148:149] op_sel_hi:[1,0,1]
    v_pk_fma_f32 v[150:151], v[74:75], v[2:3], v[150:151] op_sel_hi:[1,0,1]
    v_pk_fma_f32 v[144:145], v[100:101], v[4:5], v[144:145] op_sel_hi:[1,0,1]
    v_pk_fma_f32 v[146:147], v[102:103], v[4:5], v[146:147] op_sel_hi:[1,0,1]
    v_pk_fma_f32 v[148:149], v[100:101], v[6:7], v[148:149] op_sel_hi:[1,0,1]
    v_pk_fma_f32 v[150:151], v[102:103], v[6:7], v[150:151] op_sel_hi:[1,0,1]
    v_pk_mul_f32 v[16:17], v[144:145], v[144:145]
    v_pk_mul_f32 v[18:19], v[146:147], v[146:147]
    v_pk_mul_f32 v[20:21], v[148:149], v[148:149]
    v_pk_mul_f32 v[22:23], v[150:151], v[150:151]
    v_pk_fma_f32 v[16:17], v[16:17], v[12:13], v[8:9] op_sel_hi:[1,0,0]
    v_pk_fma_f32 v[18:19], v[18:19], v[12:13], v[8:9] op_sel_hi:[1,0,0]
    v_pk_fma_f32 v[20:21], v[20:21], v[14:15], v[10:11] op_sel_hi:[1,0,0]
    v_pk_fma_f32 v[22:23], v[22:23], v[14:15], v[10:11] op_sel_hi:[1,0,0]
    v_pk_mul_f32 v[16:17], v[16:17], v[144:145]
    v_pk_mul_f32 v[18:19], v[18:19], v[146:147]
    v_pk_mul_f32 v[20:21], v[20:21], v[148:149]
    v_pk_mul_f32 v[22:23], v[22:23], v[150:151]
    v_exp_f32 v16, v16
    v_exp_f32 v17, v17
    v_exp_f32 v18, v18
    v_exp_f32 v19, v19
    v_exp_f32 v20, v20
    v_exp_f32 v21, v21
    v_exp_f32 v22, v22
    v_exp_f32 v23, v23
    v_pk_fma_f32 v[16:17], v[16:17], v[4:5], v[4:5] op_sel_hi:[1,0,0]
    v_pk_fma_f32 v[18:19], v[18:19], v[4:5], v[4:5] op_sel_hi:[1,0,0]
    v_pk_fma_f32 v[20:21], v[20:21], v[6:7], v[6:7] op_sel_hi:[1,0,0]
    v_pk_fma_f32 v[22:23], v[22:23], v[6:7], v[6:7] op_sel_hi:[1,0,0]
    v_rcp_f32 v16, v16
    v_rcp_f32 v17, v17
    v_rcp_f32 v18, v18
    v_rcp_f32 v19, v19
    v_rcp_f32 v20, v20
    v_rcp_f32 v21, v21
    v_rcp_f32 v22, v22
    v_rcp_f32 v23, v23
    v_pk_mul_f32 v[144:145], v[144:145], v[16:17]
    v_pk_mul_f32 v[146:147], v[146:147], v[18:19]
    v_pk_mul_f32 v[148:149], v[148:149], v[20:21]
    v_pk_mul_f32 v[150:151], v[150:151], v[22:23]
    v_cvt_pk_bf16_f32 v32, v144, v145
    v_cvt_pk_bf16_f32 v33, v146, v147
    v_cvt_pk_bf16_f32 v34, v148, v149
    v_cvt_pk_bf16_f32 v35, v150, v151
    s_nop 0
    v_permlane16_swap_b32 v32, v34
    v_permlane16_swap_b32 v33, v35
    buffer_store_dwordx4 v[32:35], v206, s[8:11], s98 offen offset:2048
    v_pk_fma_f32 v[152:153], v[76:77], v[0:1], v[152:153] op_sel_hi:[1,0,1]
    v_pk_fma_f32 v[154:155], v[78:79], v[0:1], v[154:155] op_sel_hi:[1,0,1]
    v_pk_fma_f32 v[156:157], v[76:77], v[2:3], v[156:157] op_sel_hi:[1,0,1]
    v_pk_fma_f32 v[158:159], v[78:79], v[2:3], v[158:159] op_sel_hi:[1,0,1]
    v_pk_fma_f32 v[152:153], v[104:105], v[4:5], v[152:153] op_sel_hi:[1,0,1]
    v_pk_fma_f32 v[154:155], v[106:107], v[4:5], v[154:155] op_sel_hi:[1,0,1]
    v_pk_fma_f32 v[156:157], v[104:105], v[6:7], v[156:157] op_sel_hi:[1,0,1]
    v_pk_fma_f32 v[158:159], v[106:107], v[6:7], v[158:159] op_sel_hi:[1,0,1]
    v_pk_mul_f32 v[24:25], v[152:153], v[152:153]
    v_pk_mul_f32 v[26:27], v[154:155], v[154:155]
    v_pk_mul_f32 v[28:29], v[156:157], v[156:157]
    v_pk_mul_f32 v[30:31], v[158:159], v[158:159]
    v_pk_fma_f32 v[24:25], v[24:25], v[12:13], v[8:9] op_sel_hi:[1,0,0]
    v_pk_fma_f32 v[26:27], v[26:27], v[12:13], v[8:9] op_sel_hi:[1,0,0]
    v_pk_fma_f32 v[28:29], v[28:29], v[14:15], v[10:11] op_sel_hi:[1,0,0]
    v_pk_fma_f32 v[30:31], v[30:31], v[14:15], v[10:11] op_sel_hi:[1,0,0]
    v_pk_mul_f32 v[24:25], v[24:25], v[152:153]
    v_pk_mul_f32 v[26:27], v[26:27], v[154:155]
    v_pk_mul_f32 v[28:29], v[28:29], v[156:157]
    v_pk_mul_f32 v[30:31], v[30:31], v[158:159]
    v_exp_f32 v24, v24
    v_exp_f32 v25, v25
    v_exp_f32 v26, v26
    v_exp_f32 v27, v27
    v_exp_f32 v28, v28
    v_exp_f32 v29, v29
    v_exp_f32 v30, v30
    v_exp_f32 v31, v31
    v_pk_fma_f32 v[24:25], v[24:25], v[4:5], v[4:5] op_sel_hi:[1,0,0]
    v_pk_fma_f32 v[26:27], v[26:27], v[4:5], v[4:5] op_sel_hi:[1,0,0]
    v_pk_fma_f32 v[28:29], v[28:29], v[6:7], v[6:7] op_sel_hi:[1,0,0]
    v_pk_fma_f32 v[30:31], v[30:31], v[6:7], v[6:7] op_sel_hi:[1,0,0]
    v_rcp_f32 v24, v24
    v_rcp_f32 v25, v25
    v_rcp_f32 v26, v26
    v_rcp_f32 v27, v27
    v_rcp_f32 v28, v28
    v_rcp_f32 v29, v29
    v_rcp_f32 v30, v30
    v_rcp_f32 v31, v31
    v_pk_mul_f32 v[152:153], v[152:153], v[24:25]
    v_pk_mul_f32 v[154:155], v[154:155], v[26:27]
    v_pk_mul_f32 v[156:157], v[156:157], v[28:29]
    v_pk_mul_f32 v[158:159], v[158:159], v[30:31]
    v_cvt_pk_bf16_f32 v36, v152, v153
    v_cvt_pk_bf16_f32 v37, v154, v155
    v_cvt_pk_bf16_f32 v38, v156, v157
    v_cvt_pk_bf16_f32 v39, v158, v159
    s_nop 0
    v_permlane16_swap_b32 v36, v38
    v_permlane16_swap_b32 v37, v39
    buffer_store_dwordx4 v[36:39], v206, s[8:11], s98 offen offset:3072
    s_add_u32 s98, s98, 4096
    v_pk_fma_f32 v[160:161], v[80:81], v[0:1], v[160:161] op_sel_hi:[1,0,1]
    v_pk_fma_f32 v[162:163], v[82:83], v[0:1], v[162:163] op_sel_hi:[1,0,1]
    v_pk_fma_f32 v[164:165], v[80:81], v[2:3], v[164:165] op_sel_hi:[1,0,1]
    v_pk_fma_f32 v[166:167], v[82:83], v[2:3], v[166:167] op_sel_hi:[1,0,1]
    v_pk_fma_f32 v[160:161], v[108:109], v[4:5], v[160:161] op_sel_hi:[1,0,1]
    v_pk_fma_f32 v[162:163], v[110:111], v[4:5], v[162:163] op_sel_hi:[1,0,1]
    v_pk_fma_f32 v[164:165], v[108:109], v[6:7], v[164:165] op_sel_hi:[1,0,1]
    v_pk_fma_f32 v[166:167], v[110:111], v[6:7], v[166:167] op_sel_hi:[1,0,1]
    v_pk_mul_f32 v[16:17], v[160:161], v[160:161]
    v_pk_mul_f32 v[18:19], v[162:163], v[162:163]
    v_pk_mul_f32 v[20:21], v[164:165], v[164:165]
    v_pk_mul_f32 v[22:23], v[166:167], v[166:167]
    v_pk_fma_f32 v[16:17], v[16:17], v[12:13], v[8:9] op_sel_hi:[1,0,0]
    v_pk_fma_f32 v[18:19], v[18:19], v[12:13], v[8:9] op_sel_hi:[1,0,0]
    v_pk_fma_f32 v[20:21], v[20:21], v[14:15], v[10:11] op_sel_hi:[1,0,0]
    v_pk_fma_f32 v[22:23], v[22:23], v[14:15], v[10:11] op_sel_hi:[1,0,0]
    v_pk_mul_f32 v[16:17], v[16:17], v[160:161]
    v_pk_mul_f32 v[18:19], v[18:19], v[162:163]
    v_pk_mul_f32 v[20:21], v[20:21], v[164:165]
    v_pk_mul_f32 v[22:23], v[22:23], v[166:167]
    v_exp_f32 v16, v16
    v_exp_f32 v17, v17
    v_exp_f32 v18, v18
    v_exp_f32 v19, v19
    v_exp_f32 v20, v20
    v_exp_f32 v21, v21
    v_exp_f32 v22, v22
    v_exp_f32 v23, v23
    v_pk_fma_f32 v[16:17], v[16:17], v[4:5], v[4:5] op_sel_hi:[1,0,0]
    v_pk_fma_f32 v[18:19], v[18:19], v[4:5], v[4:5] op_sel_hi:[1,0,0]
    v_pk_fma_f32 v[20:21], v[20:21], v[6:7], v[6:7] op_sel_hi:[1,0,0]
    v_pk_fma_f32 v[22:23], v[22:23], v[6:7], v[6:7] op_sel_hi:[1,0,0]
    v_rcp_f32 v16, v16
    v_rcp_f32 v17, v17
    v_rcp_f32 v18, v18
    v_rcp_f32 v19, v19
    v_rcp_f32 v20, v20
    v_rcp_f32 v21, v21
    v_rcp_f32 v22, v22
    v_rcp_f32 v23, v23
    v_pk_mul_f32 v[160:161], v[160:161], v[16:17]
    v_pk_mul_f32 v[162:163], v[162:163], v[18:19]
    v_pk_mul_f32 v[164:165], v[164:165], v[20:21]
    v_pk_mul_f32 v[166:167], v[166:167], v[22:23]
    v_cvt_pk_bf16_f32 v32, v160, v161
    v_cvt_pk_bf16_f32 v33, v162, v163
    v_cvt_pk_bf16_f32 v34, v164, v165
    v_cvt_pk_bf16_f32 v35, v166, v167
    s_nop 0
    v_permlane16_swap_b32 v32, v34
    v_permlane16_swap_b32 v33, v35
    buffer_store_dwordx4 v[32:35], v206, s[8:11], s98 offen offset:0
    v_pk_fma_f32 v[168:169], v[84:85], v[0:1], v[168:169] op_sel_hi:[1,0,1]
    v_pk_fma_f32 v[170:171], v[86:87], v[0:1], v[170:171] op_sel_hi:[1,0,1]
    v_pk_fma_f32 v[172:173], v[84:85], v[2:3], v[172:173] op_sel_hi:[1,0,1]
    v_pk_fma_f32 v[174:175], v[86:87], v[2:3], v[174:175] op_sel_hi:[1,0,1]
    v_pk_fma_f32 v[168:169], v[112:113], v[4:5], v[168:169] op_sel_hi:[1,0,1]
    v_pk_fma_f32 v[170:171], v[114:115], v[4:5], v[170:171] op_sel_hi:[1,0,1]
    v_pk_fma_f32 v[172:173], v[112:113], v[6:7], v[172:173] op_sel_hi:[1,0,1]
    v_pk_fma_f32 v[174:175], v[114:115], v[6:7], v[174:175] op_sel_hi:[1,0,1]
    v_pk_mul_f32 v[24:25], v[168:169], v[168:169]
    v_pk_mul_f32 v[26:27], v[170:171], v[170:171]
    v_pk_mul_f32 v[28:29], v[172:173], v[172:173]
    v_pk_mul_f32 v[30:31], v[174:175], v[174:175]
    v_pk_fma_f32 v[24:25], v[24:25], v[12:13], v[8:9] op_sel_hi:[1,0,0]
    v_pk_fma_f32 v[26:27], v[26:27], v[12:13], v[8:9] op_sel_hi:[1,0,0]
    v_pk_fma_f32 v[28:29], v[28:29], v[14:15], v[10:11] op_sel_hi:[1,0,0]
    v_pk_fma_f32 v[30:31], v[30:31], v[14:15], v[10:11] op_sel_hi:[1,0,0]
    v_pk_mul_f32 v[24:25], v[24:25], v[168:169]
    v_pk_mul_f32 v[26:27], v[26:27], v[170:171]
    v_pk_mul_f32 v[28:29], v[28:29], v[172:173]
    v_pk_mul_f32 v[30:31], v[30:31], v[174:175]
    v_exp_f32 v24, v24
    v_exp_f32 v25, v25
    v_exp_f32 v26, v26
    v_exp_f32 v27, v27
    v_exp_f32 v28, v28
    v_exp_f32 v29, v29
    v_exp_f32 v30, v30
    v_exp_f32 v31, v31
    v_pk_fma_f32 v[24:25], v[24:25], v[4:5], v[4:5] op_sel_hi:[1,0,0]
    v_pk_fma_f32 v[26:27], v[26:27], v[4:5], v[4:5] op_sel_hi:[1,0,0]
    v_pk_fma_f32 v[28:29], v[28:29], v[6:7], v[6:7] op_sel_hi:[1,0,0]
    v_pk_fma_f32 v[30:31], v[30:31], v[6:7], v[6:7] op_sel_hi:[1,0,0]
    v_rcp_f32 v24, v24
    v_rcp_f32 v25, v25
    v_rcp_f32 v26, v26
    v_rcp_f32 v27, v27
    v_rcp_f32 v28, v28
    v_rcp_f32 v29, v29
    v_rcp_f32 v30, v30
    v_rcp_f32 v31, v31
    v_pk_mul_f32 v[168:169], v[168:169], v[24:25]
    v_pk_mul_f32 v[170:171], v[170:171], v[26:27]
    v_pk_mul_f32 v[172:173], v[172:173], v[28:29]
    v_pk_mul_f32 v[174:175], v[174:175], v[30:31]
    v_cvt_pk_bf16_f32 v36, v168, v169
    v_cvt_pk_bf16_f32 v37, v170, v171
    v_cvt_pk_bf16_f32 v38, v172, v173
    v_cvt_pk_bf16_f32 v39, v174, v175
    s_nop 0
    v_permlane16_swap_b32 v36, v38
    v_permlane16_swap_b32 v37, v39
    buffer_store_dwordx4 v[36:39], v206, s[8:11], s98 offen offset:1024
    v_pk_fma_f32 v[176:177], v[88:89], v[0:1], v[176:177] op_sel_hi:[1,0,1]
    v_pk_fma_f32 v[178:179], v[90:91], v[0:1], v[178:179] op_sel_hi:[1,0,1]
    v_pk_fma_f32 v[180:181], v[88:89], v[2:3], v[180:181] op_sel_hi:[1,0,1]
    v_pk_fma_f32 v[182:183], v[90:91], v[2:3], v[182:183] op_sel_hi:[1,0,1]
    v_pk_fma_f32 v[176:177], v[116:117], v[4:5], v[176:177] op_sel_hi:[1,0,1]
    v_pk_fma_f32 v[178:179], v[118:119], v[4:5], v[178:179] op_sel_hi:[1,0,1]
    v_pk_fma_f32 v[180:181], v[116:117], v[6:7], v[180:181] op_sel_hi:[1,0,1]
    v_pk_fma_f32 v[182:183], v[118:119], v[6:7], v[182:183] op_sel_hi:[1,0,1]
    v_pk_mul_f32 v[16:17], v[176:177], v[176:177]
    v_pk_mul_f32 v[18:19], v[178:179], v[178:179]
    v_pk_mul_f32 v[20:21], v[180:181], v[180:181]
    v_pk_mul_f32 v[22:23], v[182:183], v[182:183]
    v_pk_fma_f32 v[16:17], v[16:17], v[12:13], v[8:9] op_sel_hi:[1,0,0]
    v_pk_fma_f32 v[18:19], v[18:19], v[12:13], v[8:9] op_sel_hi:[1,0,0]
    v_pk_fma_f32 v[20:21], v[20:21], v[14:15], v[10:11] op_sel_hi:[1,0,0]
    v_pk_fma_f32 v[22:23], v[22:23], v[14:15], v[10:11] op_sel_hi:[1,0,0]
    v_pk_mul_f32 v[16:17], v[16:17], v[176:177]
    v_pk_mul_f32 v[18:19], v[18:19], v[178:179]
    v_pk_mul_f32 v[20:21], v[20:21], v[180:181]
    v_pk_mul_f32 v[22:23], v[22:23], v[182:183]
    v_exp_f32 v16, v16
    v_exp_f32 v17, v17
    v_exp_f32 v18, v18
    v_exp_f32 v19, v19
    v_exp_f32 v20, v20
    v_exp_f32 v21, v21
    v_exp_f32 v22, v22
    v_exp_f32 v23, v23
    v_pk_fma_f32 v[16:17], v[16:17], v[4:5], v[4:5] op_sel_hi:[1,0,0]
    v_pk_fma_f32 v[18:19], v[18:19], v[4:5], v[4:5] op_sel_hi:[1,0,0]
    v_pk_fma_f32 v[20:21], v[20:21], v[6:7], v[6:7] op_sel_hi:[1,0,0]
    v_pk_fma_f32 v[22:23], v[22:23], v[6:7], v[6:7] op_sel_hi:[1,0,0]
    v_rcp_f32 v16, v16
    v_rcp_f32 v17, v17
    v_rcp_f32 v18, v18
    v_rcp_f32 v19, v19
    v_rcp_f32 v20, v20
    v_rcp_f32 v21, v21
    v_rcp_f32 v22, v22
    v_rcp_f32 v23, v23
    v_pk_mul_f32 v[176:177], v[176:177], v[16:17]
    v_pk_mul_f32 v[178:179], v[178:179], v[18:19]
    v_pk_mul_f32 v[180:181], v[180:181], v[20:21]
    v_pk_mul_f32 v[182:183], v[182:183], v[22:23]
    v_cvt_pk_bf16_f32 v32, v176, v177
    v_cvt_pk_bf16_f32 v33, v178, v179
    v_cvt_pk_bf16_f32 v34, v180, v181
    v_cvt_pk_bf16_f32 v35, v182, v183
    s_nop 0
    v_permlane16_swap_b32 v32, v34
    v_permlane16_swap_b32 v33, v35
    buffer_store_dwordx4 v[32:35], v206, s[8:11], s98 offen offset:2048
L_gelu2:
    s_waitcnt vmcnt(5)
    v_lshlrev_b32 v128, 16, v216
    v_and_b32 v129, 0xffff0000, v216
    v_lshlrev_b32 v130, 16, v217
    v_and_b32 v131, 0xffff0000, v217
    v_lshlrev_b32 v132, 16, v218
    v_and_b32 v133, 0xffff0000, v218
    v_lshlrev_b32 v134, 16, v219
    v_and_b32 v135, 0xffff0000, v219
    v_lshlrev_b32 v136, 16, v220
    v_and_b32 v137, 0xffff0000, v220
    v_lshlrev_b32 v138, 16, v221
    v_and_b32 v139, 0xffff0000, v221
    v_lshlrev_b32 v140, 16, v222
    v_and_b32 v141, 0xffff0000, v222
    v_lshlrev_b32 v142, 16, v223
    v_and_b32 v143, 0xffff0000, v223
    v_lshlrev_b32 v144, 16, v64
    v_and_b32 v145, 0xffff0000, v64
    v_lshlrev_b32 v146, 16, v65
    v_and_b32 v147, 0xffff0000, v65
    v_lshlrev_b32 v148, 16, v66
    v_and_b32 v149, 0xffff0000, v66
    v_lshlrev_b32 v150, 16, v67
    v_and_b32 v151, 0xffff0000, v67
    v_lshlrev_b32 v152, 16, v68
    v_and_b32 v153, 0xffff0000, v68
    v_lshlrev_b32 v154, 16, v69
    v_and_b32 v155, 0xffff0000, v69
    v_lshlrev_b32 v156, 16, v70
    v_and_b32 v157, 0xffff0000, v70
    v_lshlrev_b32 v158, 16, v71
    v_and_b32 v159, 0xffff0000, v71
    v_pk_add_f32 v[128:129], v[128:129], v[144:145]
    v_pk_add_f32 v[130:131], v[130:131], v[146:147]
    v_pk_add_f32 v[132:133], v[132:133], v[148:149]
    v_pk_add_f32 v[134:135], v[134:135], v[150:151]
    v_pk_add_f32 v[136:137], v[136:137], v[152:153]
    v_pk_add_f32 v[138:139], v[138:139], v[154:155]
    v_pk_add_f32 v[140:141], v[140:141], v[156:157]
    v_pk_add_f32 v[142:143], v[142:143], v[158:159]
    s_mul_i32 s3, s48, 12288
    s_add_u32 s3, s3, 114688
    v_add_u32 v192, s3, v206
    s_xor_b32 s3, s48, 1
    s_mul_i32 s3, s3, 12288
    s_add_u32 s3, s3, 114688
    v_add_u32 v193, s3, v206
    s_xor_b32 s3, s48, 2
    s_mul_i32 s3, s3, 12288
    s_add_u32 s3, s3, 118784
    v_add_u32 v194, s3, v206
    s_xor_b32 s3, s48, 3
    s_mul_i32 s3, s3, 12288
    s_add_u32 s3, s3, 122880
    v_add_u32 v195, s3, v206
    s_lshl_b32 s4, s33, 3
    s_sub_u32 s4, s4, s33
    s_lshl_b32 s4, s4, 20
    s_mul_i32 s5, s48, 28672
    s_add_u32 s4, s4, s5
    s_add_u32 s4, s4, 23068672
    s_mul_i32 s3, s55, 114688
    s_add_u32 s96, s3, s4
    s_xor_b32 s3, s55, 1
    s_mul_i32 s3, s3, 114688
    s_add_u32 s97, s3, s4
    s_add_u32 s58, s58, 0x200000
    s_cmp_lg_u32 s32, 0
    s_cselect_b32 s58, 0x800000, s58
    s_mov_b32 s47, s32
    s_lshl_b32 s3, s55, 15
    s_lshl_b32 s4, s56, 10
    s_add_u32 s3, s3, s4
    s_cmp_eq_u32 s58, 0x800000
    s_cselect_b32 s4, 0x200000, s58
    s_add_u32 s4, s4, s3
    s_lshr_b32 s4, s4, 3
    s_add_u32 s3, s3, s58
    s_add_u32 s98, s3, 2097152
    s_add_u32 s99, s4, 1048576
    s_waitcnt vmcnt(0) lgkmcnt(0)
    s_barrier
    s_add_u32 s51, s51, 1
    s_cmp_lg_u32 s48, 0
    s_cbranch_scc1 Lpub_29
    v_mov_b32 v200, s51
    s_lshl_b32 s3, s51, 4
    s_xor_b32 s3, s3, 0x5bd1e990
    s_or_b32 s3, s3, s52
    v_mov_b32 v201, s3
    v_mov_b32 v202, 0
    s_mov_b64 exec, 1
    s_cmp_lg_u32 s32, 0
    s_cbranch_scc1 Ldu_30
    buffer_store_dwordx2 v[200:201], v202, s[8:11], s60 offen sc1
    s_branch Ldv_31
Ldu_30:
    buffer_store_dwordx2 v[200:201], v202, s[8:11], s60 offen
Ldv_31:
    s_mov_b64 exec, -1
Lpub_29:
    s_nop 1
    s_cmp_lg_u32 s48, 0
    s_cbranch_scc1 Lpw_32
    v_mov_b32 v202, v206
    s_mov_b32 s3, s45
    s_mov_b64 exec, 0xffff
    s_mov_b32 s6, 0
Lpp_33:
    buffer_load_dwordx2 v[200:201], v202, s[8:11], s3 offen sc1
    s_add_u32 s6, s6, 1
    s_cmp_ge_u32 s6, 0x40000
    s_cbranch_scc1 Lpd_34
    s_waitcnt vmcnt(0)
    v_lshlrev_b32 v204, 4, v200
    v_subrev_u32 v200, s51, v200
    v_xor_b32 v201, 0x5bd1e990, v201
    v_cmp_gt_u32 vcc, 32, v200
    v_xor_b32 v201, v201, v204
    v_cmp_gt_u32 s[4:5], 16, v201
    s_nop 0
    s_and_b64 vcc, vcc, s[4:5]
    s_cmp_eq_u64 vcc, exec
    s_cbranch_scc0 Lpp_33
Lpd_34:
    s_waitcnt vmcnt(0)
    s_mov_b64 exec, -1
Lpw_32:
    s_barrier
    buffer_load_dwordx4 v[0:3], v206, s[8:11], s97 offen offset:0 sc1
    buffer_load_dwordx4 v[4:7], v206, s[8:11], s97 offen offset:1024 sc1
    buffer_load_dwordx4 v[8:11], v206, s[8:11], s97 offen offset:2048 sc1
    buffer_load_dwordx4 v[12:15], v206, s[8:11], s97 offen offset:3072 sc1
    s_add_u32 s97, s97, 4096
    buffer_load_dwordx4 v[16:19], v206, s[8:11], s97 offen offset:0 sc1
    buffer_load_dwordx4 v[20:23], v206, s[8:11], s97 offen offset:1024 sc1
    buffer_load_dwordx4 v[24:27], v206, s[8:11], s97 offen offset:2048 sc1
    buffer_load_dwordx4 v[28:31], v206, s[8:11], s97 offen offset:3072 sc1
    s_add_u32 s97, s97, 4096
    buffer_load_dwordx4 v[32:35], v206, s[8:11], s97 offen offset:0 sc1
    buffer_load_dwordx4 v[36:39], v206, s[8:11], s97 offen offset:1024 sc1
    buffer_load_dwordx4 v[40:43], v206, s[8:11], s97 offen offset:2048 sc1
    buffer_load_dwordx4 v[44:47], v206, s[8:11], s97 offen offset:3072 sc1
    s_add_u32 s97, s97, 4096
    s_cmp_lg_u32 s53, 0
    s_cbranch_scc1 Ll0_35
    s_mul_i32 s3, s48, 12288
    s_add_u32 s3, s3, 114688
    v_add_u32 v200, s3, v215
    v_xor_b32 v201, 64, v200
    ds_read_b64_tr_b16 a[192:193], v200 offset:0
    ds_read_b64_tr_b16 a[194:195], v200 offset:512
    ds_read_b64_tr_b16 a[196:197], v201 offset:0
    ds_read_b64_tr_b16 a[198:199], v201 offset:512
    ds_read_b64_tr_b16 a[200:201], v200 offset:2048
    ds_read_b64_tr_b16 a[202:203], v200 offset:2560
    ds_read_b64_tr_b16 a[204:205], v201 offset:2048
    ds_read_b64_tr_b16 a[206:207], v201 offset:2560
    s_waitcnt lgkmcnt(7)
    ds_read_b64_tr_b16 a[208:209], v200 offset:4096
    ds_read_b64_tr_b16 a[210:211], v200 offset:4608
    ds_read_b64_tr_b16 a[212:213], v201 offset:4096
    ds_read_b64_tr_b16 a[214:215], v201 offset:4608
    ds_read_b64_tr_b16 a[216:217], v200 offset:6144
    ds_read_b64_tr_b16 a[218:219], v200 offset:6656
    ds_read_b64_tr_b16 a[220:221], v201 offset:6144
    ds_read_b64_tr_b16 a[222:223], v201 offset:6656
    s_waitcnt lgkmcnt(7)
    s_waitcnt lgkmcnt(0)
Ll0_35:
    buffer_load_dwordx4 v[48:51], v206, s[8:11], s97 offen offset:0 sc1
    s_waitcnt vmcnt(12)
    v_mfma_f32_32x32x16_bf16 v[144:159], a[0:3], v[0:3], 0
    v_mfma_f32_32x32x16_bf16 v[176:191], a[4:7], v[0:3], 0
    buffer_load_dwordx4 v[52:55], v206, s[8:11], s97 offen offset:1024 sc1
    s_waitcnt vmcnt(12)
    v_mfma_f32_32x32x16_bf16 v[144:159], a[8:11], v[4:7], v[144:159]
    v_mfma_f32_32x32x16_bf16 v[176:191], a[12:15], v[4:7], v[176:191]
    buffer_load_dwordx4 v[56:59], v206, s[8:11], s97 offen offset:2048 sc1
    s_waitcnt vmcnt(12)
    v_mfma_f32_32x32x16_bf16 v[144:159], a[16:19], v[8:11], v[144:159]
    v_mfma_f32_32x32x16_bf16 v[176:191], a[20:23], v[8:11], v[176:191]
    buffer_load_dwordx4 v[60:63], v206, s[8:11], s97 offen offset:3072 sc1
    s_add_u32 s97, s97, 4096
    s_waitcnt vmcnt(12)
    v_mfma_f32_32x32x16_bf16 v[144:159], a[24:27], v[12:15], v[144:159]
    v_mfma_f32_32x32x16_bf16 v[176:191], a[28:31], v[12:15], v[176:191]
    buffer_load_dwordx4 v[64:67], v206, s[8:11], s97 offen offset:0 sc1
    s_waitcnt vmcnt(12)
    v_mfma_f32_32x32x16_bf16 v[144:159], a[32:35], v[16:19], v[144:159]
    v_mfma_f32_32x32x16_bf16 v[176:191], a[36:39], v[16:19], v[176:191]
    buffer_load_dwordx4 v[68:71], v206, s[8:11], s97 offen offset:1024 sc1
    s_waitcnt vmcnt(12)
    v_mfma_f32_32x32x16_bf16 v[144:159], a[40:43], v[20:23], v[144:159]
    v_mfma_f32_32x32x16_bf16 v[176:191], a[44:47], v[20:23], v[176:191]
    buffer_load_dwordx4 v[72:75], v206, s[8:11], s97 offen offset:2048 sc1
    s_waitcnt vmcnt(12)
    v_mfma_f32_32x32x16_bf16 v[144:159], a[48:51], v[24:27], v[144:159]
    v_mfma_f32_32x32x16_bf16 v[176:191], a[52:55], v[24:27], v[176:191]
    buffer_load_dwordx4 v[76:79], v206, s[8:11], s97 offen offset:3072 sc1
    s_add_u32 s97, s97, 4096
    s_waitcnt vmcnt(12)
    v_mfma_f32_32x32x16_bf16 v[144:159], a[56:59], v[28:31], v[144:159]
    v_mfma_f32_32x32x16_bf16 v[176:191], a[60:63], v[28:31], v[176:191]
    buffer_load_dwordx4 v[80:83], v206, s[8:11], s97 offen offset:0 sc1
    s_waitcnt vmcnt(12)
    v_mfma_f32_32x32x16_bf16 v[144:159], a[64:67], v[32:35], v[144:159]
    v_mfma_f32_32x32x16_bf16 v[176:191], a[68:71], v[32:35], v[176:191]
    buffer_load_dwordx4 v[84:87], v206, s[8:11], s97 offen offset:1024 sc1
    s_waitcnt vmcnt(12)
    v_mfma_f32_32x32x16_bf16 v[144:159], a[72:75], v[36:39], v[144:159]
    v_mfma_f32_32x32x16_bf16 v[176:191], a[76:79], v[36:39], v[176:191]
    buffer_load_dwordx4 v[88:91], v206, s[8:11], s97 offen offset:2048 sc1
    s_waitcnt vmcnt(12)
    v_mfma_f32_32x32x16_bf16 v[144:159], a[80:83], v[40:43], v[144:159]
    v_mfma_f32_32x32x16_bf16 v[176:191], a[84:87], v[40:43], v[176:191]
    buffer_load_dwordx4 v[92:95], v206, s[8:11], s97 offen offset:3072 sc1
    s_add_u32 s97, s97, 4096
    s_waitcnt vmcnt(12)
    v_mfma_f32_32x32x16_bf16 v[144:159], a[88:91], v[44:47], v[144:159]
    v_mfma_f32_32x32x16_bf16 v[176:191], a[92:95], v[44:47], v[176:191]
    buffer_load_dwordx4 v[96:99], v206, s[8:11], s97 offen offset:0 sc1
    s_waitcnt vmcnt(12)
    v_mfma_f32_32x32x16_bf16 v[144:159], a[96:99], v[48:51], v[144:159]
    v_mfma_f32_32x32x16_bf16 v[176:191], a[100:103], v[48:51], v[176:191]
    buffer_load_dwordx4 v[100:103], v206, s[8:11], s97 offen offset:1024 sc1
    s_waitcnt vmcnt(12)
    v_mfma_f32_32x32x16_bf16 v[144:159], a[104:107], v[52:55], v[144:159]
    v_mfma_f32_32x32x16_bf16 v[176:191], a[108:111], v[52:55], v[176:191]
    buffer_load_dwordx4 v[104:107], v206, s[8:11], s97 offen offset:2048 sc1
    s_waitcnt vmcnt(12)
    v_mfma_f32_32x32x16_bf16 v[144:159], a[112:115], v[56:59], v[144:159]
    v_mfma_f32_32x32x16_bf16 v[176:191], a[116:119], v[56:59], v[176:191]
    buffer_load_dwordx4 v[108:111], v206, s[8:11], s97 offen offset:3072 sc1
    s_add_u32 s97, s97, 4096
    s_waitcnt vmcnt(12)
    v_mfma_f32_32x32x16_bf16 v[144:159], a[120:123], v[60:63], v[144:159]
    v_mfma_f32_32x32x16_bf16 v[176:191], a[124:127], v[60:63], v[176:191]
    buffer_load_dwordx4 v[112:115], v206, s[8:11], s96 offen offset:0 sc1
    s_waitcnt vmcnt(12)
    v_mfma_f32_32x32x16_bf16 v[144:159], a[128:131], v[64:67], v[144:159]
    v_mfma_f32_32x32x16_bf16 v[176:191], a[132:135], v[64:67], v[176:191]
    buffer_load_dwordx4 v[116:119], v206, s[8:11], s96 offen offset:1024 sc1
    s_waitcnt vmcnt(12)
    v_mfma_f32_32x32x16_bf16 v[144:159], a[136:139], v[68:71], v[144:159]
    v_mfma_f32_32x32x16_bf16 v[176:191], a[140:143], v[68:71], v[176:191]
    buffer_load_dwordx4 v[120:123], v206, s[8:11], s96 offen offset:2048 sc1
    s_waitcnt vmcnt(12)
    v_mfma_f32_32x32x16_bf16 v[144:159], a[144:147], v[72:75], v[144:159]
    v_mfma_f32_32x32x16_bf16 v[176:191], a[148:151], v[72:75], v[176:191]
    buffer_load_dwordx4 v[124:127], v206, s[8:11], s96 offen offset:3072 sc1
    s_add_u32 s96, s96, 4096
    s_waitcnt vmcnt(12)
    v_mfma_f32_32x32x16_bf16 v[144:159], a[152:155], v[76:79], v[144:159]
    v_mfma_f32_32x32x16_bf16 v[176:191], a[156:159], v[76:79], v[176:191]
    buffer_load_dwordx4 v[0:3], v206, s[8:11], s96 offen offset:0 sc1
    s_waitcnt vmcnt(12)
    v_mfma_f32_32x32x16_bf16 v[144:159], a[160:163], v[80:83], v[144:159]
    v_mfma_f32_32x32x16_bf16 v[176:191], a[164:167], v[80:83], v[176:191]
    buffer_load_dwordx4 v[4:7], v206, s[8:11], s96 offen offset:1024 sc1
    s_waitcnt vmcnt(12)
    v_mfma_f32_32x32x16_bf16 v[144:159], a[168:171], v[84:87], v[144:159]
    v_mfma_f32_32x32x16_bf16 v[176:191], a[172:175], v[84:87], v[176:191]
    buffer_load_dwordx4 v[8:11], v206, s[8:11], s96 offen offset:2048 sc1
    s_waitcnt vmcnt(12)
    v_mfma_f32_32x32x16_bf16 v[144:159], a[176:179], v[88:91], v[144:159]
    v_mfma_f32_32x32x16_bf16 v[176:191], a[180:183], v[88:91], v[176:191]
    buffer_load_dwordx4 v[12:15], v206, s[8:11], s96 offen offset:3072 sc1
    s_add_u32 s96, s96, 4096
    s_waitcnt vmcnt(12)
    v_mfma_f32_32x32x16_bf16 v[144:159], a[184:187], v[92:95], v[144:159]
    v_mfma_f32_32x32x16_bf16 v[176:191], a[188:191], v[92:95], v[176:191]
    buffer_load_dwordx4 v[16:19], v206, s[8:11], s96 offen offset:0 sc1
    s_waitcnt vmcnt(12)
    v_mfma_f32_32x32x16_bf16 v[144:159], a[192:195], v[96:99], v[144:159]
    v_mfma_f32_32x32x16_bf16 v[176:191], a[196:199], v[96:99], v[176:191]
    buffer_load_dwordx4 v[20:23], v206, s[8:11], s96 offen offset:1024 sc1
    s_waitcnt vmcnt(12)
    v_mfma_f32_32x32x16_bf16 v[144:159], a[200:203], v[100:103], v[144:159]
    v_mfma_f32_32x32x16_bf16 v[176:191], a[204:207], v[100:103], v[176:191]
    buffer_load_dwordx4 v[24:27], v206, s[8:11], s96 offen offset:2048 sc1
    s_waitcnt vmcnt(12)
    v_mfma_f32_32x32x16_bf16 v[144:159], a[208:211], v[104:107], v[144:159]
    v_mfma_f32_32x32x16_bf16 v[176:191], a[212:215], v[104:107], v[176:191]
    buffer_load_dwordx4 v[28:31], v206, s[8:11], s96 offen offset:3072 sc1
    s_add_u32 s96, s96, 4096
    s_waitcnt vmcnt(12)
    v_mfma_f32_32x32x16_bf16 v[144:159], a[216:219], v[108:111], v[144:159]
    v_mfma_f32_32x32x16_bf16 v[176:191], a[220:223], v[108:111], v[176:191]
    buffer_load_dwordx4 v[32:35], v206, s[8:11], s96 offen offset:0 sc1
    s_waitcnt vmcnt(12)
    v_mfma_f32_32x32x16_bf16 v[128:143], a[0:3], v[112:115], v[128:143]
    v_mfma_f32_32x32x16_bf16 v[160:175], a[4:7], v[112:115], 0
    buffer_load_dwordx4 v[36:39], v206, s[8:11], s96 offen offset:1024 sc1
    s_waitcnt vmcnt(12)
    v_mfma_f32_32x32x16_bf16 v[128:143], a[8:11], v[116:119], v[128:143]
    v_mfma_f32_32x32x16_bf16 v[160:175], a[12:15], v[116:119], v[160:175]
    buffer_load_dwordx4 v[40:43], v206, s[8:11], s96 offen offset:2048 sc1
    s_waitcnt vmcnt(12)
    v_mfma_f32_32x32x16_bf16 v[128:143], a[16:19], v[120:123], v[128:143]
    ds_write_b128 v192, v[144:147] offset:0
    v_mfma_f32_32x32x16_bf16 v[160:175], a[20:23], v[120:123], v[160:175]
    ds_write_b128 v192, v[148:151] offset:1024
    buffer_load_dwordx4 v[44:47], v206, s[8:11], s96 offen offset:3072 sc1
    s_add_u32 s96, s96, 4096
    s_waitcnt vmcnt(12)
    v_mfma_f32_32x32x16_bf16 v[128:143], a[24:27], v[124:127], v[128:143]
    ds_write_b128 v192, v[152:155] offset:2048
    v_mfma_f32_32x32x16_bf16 v[160:175], a[28:31], v[124:127], v[160:175]
    ds_write_b128 v192, v[156:159] offset:3072
    buffer_load_dwordx4 v[48:51], v206, s[8:11], s96 offen offset:0 sc1
    s_waitcnt vmcnt(12)
    v_mfma_f32_32x32x16_bf16 v[128:143], a[32:35], v[0:3], v[128:143]
    ds_write_b128 v192, v[176:179] offset:8192
    v_mfma_f32_32x32x16_bf16 v[160:175], a[36:39], v[0:3], v[160:175]
    ds_write_b128 v192, v[180:183] offset:9216
    buffer_load_dwordx4 v[52:55], v206, s[8:11], s96 offen offset:1024 sc1
    s_waitcnt vmcnt(12)
    v_mfma_f32_32x32x16_bf16 v[128:143], a[40:43], v[4:7], v[128:143]
    ds_write_b128 v192, v[184:187] offset:10240
    v_mfma_f32_32x32x16_bf16 v[160:175], a[44:47], v[4:7], v[160:175]
    ds_write_b128 v192, v[188:191] offset:11264
    buffer_load_dwordx4 v[56:59], v206, s[8:11], s96 offen offset:2048 sc1
    s_waitcnt vmcnt(12)
    v_mfma_f32_32x32x16_bf16 v[128:143], a[48:51], v[8:11], v[128:143]
    v_mfma_f32_32x32x16_bf16 v[160:175], a[52:55], v[8:11], v[160:175]
    buffer_load_dwordx4 v[60:63], v206, s[8:11], s96 offen offset:3072 sc1
    s_add_u32 s96, s96, 4096
    s_waitcnt vmcnt(12)
    v_mfma_f32_32x32x16_bf16 v[128:143], a[56:59], v[12:15], v[128:143]
    v_mfma_f32_32x32x16_bf16 v[160:175], a[60:63], v[12:15], v[160:175]
    buffer_load_dwordx4 v[64:67], v206, s[8:11], s96 offen offset:0 sc1
    s_waitcnt vmcnt(12)
    v_mfma_f32_32x32x16_bf16 v[128:143], a[64:67], v[16:19], v[128:143]
    v_mfma_f32_32x32x16_bf16 v[160:175], a[68:71], v[16:19], v[160:175]
    buffer_load_dwordx4 v[68:71], v206, s[8:11], s96 offen offset:1024 sc1
    s_waitcnt vmcnt(12)
    v_mfma_f32_32x32x16_bf16 v[128:143], a[72:75], v[20:23], v[128:143]
    v_mfma_f32_32x32x16_bf16 v[160:175], a[76:79], v[20:23], v[160:175]
    buffer_load_dwordx4 v[72:75], v206, s[8:11], s96 offen offset:2048 sc1
    s_waitcnt vmcnt(12)
    v_mfma_f32_32x32x16_bf16 v[128:143], a[80:83], v[24:27], v[128:143]
    v_mfma_f32_32x32x16_bf16 v[160:175], a[84:87], v[24:27], v[160:175]
    buffer_load_dwordx4 v[76:79], v206, s[8:11], s96 offen offset:3072 sc1
    s_add_u32 s96, s96, 4096
    s_waitcnt vmcnt(12)
    v_mfma_f32_32x32x16_bf16 v[128:143], a[88:91], v[28:31], v[128:143]
    v_mfma_f32_32x32x16_bf16 v[160:175], a[92:95], v[28:31], v[160:175]
    buffer_load_dwordx4 v[80:83], v206, s[8:11], s96 offen offset:0 sc1
    s_waitcnt vmcnt(12)
    v_mfma_f32_32x32x16_bf16 v[128:143], a[96:99], v[32:35], v[128:143]
    v_mfma_f32_32x32x16_bf16 v[160:175], a[100:103], v[32:35], v[160:175]
    buffer_load_dwordx4 v[84:87], v206, s[8:11], s96 offen offset:1024 sc1
    s_waitcnt vmcnt(12)
    v_mfma_f32_32x32x16_bf16 v[128:143], a[104:107], v[36:39], v[128:143]
    v_mfma_f32_32x32x16_bf16 v[160:175], a[108:111], v[36:39], v[160:175]
    buffer_load_dwordx4 v[88:91], v206, s[8:11], s96 offen offset:2048 sc1
    s_waitcnt vmcnt(12)
    v_mfma_f32_32x32x16_bf16 v[128:143], a[112:115], v[40:43], v[128:143]
    v_mfma_f32_32x32x16_bf16 v[160:175], a[116:119], v[40:43], v[160:175]
    buffer_load_dwordx4 v[92:95], v206, s[8:11], s96 offen offset:3072 sc1
    s_add_u32 s96, s96, 4096
    s_waitcnt vmcnt(12)
    v_mfma_f32_32x32x16_bf16 v[128:143], a[120:123], v[44:47], v[128:143]
    v_mfma_f32_32x32x16_bf16 v[160:175], a[124:127], v[44:47], v[160:175]
    s_waitcnt vmcnt(11)
    v_mfma_f32_32x32x16_bf16 v[128:143], a[128:131], v[48:51], v[128:143]
    v_mfma_f32_32x32x16_bf16 v[160:175], a[132:135], v[48:51], v[160:175]
    s_waitcnt vmcnt(10)
    v_mfma_f32_32x32x16_bf16 v[128:143], a[136:139], v[52:55], v[128:143]
    v_mfma_f32_32x32x16_bf16 v[160:175], a[140:143], v[52:55], v[160:175]
    s_waitcnt vmcnt(9)
    v_mfma_f32_32x32x16_bf16 v[128:143], a[144:147], v[56:59], v[128:143]
    v_mfma_f32_32x32x16_bf16 v[160:175], a[148:151], v[56:59], v[160:175]
    s_waitcnt vmcnt(8)
    v_mfma_f32_32x32x16_bf16 v[128:143], a[152:155], v[60:63], v[128:143]
    v_mfma_f32_32x32x16_bf16 v[160:175], a[156:159], v[60:63], v[160:175]
    s_waitcnt vmcnt(7)
    v_mfma_f32_32x32x16_bf16 v[128:143], a[160:163], v[64:67], v[128:143]
    v_mfma_f32_32x32x16_bf16 v[160:175], a[164:167], v[64:67], v[160:175]
    s_waitcnt vmcnt(6)
    v_mfma_f32_32x32x16_bf16 v[128:143], a[168:171], v[68:71], v[128:143]
    v_mfma_f32_32x32x16_bf16 v[160:175], a[172:175], v[68:71], v[160:175]
    s_waitcnt vmcnt(5)
    v_mfma_f32_32x32x16_bf16 v[128:143], a[176:179], v[72:75], v[128:143]
    v_mfma_f32_32x32x16_bf16 v[160:175], a[180:183], v[72:75], v[160:175]
    s_waitcnt vmcnt(4)
    v_mfma_f32_32x32x16_bf16 v[128:143], a[184:187], v[76:79], v[128:143]
    v_mfma_f32_32x32x16_bf16 v[160:175], a[188:191], v[76:79], v[160:175]
    s_waitcnt vmcnt(3)
    v_mfma_f32_32x32x16_bf16 v[128:143], a[192:195], v[80:83], v[128:143]
    v_mfma_f32_32x32x16_bf16 v[160:175], a[196:199], v[80:83], v[160:175]
    s_waitcnt vmcnt(2)
    v_mfma_f32_32x32x16_bf16 v[128:143], a[200:203], v[84:87], v[128:143]
    v_mfma_f32_32x32x16_bf16 v[160:175], a[204:207], v[84:87], v[160:175]
    s_waitcnt vmcnt(1)
    v_mfma_f32_32x32x16_bf16 v[128:143], a[208:211], v[88:91], v[128:143]
    v_mfma_f32_32x32x16_bf16 v[160:175], a[212:215], v[88:91], v[160:175]
    s_waitcnt vmcnt(0)
    v_mfma_f32_32x32x16_bf16 v[160:175], a[220:223], v[92:95], v[160:175]
    v_mfma_f32_32x32x16_bf16 v[128:143], a[216:219], v[92:95], v[128:143]
    s_cmp_lg_u32 s53, 0
    s_cbranch_scc1 L_final
    s_nop 8
    ds_write_b128 v192, v[160:163] offset:4096
    ds_write_b128 v192, v[164:167] offset:5120
    ds_write_b128 v192, v[168:171] offset:6144
    ds_write_b128 v192, v[172:175] offset:7168
    s_waitcnt lgkmcnt(0)
    s_barrier
    ds_read_b128 v[144:147], v193 offset:0
    ds_read_b128 v[148:151], v193 offset:1024
    ds_read_b128 v[152:155], v193 offset:2048
    ds_read_b128 v[156:159], v193 offset:3072
    ds_read_b128 v[160:163], v194 offset:0
    ds_read_b128 v[164:167], v194 offset:1024
    ds_read_b128 v[168:171], v194 offset:2048
    ds_read_b128 v[172:175], v194 offset:3072
    ds_read_b128 v[176:179], v195 offset:0
    ds_read_b128 v[180:183], v195 offset:1024
    ds_read_b128 v[184:187], v195 offset:2048
    ds_read_b128 v[188:191], v195 offset:3072
    s_waitcnt lgkmcnt(8)
    v_pk_add_f32 v[128:129], v[128:129], v[144:145]
    v_pk_add_f32 v[130:131], v[130:131], v[146:147]
    v_pk_add_f32 v[132:133], v[132:133], v[148:149]
    v_pk_add_f32 v[134:135], v[134:135], v[150:151]
    v_pk_add_f32 v[136:137], v[136:137], v[152:153]
    v_pk_add_f32 v[138:139], v[138:139], v[154:155]
    v_pk_add_f32 v[140:141], v[140:141], v[156:157]
    v_pk_add_f32 v[142:143], v[142:143], v[158:159]
    s_waitcnt lgkmcnt(4)
    v_pk_add_f32 v[128:129], v[128:129], v[160:161]
    v_pk_add_f32 v[130:131], v[130:131], v[162:163]
    v_pk_add_f32 v[132:133], v[132:133], v[164:165]
    v_pk_add_f32 v[134:135], v[134:135], v[166:167]
    v_pk_add_f32 v[136:137], v[136:137], v[168:169]
    v_pk_add_f32 v[138:139], v[138:139], v[170:171]
    v_pk_add_f32 v[140:141], v[140:141], v[172:173]
    v_pk_add_f32 v[142:143], v[142:143], v[174:175]
    s_waitcnt lgkmcnt(0)
    v_pk_add_f32 v[128:129], v[128:129], v[176:177]
    v_pk_add_f32 v[130:131], v[130:131], v[178:179]
    v_pk_add_f32 v[132:133], v[132:133], v[180:181]
    v_pk_add_f32 v[134:135], v[134:135], v[182:183]
    v_pk_add_f32 v[136:137], v[136:137], v[184:185]
    v_pk_add_f32 v[138:139], v[138:139], v[186:187]
    v_pk_add_f32 v[140:141], v[140:141], v[188:189]
    v_pk_add_f32 v[142:143], v[142:143], v[190:191]
    v_cvt_pk_bf16_f32 v216, v128, v129
    v_cvt_pk_bf16_f32 v217, v130, v131
    v_cvt_pk_bf16_f32 v218, v132, v133
    v_cvt_pk_bf16_f32 v219, v134, v135
    v_cvt_pk_bf16_f32 v220, v136, v137
    v_cvt_pk_bf16_f32 v221, v138, v139
    v_cvt_pk_bf16_f32 v222, v140, v141
    v_cvt_pk_bf16_f32 v223, v142, v143
    s_cmp_lg_u32 s47, 0
    s_cbranch_scc1 Ldu_36
    buffer_store_dwordx4 v[216:219], v206, s[8:11], s98 offen sc1
    buffer_store_dwordx4 v[220:223], v206, s[8:11], s98 offen offset:1024 sc1
    s_branch Ldv_37
Ldu_36:
    buffer_store_dwordx4 v[216:219], v206, s[8:11], s98 offen
    buffer_store_dwordx4 v[220:223], v206, s[8:11], s98 offen offset:1024
Ldv_37:
    v_pk_add_f32 v[144:145], v[128:129], v[130:131]
    v_pk_mul_f32 v[146:147], v[128:129], v[128:129]
    v_pk_fma_f32 v[146:147], v[130:131], v[130:131], v[146:147]
    v_pk_add_f32 v[144:145], v[144:145], v[132:133]
    v_pk_fma_f32 v[146:147], v[132:133], v[132:133], v[146:147]
    v_pk_add_f32 v[144:145], v[144:145], v[134:135]
    v_pk_fma_f32 v[146:147], v[134:135], v[134:135], v[146:147]
    v_pk_add_f32 v[144:145], v[144:145], v[136:137]
    v_pk_fma_f32 v[146:147], v[136:137], v[136:137], v[146:147]
    v_pk_add_f32 v[144:145], v[144:145], v[138:139]
    v_pk_fma_f32 v[146:147], v[138:139], v[138:139], v[146:147]
    v_pk_add_f32 v[144:145], v[144:145], v[140:141]
    v_pk_fma_f32 v[146:147], v[140:141], v[140:141], v[146:147]
    v_pk_add_f32 v[144:145], v[144:145], v[142:143]
    v_pk_fma_f32 v[146:147], v[142:143], v[142:143], v[146:147]
    v_add_f32 v144, v144, v145
    v_add_f32 v146, v146, v147
    s_nop 1
    v_permlane32_swap_b32 v144, v146
    v_add_f32 v144, v144, v146
    s_cmp_lg_u32 s47, 0
    s_cbranch_scc1 Ldu_38
    buffer_store_dword v144, v213, s[8:11], s99 offen sc1
    s_branch Ldv_39
Ldu_38:
    buffer_store_dword v144, v213, s[8:11], s99 offen
Ldv_39:
    s_getpc_b64 s[4:5]
Lct_40:
    s_sub_u32 s4, s4, Lct_40-L_pc0
    s_subb_u32 s5, s5, 0
    s_lshr_b32 s3, s2, 3
    s_lshl_b32 s3, s3, 2
    s_add_u32 s3, s3, s48
    s_lshl_b32 s3, s3, 9
    v_lshlrev_b32 v2, 7, v207
    v_add_u32 v2, s3, v2
    v_min_u32 v2, L_code_end-L_pc0-4, v2
    v_mov_b32 v1, s5
    v_add_co_u32 v0, vcc, s4, v2
    s_nop 1
    v_addc_co_u32 v1, vcc, 0, v1, vcc
    s_mov_b64 exec, 15
    global_load_dword v211, v[0:1], off
    s_mov_b64 exec, -1
    s_mov_b32 m0, 98304
    s_nop 0
    buffer_load_dwordx4 v206, s[8:11], s59 offen sc1 lds
    s_lshl_b32 s5, s48, 8
    s_add_u32 s5, s5, 99328
    v_and_b32 v203, 31, v207
    v_lshl_add_u32 v203, v203, 2, s5
    v_lshrrev_b32 v199, 5, v207
    v_lshlrev_b32 v199, 4, v199
    v_add_u32 v198, s5, v199
    v_add_u32 v199, 98304, v199
    v_and_b32 v197, 31, v207
    v_lshlrev_b32 v197, 2, v197
    v_add_u32 v197, 98432, v197
    v_add_u32 v192, 49152, v208
    s_lshl_b32 s96, s54, 15
    s_cmp_eq_u32 s58, 0x800000
    s_cselect_b32 s97, 0x200000, s58
    s_add_u32 s97, s97, s96
    s_lshr_b32 s97, s97, 3
    s_add_u32 s96, s96, s58
    s_add_u32 s96, s96, 2097152
    s_add_u32 s97, s97, 1048576
    s_waitcnt vmcnt(2) lgkmcnt(0)
    s_barrier
    s_add_u32 s51, s51, 1
    s_cmp_lg_u32 s48, 0
    s_cbranch_scc1 Lpub_41
    v_mov_b32 v200, s51
    s_lshl_b32 s3, s51, 4
    s_xor_b32 s3, s3, 0x5bd1e990
    s_or_b32 s3, s3, s52
    v_mov_b32 v201, s3
    v_mov_b32 v202, 0
    s_mov_b64 exec, 1
    s_cmp_lg_u32 s32, 0
    s_cbranch_scc1 Ldu_42
    buffer_store_dwordx2 v[200:201], v202, s[8:11], s44 offen sc1
    s_branch Ldv_43
Ldu_42:
    buffer_store_dwordx2 v[200:201], v202, s[8:11], s44 offen
Ldv_43:
    s_mov_b64 exec, -1
Lpub_41:
    s_nop 1
    s_waitcnt vmcnt(0)
    s_mov_b32 s53, 1
    s_xor_b32 s33, s32, 1
    s_mov_b32 s47, s32
    s_branch L_layer
L_final:
    s_nop 7
    s_nop 3
    ds_write_b128 v192, v[160:163] offset:4096
    ds_write_b128 v192, v[164:167] offset:5120
    ds_write_b128 v192, v[168:171] offset:6144
    ds_write_b128 v192, v[172:175] offset:7168
    s_waitcnt lgkmcnt(0)
    s_barrier
    ds_read_b128 v[144:147], v193 offset:0
    ds_read_b128 v[148:151], v193 offset:1024
    ds_read_b128 v[152:155], v193 offset:2048
    ds_read_b128 v[156:159], v193 offset:3072
    ds_read_b128 v[160:163], v194 offset:0
    ds_read_b128 v[164:167], v194 offset:1024
    ds_read_b128 v[168:171], v194 offset:2048
    ds_read_b128 v[172:175], v194 offset:3072
    ds_read_b128 v[176:179], v195 offset:0
    ds_read_b128 v[180:183], v195 offset:1024
    ds_read_b128 v[184:187], v195 offset:2048
    ds_read_b128 v[188:191], v195 offset:3072
    s_waitcnt lgkmcnt(8)
    v_pk_add_f32 v[128:129], v[128:129], v[144:145]
    v_pk_add_f32 v[130:131], v[130:131], v[146:147]
    v_pk_add_f32 v[132:133], v[132:133], v[148:149]
    v_pk_add_f32 v[134:135], v[134:135], v[150:151]
    v_pk_add_f32 v[136:137], v[136:137], v[152:153]
    v_pk_add_f32 v[138:139], v[138:139], v[154:155]
    v_pk_add_f32 v[140:141], v[140:141], v[156:157]
    v_pk_add_f32 v[142:143], v[142:143], v[158:159]
    s_waitcnt lgkmcnt(4)
    v_pk_add_f32 v[128:129], v[128:129], v[160:161]
    v_pk_add_f32 v[130:131], v[130:131], v[162:163]
    v_pk_add_f32 v[132:133], v[132:133], v[164:165]
    v_pk_add_f32 v[134:135], v[134:135], v[166:167]
    v_pk_add_f32 v[136:137], v[136:137], v[168:169]
    v_pk_add_f32 v[138:139], v[138:139], v[170:171]
    v_pk_add_f32 v[140:141], v[140:141], v[172:173]
    v_pk_add_f32 v[142:143], v[142:143], v[174:175]
    s_waitcnt lgkmcnt(0)
    v_pk_add_f32 v[128:129], v[128:129], v[176:177]
    v_pk_add_f32 v[130:131], v[130:131], v[178:179]
    v_pk_add_f32 v[132:133], v[132:133], v[180:181]
    v_pk_add_f32 v[134:135], v[134:135], v[182:183]
    v_pk_add_f32 v[136:137], v[136:137], v[184:185]
    v_pk_add_f32 v[138:139], v[138:139], v[186:187]
    v_pk_add_f32 v[140:141], v[140:141], v[188:189]
    v_pk_add_f32 v[142:143], v[142:143], v[190:191]
    v_cvt_pk_bf16_f32 v216, v128, v129
    v_cvt_pk_bf16_f32 v217, v130, v131
    v_cvt_pk_bf16_f32 v218, v132, v133
    v_cvt_pk_bf16_f32 v219, v134, v135
    v_cvt_pk_bf16_f32 v220, v136, v137
    v_cvt_pk_bf16_f32 v221, v138, v139
    v_cvt_pk_bf16_f32 v222, v140, v141
    v_cvt_pk_bf16_f32 v223, v142, v143
    s_nop 1
    v_permlane32_swap_b32 v216, v218
    v_permlane32_swap_b32 v217, v219
    v_permlane32_swap_b32 v220, v222
    v_permlane32_swap_b32 v221, v223
    v_and_b32 v1, 31, v207
    v_lshrrev_b32 v2, 5, v207
    v_lshlrev_b32 v1, 10, v1
    v_lshl_add_u32 v1, v2, 4, v1
    s_lshl_b32 s3, s55, 15
    s_lshl_b32 s4, s56, 5
    s_add_u32 s3, s3, s4
    s_mov_b32 s32, s34
    s_mov_b32 s33, s35
    s_mov_b32 s34, 0x200000
    s_mov_b32 s35, 0x00020000
    buffer_store_dwordx4 v[216:219], v1, s[32:35], s3 offen
    buffer_store_dwordx4 v[220:223], v1, s[32:35], s3 offen offset:32
L_end:
    s_endpgm
L_kvlate:
    v_lshlrev_b32 v202, 3, v207
    s_mov_b32 s3, s62
    s_add_u32 s7, s51, s46
    s_mov_b64 exec, 3
    s_mov_b32 s6, 0
Lpp_100001:
    buffer_load_dwordx2 v[200:201], v202, s[8:11], s3 offen sc1
    s_add_u32 s6, s6, 1
    s_cmp_ge_u32 s6, 0x40000
    s_cbranch_scc1 Lpd_100002
    s_waitcnt vmcnt(0)
    v_lshlrev_b32 v204, 4, v200
    v_subrev_u32 v200, s7, v200
    v_xor_b32 v201, 0x5bd1e990, v201
    v_cmp_gt_u32 vcc, 32, v200
    v_xor_b32 v201, v201, v204
    v_cmp_gt_u32 s[4:5], 16, v201
    s_nop 0
    s_and_b64 vcc, vcc, s[4:5]
    s_cmp_eq_u64 vcc, exec
    s_cbranch_scc0 Lpp_100001
Lpd_100002:
    s_waitcnt vmcnt(0)
    s_mov_b64 exec, -1
    s_mov_b32 s98, m0
    s_lshl_b32 s3, s49, 2
    s_lshl_b32 s4, s48, 1
    s_add_u32 s3, s3, s4
    s_sub_i32 s3, s3, 8
    s_lshl_b32 s5, s3, 12
    s_lshl_b32 s4, s50, 18
    s_add_u32 s5, s5, s4
    s_lshl_b32 s4, s53, 22
    s_add_u32 s5, s5, s4
    s_add_u32 s5, s5, 14680064
    s_lshl_b32 s3, s48, 13
    s_add_u32 m0, s3, 114688
    s_nop 0
    buffer_load_dwordx4 v206, s[8:11], s5 offen offset:0 sc1 lds
    buffer_load_dwordx4 v206, s[8:11], s5 offen offset:1024 sc1 lds
    buffer_load_dwordx4 v206, s[8:11], s5 offen offset:2048 sc1 lds
    buffer_load_dwordx4 v206, s[8:11], s5 offen offset:3072 sc1 lds
    s_add_u32 s5, s5, 4096
    s_add_u32 m0, m0, 4096
    s_nop 0
    buffer_load_dwordx4 v206, s[8:11], s5 offen offset:0 sc1 lds
    buffer_load_dwordx4 v206, s[8:11], s5 offen offset:1024 sc1 lds
    buffer_load_dwordx4 v206, s[8:11], s5 offen offset:2048 sc1 lds
    buffer_load_dwordx4 v206, s[8:11], s5 offen offset:3072 sc1 lds
    s_mov_b32 m0, s98
    s_branch L_kvdone
L_g01:
    buffer_load_dwordx4 v190, s[20:23], s96 offen lds
    s_add_u32 s96, s96, 14336
    s_add_u32 m0, m0, 896
    s_nop 0
    buffer_load_dwordx4 v190, s[20:23], s96 offen lds
    s_add_u32 s96, s96, 14336
    s_add_u32 m0, m0, 896
    s_nop 0
    buffer_load_dwordx4 v190, s[20:23], s96 offen lds
    s_add_u32 s96, s96, 14336
    s_add_u32 m0, m0, 896
    s_nop 0
    buffer_load_dwordx4 v190, s[20:23], s96 offen lds
    s_add_u32 s96, s96, 14336
    s_add_u32 m0, m0, 896
    s_nop 0
    buffer_load_dwordx4 v190, s[20:23], s96 offen lds
    s_add_u32 s96, s96, 14336
    s_add_u32 m0, m0, 896
    s_nop 0
    buffer_load_dwordx4 v190, s[20:23], s96 offen lds
    s_add_u32 s96, s96, 14336
    s_add_u32 m0, m0, 896
    s_nop 0
    buffer_load_dwordx4 v190, s[20:23], s96 offen lds
    s_add_u32 s96, s96, 14336
    s_add_u32 m0, m0, 896
    s_nop 0
    buffer_load_dwordx4 v190, s[20:23], s96 offen lds
    s_add_u32 s96, s96, 14336
    s_add_u32 m0, m0, 896
    s_nop 0
    buffer_load_dwordx4 v190, s[20:23], s96 offen lds
    s_add_u32 s96, s96, 14336
    s_add_u32 m0, m0, 896
    s_nop 0
    buffer_load_dwordx4 v190, s[20:23], s96 offen lds
    s_add_u32 s96, s96, 14336
    s_add_u32 m0, m0, 896
    s_nop 0
    buffer_load_dwordx4 v190, s[20:23], s96 offen lds
    s_add_u32 s96, s96, 14336
    s_add_u32 m0, m0, 896
    s_nop 0
    buffer_load_dwordx4 v190, s[20:23], s96 offen lds
    s_add_u32 s96, s96, 14336
    s_add_u32 m0, m0, 896
    s_cmp_lg_u32 s49, 0
    s_cbranch_scc1 L_g1a
    buffer_load_dwordx4 v190, s[20:23], s96 offen lds
    s_add_u32 s96, s96, 14336
    s_add_u32 m0, m0, 896
    s_nop 0
    buffer_load_dwordx4 v190, s[20:23], s96 offen lds
    s_add_u32 s96, s96, 14336
    s_add_u32 m0, m0, 896
    s_nop 0
    buffer_load_dwordx4 v190, s[20:23], s96 offen lds
    s_add_u32 s96, s96, 14336
    s_add_u32 m0, m0, 896
    s_nop 0
    buffer_load_dwordx4 v190, s[20:23], s96 offen lds
    s_add_u32 s96, s96, 14336
    s_add_u32 m0, m0, 896
    s_nop 0
    buffer_load_dwordx4 v190, s[20:23], s96 offen lds
    s_add_u32 s96, s96, 14336
    s_add_u32 m0, m0, 896
    s_nop 0
    buffer_load_dwordx4 v190, s[20:23], s96 offen lds
    s_add_u32 s96, s96, 14336
    s_add_u32 m0, m0, 896
    s_nop 0
    buffer_load_dwordx4 v190, s[20:23], s96 offen lds
    s_add_u32 s96, s96, 14336
    s_add_u32 m0, m0, 896
    s_nop 0
    buffer_load_dwordx4 v190, s[20:23], s96 offen lds
    s_add_u32 s96, s96, 14336
    s_add_u32 m0, m0, 896
    s_nop 0
    buffer_load_dwordx4 v190, s[20:23], s96 offen lds
    s_add_u32 s96, s96, 14336
    s_add_u32 m0, m0, 896
    s_nop 0
    buffer_load_dwordx4 v190, s[20:23], s96 offen lds
    s_add_u32 s96, s96, 14336
    s_add_u32 m0, m0, 896
    s_nop 0
    buffer_load_dwordx4 v190, s[20:23], s96 offen lds
    s_add_u32 s96, s96, 14336
    s_add_u32 m0, m0, 896
    s_nop 0
    buffer_load_dwordx4 v190, s[20:23], s96 offen lds
    s_add_u32 s96, s96, 14336
    s_add_u32 m0, m0, 896
    s_nop 0
    buffer_load_dwordx4 v190, s[20:23], s96 offen lds
    s_add_u32 s96, s96, 14336
    s_add_u32 m0, m0, 896
    s_nop 0
    buffer_load_dwordx4 v190, s[20:23], s96 offen lds
    s_add_u32 s96, s96, 14336
    s_add_u32 m0, m0, 896
    s_branch L_nofor
L_g1a:
    ds_read_b128 v[180:183], v186 offset:28672
    s_waitcnt lgkmcnt(0)
    v_mfma_f32_32x32x16_bf16 v[112:127], v[180:183], v[192:195], v[80:95]
    v_mfma_f32_32x32x16_bf16 v[128:143], v[180:183], v[196:199], v[96:111]
    s_mov_b32 s3, 4
    s_mov_b32 s4, 7
    s_lshl_b32 s3, s3, 12
    s_lshl_b32 s4, s4, 12
    v_add_u32 v184, s3, v186
    v_add_u32 v185, s3, v187
    s_sub_u32 s5, s4, 4096
    v_add_u32 v188, s5, v186
    v_add_u32 v189, s4, v187
    ds_read_b128 v[176:179], v188
    s_mov_b64 exec, s[100:101]
    ds_read_b128 v[40:43], v189 offset:0
    ds_read_b128 v[44:47], v189 offset:1024
    s_mov_b64 exec, -1
    s_nop 7
    s_branch Lfa_3
L_g1b:
    s_mov_b32 s3, 4
    s_mov_b32 s4, 7
    s_lshl_b32 s3, s3, 12
    s_lshl_b32 s4, s4, 12
    v_add_u32 v184, s3, v186
    v_add_u32 v185, s3, v187
    s_sub_u32 s5, s4, 4096
    v_add_u32 v188, s5, v186
    v_add_u32 v189, s4, v187
    ds_read_b128 v[176:179], v188
    s_mov_b64 exec, s[100:101]
    ds_read_b128 v[40:43], v189 offset:0
    ds_read_b128 v[44:47], v189 offset:1024
    s_mov_b64 exec, -1
    v_mov_b64 v[144:145], v[128:129]
    v_mov_b64 v[146:147], v[130:131]
    v_mov_b64 v[148:149], v[132:133]
    v_mov_b64 v[150:151], v[134:135]
    v_mov_b64 v[152:153], v[136:137]
    v_mov_b64 v[154:155], v[138:139]
    v_mov_b64 v[156:157], v[140:141]
    v_mov_b64 v[158:159], v[142:143]
    s_branch Lfb_3
L_fb0:
    s_nop 15
    s_lshl_b32 s3, s49, 2
    s_sub_i32 s3, 8, s3
    s_max_i32 s3, s3, s28
    s_add_u32 s7, s28, 8
    v_mov_b32 v200, 0xf149f2ca
    v_mov_b32 v184, 0
    v_mov_b32 v185, 0
L_fb0_p1:
    s_lshl_b32 s5, s3, 12
    v_add_u32 v202, s5, v186
    v_add_u32 v203, s5, v187
    ds_read_b128 v[176:179], v202
    s_mov_b64 exec, s[100:101]
    ds_read_b128 v[32:35], v203
    ds_read_b128 v[36:39], v203 offset:1024
    s_mov_b64 exec, -1
    v_mov_b64 v[112:113], v[184:185]
    v_mov_b64 v[114:115], v[184:185]
    v_mov_b64 v[116:117], v[184:185]
    v_mov_b64 v[118:119], v[184:185]
    v_mov_b64 v[120:121], v[184:185]
    v_mov_b64 v[122:123], v[184:185]
    v_mov_b64 v[124:125], v[184:185]
    v_mov_b64 v[126:127], v[184:185]
    s_add_u32 s5, s28, 8
    s_cmp_lg_u32 s3, s5
    s_cbranch_scc1 Lfa_100003
    v_pk_add_f32 v[112:113], v[112:113], v[0:1]
    v_pk_add_f32 v[114:115], v[114:115], v[2:3]
    v_pk_add_f32 v[116:117], v[116:117], v[4:5]
    v_pk_add_f32 v[118:119], v[118:119], v[6:7]
    v_pk_add_f32 v[120:121], v[120:121], v[8:9]
    v_pk_add_f32 v[122:123], v[122:123], v[10:11]
    v_pk_add_f32 v[124:125], v[124:125], v[12:13]
    v_pk_add_f32 v[126:127], v[126:127], v[14:15]
Lfa_100003:
    s_cmp_lg_u32 s3, s28
    s_cbranch_scc1 Lfb_100004
    v_pk_add_f32 v[112:113], v[112:113], v[16:17]
    v_pk_add_f32 v[114:115], v[114:115], v[18:19]
    v_pk_add_f32 v[116:117], v[116:117], v[20:21]
    v_pk_add_f32 v[118:119], v[118:119], v[22:23]
    v_pk_add_f32 v[120:121], v[120:121], v[24:25]
    v_pk_add_f32 v[122:123], v[122:123], v[26:27]
    v_pk_add_f32 v[124:125], v[124:125], v[28:29]
    v_pk_add_f32 v[126:127], v[126:127], v[30:31]
Lfb_100004:
    s_waitcnt lgkmcnt(0)
    s_nop 1
    v_mfma_f32_32x32x16_bf16 v[112:127], v[176:179], v[192:195], v[112:127]
    s_nop 15
    v_max3_f32 v200, v200, v112, v113
    v_max3_f32 v200, v200, v114, v115
    v_max3_f32 v200, v200, v116, v117
    v_max3_f32 v200, v200, v118, v119
    v_max3_f32 v200, v200, v120, v121
    v_max3_f32 v200, v200, v122, v123
    v_max3_f32 v200, v200, v124, v125
    v_max3_f32 v200, v200, v126, v127
    s_add_u32 s3, s3, 1
    s_cmp_le_u32 s3, s7
    s_cbranch_scc1 L_fb0_p1
    v_mov_b32 v201, v200
    s_nop 1
    v_permlane32_swap_b32 v200, v201
    v_max_f32 v200, v200, v201
    v_sub_f32 v184, 0, v200
    v_sub_f32 v185, 0, v200
    v_mov_b64 v[48:49], 0
    v_mov_b64 v[50:51], 0
    v_mov_b64 v[52:53], 0
    v_mov_b64 v[54:55], 0
    v_mov_b64 v[56:57], 0
    v_mov_b64 v[58:59], 0
    v_mov_b64 v[60:61], 0
    v_mov_b64 v[62:63], 0
    s_lshl_b32 s3, s49, 2
    s_sub_i32 s3, 8, s3
    s_max_i32 s3, s3, s28
    s_add_u32 s7, s28, 8
L_fb0_p2:
    s_lshl_b32 s5, s3, 12
    v_add_u32 v202, s5, v186
    v_add_u32 v203, s5, v187
    ds_read_b128 v[176:179], v202
    s_mov_b64 exec, s[100:101]
    ds_read_b128 v[32:35], v203
    ds_read_b128 v[36:39], v203 offset:1024
    s_mov_b64 exec, -1
    v_mov_b64 v[112:113], v[184:185]
    v_mov_b64 v[114:115], v[184:185]
    v_mov_b64 v[116:117], v[184:185]
    v_mov_b64 v[118:119], v[184:185]
    v_mov_b64 v[120:121], v[184:185]
    v_mov_b64 v[122:123], v[184:185]
    v_mov_b64 v[124:125], v[184:185]
    v_mov_b64 v[126:127], v[184:185]
    s_add_u32 s5, s28, 8
    s_cmp_lg_u32 s3, s5
    s_cbranch_scc1 Lfa_100005
    v_pk_add_f32 v[112:113], v[112:113], v[0:1]
    v_pk_add_f32 v[114:115], v[114:115], v[2:3]
    v_pk_add_f32 v[116:117], v[116:117], v[4:5]
    v_pk_add_f32 v[118:119], v[118:119], v[6:7]
    v_pk_add_f32 v[120:121], v[120:121], v[8:9]
    v_pk_add_f32 v[122:123], v[122:123], v[10:11]
    v_pk_add_f32 v[124:125], v[124:125], v[12:13]
    v_pk_add_f32 v[126:127], v[126:127], v[14:15]
Lfa_100005:
    s_cmp_lg_u32 s3, s28
    s_cbranch_scc1 Lfb_100006
    v_pk_add_f32 v[112:113], v[112:113], v[16:17]
    v_pk_add_f32 v[114:115], v[114:115], v[18:19]
    v_pk_add_f32 v[116:117], v[116:117], v[20:21]
    v_pk_add_f32 v[118:119], v[118:119], v[22:23]
    v_pk_add_f32 v[120:121], v[120:121], v[24:25]
    v_pk_add_f32 v[122:123], v[122:123], v[26:27]
    v_pk_add_f32 v[124:125], v[124:125], v[28:29]
    v_pk_add_f32 v[126:127], v[126:127], v[30:31]
Lfb_100006:
    s_waitcnt lgkmcnt(0)
    s_nop 1
    v_mfma_f32_32x32x16_bf16 v[112:127], v[176:179], v[192:195], v[112:127]
    s_nop 15
    v_exp_f32 v112, v112
    v_exp_f32 v113, v113
    v_exp_f32 v114, v114
    v_exp_f32 v115, v115
    v_exp_f32 v116, v116
    v_exp_f32 v117, v117
    v_exp_f32 v118, v118
    v_exp_f32 v119, v119
    v_exp_f32 v120, v120
    v_exp_f32 v121, v121
    v_exp_f32 v122, v122
    v_exp_f32 v123, v123
    v_exp_f32 v124, v124
    v_exp_f32 v125, v125
    v_exp_f32 v126, v126
    v_exp_f32 v127, v127
    s_nop 0
    v_cvt_pk_bf16_f32 v128, v112, v113
    v_cvt_pk_bf16_f32 v129, v114, v115
    v_cvt_pk_bf16_f32 v130, v116, v117
    v_cvt_pk_bf16_f32 v131, v118, v119
    v_cvt_pk_bf16_f32 v132, v120, v121
    v_cvt_pk_bf16_f32 v133, v122, v123
    v_cvt_pk_bf16_f32 v134, v124, v125
    v_cvt_pk_bf16_f32 v135, v126, v127
    s_nop 1
    v_mfma_f32_32x32x16_bf16 v[48:63], v[32:35], v[128:131], v[48:63]
    v_mfma_f32_32x32x16_bf16 v[48:63], v[36:39], v[132:135], v[48:63]
    s_nop 15
    s_add_u32 s3, s3, 1
    s_cmp_le_u32 s3, s7
    s_cbranch_scc1 L_fb0_p2
    s_branch L_fbr0
L_fb1:
    s_nop 15
    s_lshl_b32 s3, s49, 2
    s_sub_i32 s3, 8, s3
    s_max_i32 s3, s3, s97
    s_add_u32 s7, s97, 8
    v_mov_b32 v200, 0xf149f2ca
    v_mov_b32 v184, 0
    v_mov_b32 v185, 0
L_fb1_p1:
    s_lshl_b32 s5, s3, 12
    v_add_u32 v202, s5, v186
    v_add_u32 v203, s5, v187
    ds_read_b128 v[176:179], v202
    s_mov_b64 exec, s[100:101]
    ds_read_b128 v[32:35], v203
    ds_read_b128 v[36:39], v203 offset:1024
    s_mov_b64 exec, -1
    v_mov_b64 v[112:113], v[184:185]
    v_mov_b64 v[114:115], v[184:185]
    v_mov_b64 v[116:117], v[184:185]
    v_mov_b64 v[118:119], v[184:185]
    v_mov_b64 v[120:121], v[184:185]
    v_mov_b64 v[122:123], v[184:185]
    v_mov_b64 v[124:125], v[184:185]
    v_mov_b64 v[126:127], v[184:185]
    s_add_u32 s5, s97, 8
    s_cmp_lg_u32 s3, s5
    s_cbranch_scc1 Lfa_100007
    v_pk_add_f32 v[112:113], v[112:113], v[0:1]
    v_pk_add_f32 v[114:115], v[114:115], v[2:3]
    v_pk_add_f32 v[116:117], v[116:117], v[4:5]
    v_pk_add_f32 v[118:119], v[118:119], v[6:7]
    v_pk_add_f32 v[120:121], v[120:121], v[8:9]
    v_pk_add_f32 v[122:123], v[122:123], v[10:11]
    v_pk_add_f32 v[124:125], v[124:125], v[12:13]
    v_pk_add_f32 v[126:127], v[126:127], v[14:15]
Lfa_100007:
    s_cmp_lg_u32 s3, s97
    s_cbranch_scc1 Lfb_100008
    v_pk_add_f32 v[112:113], v[112:113], v[16:17]
    v_pk_add_f32 v[114:115], v[114:115], v[18:19]
    v_pk_add_f32 v[116:117], v[116:117], v[20:21]
    v_pk_add_f32 v[118:119], v[118:119], v[22:23]
    v_pk_add_f32 v[120:121], v[120:121], v[24:25]
    v_pk_add_f32 v[122:123], v[122:123], v[26:27]
    v_pk_add_f32 v[124:125], v[124:125], v[28:29]
    v_pk_add_f32 v[126:127], v[126:127], v[30:31]
Lfb_100008:
    s_waitcnt lgkmcnt(0)
    s_nop 1
    v_mfma_f32_32x32x16_bf16 v[112:127], v[176:179], v[196:199], v[112:127]
    s_nop 15
    v_max3_f32 v200, v200, v112, v113
    v_max3_f32 v200, v200, v114, v115
    v_max3_f32 v200, v200, v116, v117
    v_max3_f32 v200, v200, v118, v119
    v_max3_f32 v200, v200, v120, v121
    v_max3_f32 v200, v200, v122, v123
    v_max3_f32 v200, v200, v124, v125
    v_max3_f32 v200, v200, v126, v127
    s_add_u32 s3, s3, 1
    s_cmp_le_u32 s3, s7
    s_cbranch_scc1 L_fb1_p1
    v_mov_b32 v201, v200
    s_nop 1
    v_permlane32_swap_b32 v200, v201
    v_max_f32 v200, v200, v201
    v_sub_f32 v184, 0, v200
    v_sub_f32 v185, 0, v200
    v_mov_b64 v[64:65], 0
    v_mov_b64 v[66:67], 0
    v_mov_b64 v[68:69], 0
    v_mov_b64 v[70:71], 0
    v_mov_b64 v[72:73], 0
    v_mov_b64 v[74:75], 0
    v_mov_b64 v[76:77], 0
    v_mov_b64 v[78:79], 0
    s_lshl_b32 s3, s49, 2
    s_sub_i32 s3, 8, s3
    s_max_i32 s3, s3, s97
    s_add_u32 s7, s97, 8
L_fb1_p2:
    s_lshl_b32 s5, s3, 12
    v_add_u32 v202, s5, v186
    v_add_u32 v203, s5, v187
    ds_read_b128 v[176:179], v202
    s_mov_b64 exec, s[100:101]
    ds_read_b128 v[32:35], v203
    ds_read_b128 v[36:39], v203 offset:1024
    s_mov_b64 exec, -1
    v_mov_b64 v[112:113], v[184:185]
    v_mov_b64 v[114:115], v[184:185]
    v_mov_b64 v[116:117], v[184:185]
    v_mov_b64 v[118:119], v[184:185]
    v_mov_b64 v[120:121], v[184:185]
    v_mov_b64 v[122:123], v[184:185]
    v_mov_b64 v[124:125], v[184:185]
    v_mov_b64 v[126:127], v[184:185]
    s_add_u32 s5, s97, 8
    s_cmp_lg_u32 s3, s5
    s_cbranch_scc1 Lfa_100009
    v_pk_add_f32 v[112:113], v[112:113], v[0:1]
    v_pk_add_f32 v[114:115], v[114:115], v[2:3]
    v_pk_add_f32 v[116:117], v[116:117], v[4:5]
    v_pk_add_f32 v[118:119], v[118:119], v[6:7]
    v_pk_add_f32 v[120:121], v[120:121], v[8:9]
    v_pk_add_f32 v[122:123], v[122:123], v[10:11]
    v_pk_add_f32 v[124:125], v[124:125], v[12:13]
    v_pk_add_f32 v[126:127], v[126:127], v[14:15]
Lfa_100009:
    s_cmp_lg_u32 s3, s97
    s_cbranch_scc1 Lfb_100010
    v_pk_add_f32 v[112:113], v[112:113], v[16:17]
    v_pk_add_f32 v[114:115], v[114:115], v[18:19]
    v_pk_add_f32 v[116:117], v[116:117], v[20:21]
    v_pk_add_f32 v[118:119], v[118:119], v[22:23]
    v_pk_add_f32 v[120:121], v[120:121], v[24:25]
    v_pk_add_f32 v[122:123], v[122:123], v[26:27]
    v_pk_add_f32 v[124:125], v[124:125], v[28:29]
    v_pk_add_f32 v[126:127], v[126:127], v[30:31]
Lfb_100010:
    s_waitcnt lgkmcnt(0)
    s_nop 1
    v_mfma_f32_32x32x16_bf16 v[112:127], v[176:179], v[196:199], v[112:127]
    s_nop 15
    v_exp_f32 v112, v112
    v_exp_f32 v113, v113
    v_exp_f32 v114, v114
    v_exp_f32 v115, v115
    v_exp_f32 v116, v116
    v_exp_f32 v117, v117
    v_exp_f32 v118, v118
    v_exp_f32 v119, v119
    v_exp_f32 v120, v120
    v_exp_f32 v121, v121
    v_exp_f32 v122, v122
    v_exp_f32 v123, v123
    v_exp_f32 v124, v124
    v_exp_f32 v125, v125
    v_exp_f32 v126, v126
    v_exp_f32 v127, v127
    s_nop 0
    v_cvt_pk_bf16_f32 v128, v112, v113
    v_cvt_pk_bf16_f32 v129, v114, v115
    v_cvt_pk_bf16_f32 v130, v116, v117
    v_cvt_pk_bf16_f32 v131, v118, v119
    v_cvt_pk_bf16_f32 v132, v120, v121
    v_cvt_pk_bf16_f32 v133, v122, v123
    v_cvt_pk_bf16_f32 v134, v124, v125
    v_cvt_pk_bf16_f32 v135, v126, v127
    s_nop 1
    v_mfma_f32_32x32x16_bf16 v[64:79], v[32:35], v[128:131], v[64:79]
    v_mfma_f32_32x32x16_bf16 v[64:79], v[36:39], v[132:135], v[64:79]
    s_nop 15
    s_add_u32 s3, s3, 1
    s_cmp_le_u32 s3, s7
    s_cbranch_scc1 L_fb1_p2
    s_branch L_fbr1
L_ep_o:
    s_cmp_lt_u32 s49, 2
    s_cbranch_scc1 L_ep_a
    s_cmp_eq_u32 s48, 1
    s_cbranch_scc1 L_ep_a
    s_sub_u32 s3, s51, 7
    s_add_u32 s4, s3, s46
    s_sub_u32 s5, s49, 2
    s_cmp_eq_u32 s48, 0
    s_cbranch_scc1 L_ep_b
    s_cmp_lg_u32 s49, 15
    s_cbranch_scc1 L_ep_a
    s_add_u32 s5, s48, 12
    s_cmp_eq_u32 s48, 3
    s_cselect_b32 s4, s3, s4
L_ep_b:
    s_lshl_b32 s5, s5, 7
    s_add_u32 s5, s5, 8192
    v_mov_b32 v200, s4
    v_mov_b32 v201, 0
    s_mov_b64 exec, 1
    buffer_store_dword v200, v201, s[8:11], s5 offen sc1
    s_mov_b64 exec, -1
    s_branch L_ep_a
L_gelu0:
    s_nop 1
    v_pk_fma_f32 v[128:129], v[64:65], v[0:1], v[128:129] op_sel_hi:[1,0,1]
    v_pk_fma_f32 v[130:131], v[66:67], v[0:1], v[130:131] op_sel_hi:[1,0,1]
    v_pk_fma_f32 v[132:133], v[64:65], v[2:3], v[132:133] op_sel_hi:[1,0,1]
    v_pk_fma_f32 v[134:135], v[66:67], v[2:3], v[134:135] op_sel_hi:[1,0,1]
    v_pk_fma_f32 v[128:129], v[92:93], v[4:5], v[128:129] op_sel_hi:[1,0,1]
    v_pk_fma_f32 v[130:131], v[94:95], v[4:5], v[130:131] op_sel_hi:[1,0,1]
    v_pk_fma_f32 v[132:133], v[92:93], v[6:7], v[132:133] op_sel_hi:[1,0,1]
    v_pk_fma_f32 v[134:135], v[94:95], v[6:7], v[134:135] op_sel_hi:[1,0,1]
    v_pk_mul_f32 v[16:17], v[128:129], v[128:129]
    v_pk_mul_f32 v[18:19], v[130:131], v[130:131]
    v_pk_mul_f32 v[20:21], v[132:133], v[132:133]
    v_pk_mul_f32 v[22:23], v[134:135], v[134:135]
    v_pk_fma_f32 v[16:17], v[16:17], v[12:13], v[8:9] op_sel_hi:[1,0,0]
    v_pk_fma_f32 v[18:19], v[18:19], v[12:13], v[8:9] op_sel_hi:[1,0,0]
    v_pk_fma_f32 v[20:21], v[20:21], v[14:15], v[10:11] op_sel_hi:[1,0,0]
    v_pk_fma_f32 v[22:23], v[22:23], v[14:15], v[10:11] op_sel_hi:[1,0,0]
    v_pk_mul_f32 v[16:17], v[16:17], v[128:129]
    v_pk_mul_f32 v[18:19], v[18:19], v[130:131]
    v_pk_mul_f32 v[20:21], v[20:21], v[132:133]
    v_pk_mul_f32 v[22:23], v[22:23], v[134:135]
    v_exp_f32 v16, v16
    v_exp_f32 v17, v17
    v_exp_f32 v18, v18
    v_exp_f32 v19, v19
    v_exp_f32 v20, v20
    v_exp_f32 v21, v21
    v_exp_f32 v22, v22
    v_exp_f32 v23, v23
    v_pk_fma_f32 v[16:17], v[16:17], v[4:5], v[4:5] op_sel_hi:[1,0,0]
    v_pk_fma_f32 v[18:19], v[18:19], v[4:5], v[4:5] op_sel_hi:[1,0,0]
    v_pk_fma_f32 v[20:21], v[20:21], v[6:7], v[6:7] op_sel_hi:[1,0,0]
    v_pk_fma_f32 v[22:23], v[22:23], v[6:7], v[6:7] op_sel_hi:[1,0,0]
    v_rcp_f32 v16, v16
    v_rcp_f32 v17, v17
    v_rcp_f32 v18, v18
    v_rcp_f32 v19, v19
    v_rcp_f32 v20, v20
    v_rcp_f32 v21, v21
    v_rcp_f32 v22, v22
    v_rcp_f32 v23, v23
    v_pk_mul_f32 v[128:129], v[128:129], v[16:17]
    v_pk_mul_f32 v[130:131], v[130:131], v[18:19]
    v_pk_mul_f32 v[132:133], v[132:133], v[20:21]
    v_pk_mul_f32 v[134:135], v[134:135], v[22:23]
    v_cvt_pk_bf16_f32 v32, v128, v129
    v_cvt_pk_bf16_f32 v33, v130, v131
    v_cvt_pk_bf16_f32 v34, v132, v133
    v_cvt_pk_bf16_f32 v35, v134, v135
    s_nop 0
    v_permlane16_swap_b32 v32, v34
    v_permlane16_swap_b32 v33, v35
    buffer_store_dwordx4 v[32:35], v206, s[8:11], s98 offen offset:0 sc1
    v_pk_fma_f32 v[136:137], v[68:69], v[0:1], v[136:137] op_sel_hi:[1,0,1]
    v_pk_fma_f32 v[138:139], v[70:71], v[0:1], v[138:139] op_sel_hi:[1,0,1]
    v_pk_fma_f32 v[140:141], v[68:69], v[2:3], v[140:141] op_sel_hi:[1,0,1]
    v_pk_fma_f32 v[142:143], v[70:71], v[2:3], v[142:143] op_sel_hi:[1,0,1]
    v_pk_fma_f32 v[136:137], v[96:97], v[4:5], v[136:137] op_sel_hi:[1,0,1]
    v_pk_fma_f32 v[138:139], v[98:99], v[4:5], v[138:139] op_sel_hi:[1,0,1]
    v_pk_fma_f32 v[140:141], v[96:97], v[6:7], v[140:141] op_sel_hi:[1,0,1]
    v_pk_fma_f32 v[142:143], v[98:99], v[6:7], v[142:143] op_sel_hi:[1,0,1]
    v_pk_mul_f32 v[24:25], v[136:137], v[136:137]
    v_pk_mul_f32 v[26:27], v[138:139], v[138:139]
    v_pk_mul_f32 v[28:29], v[140:141], v[140:141]
    v_pk_mul_f32 v[30:31], v[142:143], v[142:143]
    v_pk_fma_f32 v[24:25], v[24:25], v[12:13], v[8:9] op_sel_hi:[1,0,0]
    v_pk_fma_f32 v[26:27], v[26:27], v[12:13], v[8:9] op_sel_hi:[1,0,0]
    v_pk_fma_f32 v[28:29], v[28:29], v[14:15], v[10:11] op_sel_hi:[1,0,0]
    v_pk_fma_f32 v[30:31], v[30:31], v[14:15], v[10:11] op_sel_hi:[1,0,0]
    v_pk_mul_f32 v[24:25], v[24:25], v[136:137]
    v_pk_mul_f32 v[26:27], v[26:27], v[138:139]
    v_pk_mul_f32 v[28:29], v[28:29], v[140:141]
    v_pk_mul_f32 v[30:31], v[30:31], v[142:143]
    v_exp_f32 v24, v24
    v_exp_f32 v25, v25
    v_exp_f32 v26, v26
    v_exp_f32 v27, v27
    v_exp_f32 v28, v28
    v_exp_f32 v29, v29
    v_exp_f32 v30, v30
    v_exp_f32 v31, v31
    v_pk_fma_f32 v[24:25], v[24:25], v[4:5], v[4:5] op_sel_hi:[1,0,0]
    v_pk_fma_f32 v[26:27], v[26:27], v[4:5], v[4:5] op_sel_hi:[1,0,0]
    v_pk_fma_f32 v[28:29], v[28:29], v[6:7], v[6:7] op_sel_hi:[1,0,0]
    v_pk_fma_f32 v[30:31], v[30:31], v[6:7], v[6:7] op_sel_hi:[1,0,0]
    v_rcp_f32 v24, v24
    v_rcp_f32 v25, v25
    v_rcp_f32 v26, v26
    v_rcp_f32 v27, v27
    v_rcp_f32 v28, v28
    v_rcp_f32 v29, v29
    v_rcp_f32 v30, v30
    v_rcp_f32 v31, v31
    v_pk_mul_f32 v[136:137], v[136:137], v[24:25]
    v_pk_mul_f32 v[138:139], v[138:139], v[26:27]
    v_pk_mul_f32 v[140:141], v[140:141], v[28:29]
    v_pk_mul_f32 v[142:143], v[142:143], v[30:31]
    v_cvt_pk_bf16_f32 v36, v136, v137
    v_cvt_pk_bf16_f32 v37, v138, v139
    v_cvt_pk_bf16_f32 v38, v140, v141
    v_cvt_pk_bf16_f32 v39, v142, v143
    s_nop 0
    v_permlane16_swap_b32 v36, v38
    v_permlane16_swap_b32 v37, v39
    buffer_store_dwordx4 v[36:39], v206, s[8:11], s98 offen offset:1024 sc1
    v_lshrrev_b32 v202, 5, v207
    v_lshlrev_b32 v202, 3, v202
    s_lshl_b32 s3, s56, 5
    buffer_load_dwordx2 v[64:65], v202, s[40:43], s3 offen offset:0
    buffer_load_dwordx2 v[66:67], v202, s[40:43], s3 offen offset:16
    buffer_load_dwordx2 v[68:69], v202, s[40:43], s3 offen offset:32
    buffer_load_dwordx2 v[70:71], v202, s[40:43], s3 offen offset:48
    v_pk_fma_f32 v[144:145], v[72:73], v[0:1], v[144:145] op_sel_hi:[1,0,1]
    v_pk_fma_f32 v[146:147], v[74:75], v[0:1], v[146:147] op_sel_hi:[1,0,1]
    v_pk_fma_f32 v[148:149], v[72:73], v[2:3], v[148:149] op_sel_hi:[1,0,1]
    v_pk_fma_f32 v[150:151], v[74:75], v[2:3], v[150:151] op_sel_hi:[1,0,1]
    v_pk_fma_f32 v[144:145], v[100:101], v[4:5], v[144:145] op_sel_hi:[1,0,1]
    v_pk_fma_f32 v[146:147], v[102:103], v[4:5], v[146:147] op_sel_hi:[1,0,1]
    v_pk_fma_f32 v[148:149], v[100:101], v[6:7], v[148:149] op_sel_hi:[1,0,1]
    v_pk_fma_f32 v[150:151], v[102:103], v[6:7], v[150:151] op_sel_hi:[1,0,1]
    v_pk_mul_f32 v[16:17], v[144:145], v[144:145]
    v_pk_mul_f32 v[18:19], v[146:147], v[146:147]
    v_pk_mul_f32 v[20:21], v[148:149], v[148:149]
    v_pk_mul_f32 v[22:23], v[150:151], v[150:151]
    v_pk_fma_f32 v[16:17], v[16:17], v[12:13], v[8:9] op_sel_hi:[1,0,0]
    v_pk_fma_f32 v[18:19], v[18:19], v[12:13], v[8:9] op_sel_hi:[1,0,0]
    v_pk_fma_f32 v[20:21], v[20:21], v[14:15], v[10:11] op_sel_hi:[1,0,0]
    v_pk_fma_f32 v[22:23], v[22:23], v[14:15], v[10:11] op_sel_hi:[1,0,0]
    v_pk_mul_f32 v[16:17], v[16:17], v[144:145]
    v_pk_mul_f32 v[18:19], v[18:19], v[146:147]
    v_pk_mul_f32 v[20:21], v[20:21], v[148:149]
    v_pk_mul_f32 v[22:23], v[22:23], v[150:151]
    v_exp_f32 v16, v16
    v_exp_f32 v17, v17
    v_exp_f32 v18, v18
    v_exp_f32 v19, v19
    v_exp_f32 v20, v20
    v_exp_f32 v21, v21
    v_exp_f32 v22, v22
    v_exp_f32 v23, v23
    v_pk_fma_f32 v[16:17], v[16:17], v[4:5], v[4:5] op_sel_hi:[1,0,0]
    v_pk_fma_f32 v[18:19], v[18:19], v[4:5], v[4:5] op_sel_hi:[1,0,0]
    v_pk_fma_f32 v[20:21], v[20:21], v[6:7], v[6:7] op_sel_hi:[1,0,0]
    v_pk_fma_f32 v[22:23], v[22:23], v[6:7], v[6:7] op_sel_hi:[1,0,0]
    v_rcp_f32 v16, v16
    v_rcp_f32 v17, v17
    v_rcp_f32 v18, v18
    v_rcp_f32 v19, v19
    v_rcp_f32 v20, v20
    v_rcp_f32 v21, v21
    v_rcp_f32 v22, v22
    v_rcp_f32 v23, v23
    v_pk_mul_f32 v[144:145], v[144:145], v[16:17]
    v_pk_mul_f32 v[146:147], v[146:147], v[18:19]
    v_pk_mul_f32 v[148:149], v[148:149], v[20:21]
    v_pk_mul_f32 v[150:151], v[150:151], v[22:23]
    v_cvt_pk_bf16_f32 v32, v144, v145
    v_cvt_pk_bf16_f32 v33, v146, v147
    v_cvt_pk_bf16_f32 v34, v148, v149
    v_cvt_pk_bf16_f32 v35, v150, v151
    s_nop 0
    v_permlane16_swap_b32 v32, v34
    v_permlane16_swap_b32 v33, v35
    buffer_store_dwordx4 v[32:35], v206, s[8:11], s98 offen offset:2048 sc1
    v_pk_fma_f32 v[152:153], v[76:77], v[0:1], v[152:153] op_sel_hi:[1,0,1]
    v_pk_fma_f32 v[154:155], v[78:79], v[0:1], v[154:155] op_sel_hi:[1,0,1]
    v_pk_fma_f32 v[156:157], v[76:77], v[2:3], v[156:157] op_sel_hi:[1,0,1]
    v_pk_fma_f32 v[158:159], v[78:79], v[2:3], v[158:159] op_sel_hi:[1,0,1]
    v_pk_fma_f32 v[152:153], v[104:105], v[4:5], v[152:153] op_sel_hi:[1,0,1]
    v_pk_fma_f32 v[154:155], v[106:107], v[4:5], v[154:155] op_sel_hi:[1,0,1]
    v_pk_fma_f32 v[156:157], v[104:105], v[6:7], v[156:157] op_sel_hi:[1,0,1]
    v_pk_fma_f32 v[158:159], v[106:107], v[6:7], v[158:159] op_sel_hi:[1,0,1]
    v_pk_mul_f32 v[24:25], v[152:153], v[152:153]
    v_pk_mul_f32 v[26:27], v[154:155], v[154:155]
    v_pk_mul_f32 v[28:29], v[156:157], v[156:157]
    v_pk_mul_f32 v[30:31], v[158:159], v[158:159]
    v_pk_fma_f32 v[24:25], v[24:25], v[12:13], v[8:9] op_sel_hi:[1,0,0]
    v_pk_fma_f32 v[26:27], v[26:27], v[12:13], v[8:9] op_sel_hi:[1,0,0]
    v_pk_fma_f32 v[28:29], v[28:29], v[14:15], v[10:11] op_sel_hi:[1,0,0]
    v_pk_fma_f32 v[30:31], v[30:31], v[14:15], v[10:11] op_sel_hi:[1,0,0]
    v_pk_mul_f32 v[24:25], v[24:25], v[152:153]
    v_pk_mul_f32 v[26:27], v[26:27], v[154:155]
    v_pk_mul_f32 v[28:29], v[28:29], v[156:157]
    v_pk_mul_f32 v[30:31], v[30:31], v[158:159]
    v_exp_f32 v24, v24
    v_exp_f32 v25, v25
    v_exp_f32 v26, v26
    v_exp_f32 v27, v27
    v_exp_f32 v28, v28
    v_exp_f32 v29, v29
    v_exp_f32 v30, v30
    v_exp_f32 v31, v31
    v_pk_fma_f32 v[24:25], v[24:25], v[4:5], v[4:5] op_sel_hi:[1,0,0]
    v_pk_fma_f32 v[26:27], v[26:27], v[4:5], v[4:5] op_sel_hi:[1,0,0]
    v_pk_fma_f32 v[28:29], v[28:29], v[6:7], v[6:7] op_sel_hi:[1,0,0]
    v_pk_fma_f32 v[30:31], v[30:31], v[6:7], v[6:7] op_sel_hi:[1,0,0]
    v_rcp_f32 v24, v24
    v_rcp_f32 v25, v25
    v_rcp_f32 v26, v26
    v_rcp_f32 v27, v27
    v_rcp_f32 v28, v28
    v_rcp_f32 v29, v29
    v_rcp_f32 v30, v30
    v_rcp_f32 v31, v31
    v_pk_mul_f32 v[152:153], v[152:153], v[24:25]
    v_pk_mul_f32 v[154:155], v[154:155], v[26:27]
    v_pk_mul_f32 v[156:157], v[156:157], v[28:29]
    v_pk_mul_f32 v[158:159], v[158:159], v[30:31]
    v_cvt_pk_bf16_f32 v36, v152, v153
    v_cvt_pk_bf16_f32 v37, v154, v155
    v_cvt_pk_bf16_f32 v38, v156, v157
    v_cvt_pk_bf16_f32 v39, v158, v159
    s_nop 0
    v_permlane16_swap_b32 v36, v38
    v_permlane16_swap_b32 v37, v39
    buffer_store_dwordx4 v[36:39], v206, s[8:11], s98 offen offset:3072 sc1
    s_add_u32 s98, s98, 4096
    v_pk_fma_f32 v[160:161], v[80:81], v[0:1], v[160:161] op_sel_hi:[1,0,1]
    v_pk_fma_f32 v[162:163], v[82:83], v[0:1], v[162:163] op_sel_hi:[1,0,1]
    v_pk_fma_f32 v[164:165], v[80:81], v[2:3], v[164:165] op_sel_hi:[1,0,1]
    v_pk_fma_f32 v[166:167], v[82:83], v[2:3], v[166:167] op_sel_hi:[1,0,1]
    v_pk_fma_f32 v[160:161], v[108:109], v[4:5], v[160:161] op_sel_hi:[1,0,1]
    v_pk_fma_f32 v[162:163], v[110:111], v[4:5], v[162:163] op_sel_hi:[1,0,1]
    v_pk_fma_f32 v[164:165], v[108:109], v[6:7], v[164:165] op_sel_hi:[1,0,1]
    v_pk_fma_f32 v[166:167], v[110:111], v[6:7], v[166:167] op_sel_hi:[1,0,1]
    v_pk_mul_f32 v[16:17], v[160:161], v[160:161]
    v_pk_mul_f32 v[18:19], v[162:163], v[162:163]
    v_pk_mul_f32 v[20:21], v[164:165], v[164:165]
    v_pk_mul_f32 v[22:23], v[166:167], v[166:167]
    v_pk_fma_f32 v[16:17], v[16:17], v[12:13], v[8:9] op_sel_hi:[1,0,0]
    v_pk_fma_f32 v[18:19], v[18:19], v[12:13], v[8:9] op_sel_hi:[1,0,0]
    v_pk_fma_f32 v[20:21], v[20:21], v[14:15], v[10:11] op_sel_hi:[1,0,0]
    v_pk_fma_f32 v[22:23], v[22:23], v[14:15], v[10:11] op_sel_hi:[1,0,0]
    v_pk_mul_f32 v[16:17], v[16:17], v[160:161]
    v_pk_mul_f32 v[18:19], v[18:19], v[162:163]
    v_pk_mul_f32 v[20:21], v[20:21], v[164:165]
    v_pk_mul_f32 v[22:23], v[22:23], v[166:167]
    v_exp_f32 v16, v16
    v_exp_f32 v17, v17
    v_exp_f32 v18, v18
    v_exp_f32 v19, v19
    v_exp_f32 v20, v20
    v_exp_f32 v21, v21
    v_exp_f32 v22, v22
    v_exp_f32 v23, v23
    v_pk_fma_f32 v[16:17], v[16:17], v[4:5], v[4:5] op_sel_hi:[1,0,0]
    v_pk_fma_f32 v[18:19], v[18:19], v[4:5], v[4:5] op_sel_hi:[1,0,0]
    v_pk_fma_f32 v[20:21], v[20:21], v[6:7], v[6:7] op_sel_hi:[1,0,0]
    v_pk_fma_f32 v[22:23], v[22:23], v[6:7], v[6:7] op_sel_hi:[1,0,0]
    v_rcp_f32 v16, v16
    v_rcp_f32 v17, v17
    v_rcp_f32 v18, v18
    v_rcp_f32 v19, v19
    v_rcp_f32 v20, v20
    v_rcp_f32 v21, v21
    v_rcp_f32 v22, v22
    v_rcp_f32 v23, v23
    v_pk_mul_f32 v[160:161], v[160:161], v[16:17]
    v_pk_mul_f32 v[162:163], v[162:163], v[18:19]
    v_pk_mul_f32 v[164:165], v[164:165], v[20:21]
    v_pk_mul_f32 v[166:167], v[166:167], v[22:23]
    v_cvt_pk_bf16_f32 v32, v160, v161
    v_cvt_pk_bf16_f32 v33, v162, v163
    v_cvt_pk_bf16_f32 v34, v164, v165
    v_cvt_pk_bf16_f32 v35, v166, v167
    s_nop 0
    v_permlane16_swap_b32 v32, v34
    v_permlane16_swap_b32 v33, v35
    buffer_store_dwordx4 v[32:35], v206, s[8:11], s98 offen offset:0 sc1
    v_pk_fma_f32 v[168:169], v[84:85], v[0:1], v[168:169] op_sel_hi:[1,0,1]
    v_pk_fma_f32 v[170:171], v[86:87], v[0:1], v[170:171] op_sel_hi:[1,0,1]
    v_pk_fma_f32 v[172:173], v[84:85], v[2:3], v[172:173] op_sel_hi:[1,0,1]
    v_pk_fma_f32 v[174:175], v[86:87], v[2:3], v[174:175] op_sel_hi:[1,0,1]
    v_pk_fma_f32 v[168:169], v[112:113], v[4:5], v[168:169] op_sel_hi:[1,0,1]
    v_pk_fma_f32 v[170:171], v[114:115], v[4:5], v[170:171] op_sel_hi:[1,0,1]
    v_pk_fma_f32 v[172:173], v[112:113], v[6:7], v[172:173] op_sel_hi:[1,0,1]
    v_pk_fma_f32 v[174:175], v[114:115], v[6:7], v[174:175] op_sel_hi:[1,0,1]
    v_pk_mul_f32 v[24:25], v[168:169], v[168:169]
    v_pk_mul_f32 v[26:27], v[170:171], v[170:171]
    v_pk_mul_f32 v[28:29], v[172:173], v[172:173]
    v_pk_mul_f32 v[30:31], v[174:175], v[174:175]
    v_pk_fma_f32 v[24:25], v[24:25], v[12:13], v[8:9] op_sel_hi:[1,0,0]
    v_pk_fma_f32 v[26:27], v[26:27], v[12:13], v[8:9] op_sel_hi:[1,0,0]
    v_pk_fma_f32 v[28:29], v[28:29], v[14:15], v[10:11] op_sel_hi:[1,0,0]
    v_pk_fma_f32 v[30:31], v[30:31], v[14:15], v[10:11] op_sel_hi:[1,0,0]
    v_pk_mul_f32 v[24:25], v[24:25], v[168:169]
    v_pk_mul_f32 v[26:27], v[26:27], v[170:171]
    v_pk_mul_f32 v[28:29], v[28:29], v[172:173]
    v_pk_mul_f32 v[30:31], v[30:31], v[174:175]
    v_exp_f32 v24, v24
    v_exp_f32 v25, v25
    v_exp_f32 v26, v26
    v_exp_f32 v27, v27
    v_exp_f32 v28, v28
    v_exp_f32 v29, v29
    v_exp_f32 v30, v30
    v_exp_f32 v31, v31
    v_pk_fma_f32 v[24:25], v[24:25], v[4:5], v[4:5] op_sel_hi:[1,0,0]
    v_pk_fma_f32 v[26:27], v[26:27], v[4:5], v[4:5] op_sel_hi:[1,0,0]
    v_pk_fma_f32 v[28:29], v[28:29], v[6:7], v[6:7] op_sel_hi:[1,0,0]
    v_pk_fma_f32 v[30:31], v[30:31], v[6:7], v[6:7] op_sel_hi:[1,0,0]
    v_rcp_f32 v24, v24
    v_rcp_f32 v25, v25
    v_rcp_f32 v26, v26
    v_rcp_f32 v27, v27
    v_rcp_f32 v28, v28
    v_rcp_f32 v29, v29
    v_rcp_f32 v30, v30
    v_rcp_f32 v31, v31
    v_pk_mul_f32 v[168:169], v[168:169], v[24:25]
    v_pk_mul_f32 v[170:171], v[170:171], v[26:27]
    v_pk_mul_f32 v[172:173], v[172:173], v[28:29]
    v_pk_mul_f32 v[174:175], v[174:175], v[30:31]
    v_cvt_pk_bf16_f32 v36, v168, v169
    v_cvt_pk_bf16_f32 v37, v170, v171
    v_cvt_pk_bf16_f32 v38, v172, v173
    v_cvt_pk_bf16_f32 v39, v174, v175
    s_nop 0
    v_permlane16_swap_b32 v36, v38
    v_permlane16_swap_b32 v37, v39
    buffer_store_dwordx4 v[36:39], v206, s[8:11], s98 offen offset:1024 sc1
    v_pk_fma_f32 v[176:177], v[88:89], v[0:1], v[176:177] op_sel_hi:[1,0,1]
    v_pk_fma_f32 v[178:179], v[90:91], v[0:1], v[178:179] op_sel_hi:[1,0,1]
    v_pk_fma_f32 v[180:181], v[88:89], v[2:3], v[180:181] op_sel_hi:[1,0,1]
    v_pk_fma_f32 v[182:183], v[90:91], v[2:3], v[182:183] op_sel_hi:[1,0,1]
    v_pk_fma_f32 v[176:177], v[116:117], v[4:5], v[176:177] op_sel_hi:[1,0,1]
    v_pk_fma_f32 v[178:179], v[118:119], v[4:5], v[178:179] op_sel_hi:[1,0,1]
    v_pk_fma_f32 v[180:181], v[116:117], v[6:7], v[180:181] op_sel_hi:[1,0,1]
    v_pk_fma_f32 v[182:183], v[118:119], v[6:7], v[182:183] op_sel_hi:[1,0,1]
    v_pk_mul_f32 v[16:17], v[176:177], v[176:177]
    v_pk_mul_f32 v[18:19], v[178:179], v[178:179]
    v_pk_mul_f32 v[20:21], v[180:181], v[180:181]
    v_pk_mul_f32 v[22:23], v[182:183], v[182:183]
    v_pk_fma_f32 v[16:17], v[16:17], v[12:13], v[8:9] op_sel_hi:[1,0,0]
    v_pk_fma_f32 v[18:19], v[18:19], v[12:13], v[8:9] op_sel_hi:[1,0,0]
    v_pk_fma_f32 v[20:21], v[20:21], v[14:15], v[10:11] op_sel_hi:[1,0,0]
    v_pk_fma_f32 v[22:23], v[22:23], v[14:15], v[10:11] op_sel_hi:[1,0,0]
    v_pk_mul_f32 v[16:17], v[16:17], v[176:177]
    v_pk_mul_f32 v[18:19], v[18:19], v[178:179]
    v_pk_mul_f32 v[20:21], v[20:21], v[180:181]
    v_pk_mul_f32 v[22:23], v[22:23], v[182:183]
    v_exp_f32 v16, v16
    v_exp_f32 v17, v17
    v_exp_f32 v18, v18
    v_exp_f32 v19, v19
    v_exp_f32 v20, v20
    v_exp_f32 v21, v21
    v_exp_f32 v22, v22
    v_exp_f32 v23, v23
    v_pk_fma_f32 v[16:17], v[16:17], v[4:5], v[4:5] op_sel_hi:[1,0,0]
    v_pk_fma_f32 v[18:19], v[18:19], v[4:5], v[4:5] op_sel_hi:[1,0,0]
    v_pk_fma_f32 v[20:21], v[20:21], v[6:7], v[6:7] op_sel_hi:[1,0,0]
    v_pk_fma_f32 v[22:23], v[22:23], v[6:7], v[6:7] op_sel_hi:[1,0,0]
    v_rcp_f32 v16, v16
    v_rcp_f32 v17, v17
    v_rcp_f32 v18, v18
    v_rcp_f32 v19, v19
    v_rcp_f32 v20, v20
    v_rcp_f32 v21, v21
    v_rcp_f32 v22, v22
    v_rcp_f32 v23, v23
    v_pk_mul_f32 v[176:177], v[176:177], v[16:17]
    v_pk_mul_f32 v[178:179], v[178:179], v[18:19]
    v_pk_mul_f32 v[180:181], v[180:181], v[20:21]
    v_pk_mul_f32 v[182:183], v[182:183], v[22:23]
    v_cvt_pk_bf16_f32 v32, v176, v177
    v_cvt_pk_bf16_f32 v33, v178, v179
    v_cvt_pk_bf16_f32 v34, v180, v181
    v_cvt_pk_bf16_f32 v35, v182, v183
    s_nop 0
    v_permlane16_swap_b32 v32, v34
    v_permlane16_swap_b32 v33, v35
    buffer_store_dwordx4 v[32:35], v206, s[8:11], s98 offen offset:2048 sc1
    s_branch L_gelu2
L_code_end:
 s_endpgm

.section .rodata,"a"
.p2align 6
.amdhsa_kernel interleave_layers__sliding_block__dense_activation_gelu__prompt_kernel
  .amdhsa_next_free_vgpr 512
  .amdhsa_next_free_sgpr 102
  .amdhsa_accum_offset 256
  .amdhsa_group_segment_fixed_size 0
  .amdhsa_kernarg_size 88
  .amdhsa_user_sgpr_count 2
  .amdhsa_user_sgpr_kernarg_segment_ptr 1
  .amdhsa_system_sgpr_workgroup_id_x 1
.end_amdhsa_kernel
```
